```python
import torch

def _softmax(x, axis=-1):
    return torch.softmax(x, dim=axis)
def _gelu(x):
    return torch.nn.functional.gelu(x, approximate="tanh")
def _silu(x):
    return torch.nn.functional.silu(x)
def _sigmoid(x):
    return torch.sigmoid(x)
def _layernorm(x, axis=-1, eps=1e-5):
    m = x.mean(dim=axis, keepdim=True)
    v = x.var(dim=axis, keepdim=True, unbiased=False)
    return (x - m) / torch.sqrt(v + eps)
def _scatter_add(tgt, idx, src, axis=0):
    return tgt.clone().index_add_(axis, idx, src)
def _segment_sum(src, seg, n):
    out = torch.zeros((n,) + src.shape[1:], dtype=src.dtype)
    return out.index_add_(0, seg, src)
def _pad(x, pw):
    flat = tuple(v for pair in reversed(pw) for v in pair)
    return torch.nn.functional.pad(x, flat)

kernel_name = 'recurrent_scan__ssm_conv_s4d__geglu_ffn__prompt'

def setup_inputs():

    _w = (lambda a: (lambda t: t.to(torch.bfloat16) if t.is_floating_point() else t)(torch.as_tensor(a)))
    def _A_setup():
        Bsz, L, D, N = 1, 2048, 576, 128
        return {
            "u": _w((lambda *s: torch.randn(*s, dtype=torch.bfloat16) * 0.05)(Bsz, L, D)),
            "log_A_real": _w((lambda *s: torch.randn(*s, dtype=torch.bfloat16) * 6.4)(D, N) * 0.5),
            "A_imag": _w((lambda *s: torch.randn(*s, dtype=torch.bfloat16) * 0.05)(D, N) * 3.14),
            "C_real": _w((lambda *s: torch.randn(*s, dtype=torch.bfloat16) * 0.05)(D, N) / N ** 0.5),
            "C_imag": _w((lambda *s: torch.randn(*s, dtype=torch.bfloat16) * 0.05)(D, N) / N ** 0.5),
            "log_dt": _w((lambda *s: torch.randn(*s, dtype=torch.bfloat16) * 0.05)(D) * 0.5 - 4.0),
            "D_skip": _w((lambda *s: torch.randn(*s, dtype=torch.bfloat16) * 0.05)(D)),
        }
    _A_in = _A_setup()

    def _B_setup():
        B, S, D, F = 1, 2048, 576, 4608
        return {
            "x": _w((lambda *s: torch.randn(*s, dtype=torch.bfloat16) * 0.05)(B, S, D)),
            "w_gate": _w((lambda *s: torch.randn(*s, dtype=torch.bfloat16) * 0.05)(D, F)),
            "w_up": _w((lambda *s: torch.randn(*s, dtype=torch.bfloat16) * 0.05)(D, F)),
            "w_down": _w((lambda *s: torch.randn(*s, dtype=torch.bfloat16) * 0.05)(F, D)),
        }
    _B_in = _B_setup()

    return {
        "A_u": _A_in["u"],
        "A_log_A_real": _A_in["log_A_real"],
        "A_A_imag": _A_in["A_imag"],
        "A_C_real": _A_in["C_real"],
        "A_C_imag": _A_in["C_imag"],
        "A_log_dt": _A_in["log_dt"],
        "A_D_skip": _A_in["D_skip"],
        "B_x": _B_in["x"],
        "B_w_gate": _B_in["w_gate"],
        "B_w_up": _B_in["w_up"],
        "B_w_down": _B_in["w_down"],
    }

def reference(A_u, A_log_A_real, A_A_imag, A_C_real, A_C_imag, A_log_dt, A_D_skip, B_x, B_w_gate, B_w_up, B_w_down):
    def _A_ref(u, log_A_real, A_imag, C_real, C_imag, log_dt, D_skip):
        L = u.shape[1]
        dt = torch.exp(log_dt)
        A = -torch.exp(log_A_real) + 1j * A_imag
        C = (C_real + 1j * C_imag) * dt[:, None]
        pos = (lambda x, dt: x.to(dt))(torch.arange(L), log_dt.dtype)
        P = torch.exp((A * dt[:, None])[:, :, None] * pos[None, None, :])
        K = 2.0 * torch.einsum("dn,dnl->dl", C, P).real
        L2 = 2 * L
        u_t = (lambda x, *d: x.permute(*d))(u, 0, 2, 1)
        Kf = (lambda x, *a, **k: torch.fft.rfft(x.float(), *a, **k))(K, L2)
        Uf = (lambda x, *a, **k: torch.fft.rfft(x.float(), *a, **k))(u_t, L2)
        y = (lambda x, *a, **k: torch.fft.irfft(x, *a, **k).to(torch.bfloat16))(Uf * Kf[None, :, :], L2)[:, :, :L]
        y = (lambda x, *d: x.permute(*d))(y, 0, 2, 1)
        return y + u * D_skip[None, None, :]

    def _B_ref(x, w_gate, w_up, w_down):
        return (_gelu(x @ w_gate) * (x @ w_up)) @ w_down

    x = A_u
    xn = _layernorm(x, axis=-1)
    s = _A_ref(xn, A_log_A_real, A_A_imag, A_C_real, A_C_imag, A_log_dt, A_D_skip)
    g = _silu(_B_ref(xn, B_w_gate, B_w_up, B_w_down))
    return x + s * g
```

```asm
; @launch grid=(256,1,1) block=(256,1,1) lds=163840
.amdgcn_target "amdgcn-amd-amdhsa--gfx950"
.text
.globl recurrent_scan__ssm_conv_s4d__geglu_ffn__prompt_kernel
.p2align 8
.type recurrent_scan__ssm_conv_s4d__geglu_ffn__prompt_kernel,@function
recurrent_scan__ssm_conv_s4d__geglu_ffn__prompt_kernel:
  s_cmp_ge_u32 s2, 256
  s_cbranch_scc1 L_end
  s_load_dwordx2 s[70:71], s[0:1], 0
  s_load_dwordx4 s[72:75], s[0:1], 64
  s_load_dwordx4 s[92:95], s[0:1], 96
  s_load_dwordx4 s[84:87], s[0:1], 80
  s_load_dwordx8 s[8:15], s[0:1], 8
  s_load_dwordx4 s[16:19], s[0:1], 40
  s_getpc_b64 s[68:69]
L_pc:
  s_lshr_b32 s31, s2, 3
  s_lshl_b32 s33, s31, 11
  v_lshrrev_b32 v1, 4, v0
  v_lshl_add_u32 v1, v1, 7, s33
  v_min_u32 v214, code_end-L_pc-4, v1
  global_load_dword v253, v214, s[68:69]
  v_lshrrev_b32 v1, 6, v0
  v_and_b32 v0, 63, v0
  v_readfirstlane_b32 s24, v1
  s_and_b32 s3, s2, 7
  s_and_b32 s25, s3, 1
  s_lshl_b32 s25, s25, 3
  s_lshr_b32 s27, s31, 2
  s_add_u32 s25, s25, s27
  s_lshr_b32 s81, s3, 1
  s_and_b32 s82, s31, 3
  s_lshr_b32 s38, s24, 1
  s_and_b32 s39, s24, 1
  v_lshrrev_b32 v10, 3, v0
  v_and_b32 v11, 7, v0
  s_lshl_b32 s33, s25, 7
  s_lshl_b32 s34, s39, 6
  s_add_u32 s33, s33, s34
  s_lshl_b32 s34, s38, 3
  s_add_u32 s33, s33, s34
  s_and_b32 s35, s82, 0
  s_lshl_b32 s34, s35, 4
  s_add_u32 s33, s33, s34
  v_add_u32 v12, s33, v10
  v_xor_b32 v13, 16, v12
  v_mul_u32_u24 v12, 1152, v12
  v_mul_u32_u24 v13, 1152, v13
  v_lshl_add_u32 v12, v11, 4, v12
  v_lshl_add_u32 v13, v11, 4, v13
  s_lshl_b32 s60, s27, 7
  s_add_u32 s33, s60, 128
  s_cmp_eq_u32 s33, 1152
  s_cselect_b32 s61, 0, s33
  s_add_u32 s33, s61, 128
  s_cmp_eq_u32 s33, 1152
  s_cselect_b32 s62, 0, s33
  s_add_u32 s33, s62, 128
  s_cmp_eq_u32 s33, 1152
  s_cselect_b32 s63, 0, s33
  s_add_u32 s33, s63, 128
  s_cmp_eq_u32 s33, 1152
  s_cselect_b32 s64, 0, s33
  s_add_u32 s33, s64, 128
  s_cmp_eq_u32 s33, 1152
  s_cselect_b32 s65, 0, s33
  s_add_u32 s33, s65, 128
  s_cmp_eq_u32 s33, 1152
  s_cselect_b32 s66, 0, s33
  s_add_u32 s33, s66, 128
  s_cmp_eq_u32 s33, 1152
  s_cselect_b32 s67, 0, s33
  s_add_u32 s33, s67, 128
  s_cmp_eq_u32 s33, 1152
  s_cselect_b32 s88, 0, s33
  s_mov_b32 s6, 2359296
  s_mov_b32 s7, 0x20000
  s_add_u32 s33, s25, s81
  s_and_b32 s33, s33, 1
  s_lshl_b32 s33, s33, 2
  s_add_u32 s33, s33, s82
  s_cmp_eq_u32 s33, 7
  s_waitcnt lgkmcnt(0)
  s_cbranch_scc1 L_vrole
  s_mov_b32 s4, s70
  s_mov_b32 s5, s71
  buffer_load_dwordx4 v[52:55], v12, s[4:7], s60 offen
  buffer_load_dwordx4 v[56:59], v12, s[4:7], s61 offen
  buffer_load_dwordx4 v[60:63], v12, s[4:7], s62 offen
  buffer_load_dwordx4 v[64:67], v12, s[4:7], s63 offen
  buffer_load_dwordx4 v[68:71], v12, s[4:7], s64 offen
  buffer_load_dwordx4 v[72:75], v12, s[4:7], s65 offen
  buffer_load_dwordx4 v[76:79], v12, s[4:7], s66 offen
  buffer_load_dwordx4 v[80:83], v12, s[4:7], s67 offen
  buffer_load_dwordx4 v[84:87], v12, s[4:7], s88 offen
  buffer_load_dwordx4 v[16:19], v13, s[4:7], s60 offen
  s_and_b32 s29, s35, 2
  s_sub_u32 s29, 1, s29
  s_mul_i32 s29, s29, 36864
  s_mov_b32 s83, s35
  s_cmp_eq_u32 s82, 3
  s_cselect_b32 s91, -2, -1
  s_and_b32 s33, s81, s91
  s_mul_i32 s37, s33, 18
  s_mul_i32 s33, s82, 5
  s_add_u32 s37, s37, s33
  s_lshl_b32 s33, s24, 3
  v_add_u32 v1, s33, v10
  v_mul_u32_u24 v1, 9216, v1
  v_bfe_u32 v2, v0, 4, 1
  s_lshl_b32 s33, s39, 1
  v_or_b32 v2, s33, v2
  v_lshlrev_b32 v2, 1, v2
  v_xor_b32 v2, v2, v11
  v_lshl_add_u32 v1, v2, 4, v1
  s_lshl_b32 s33, s37, 7
  v_add_u32 v1, s33, v1
  s_lshl_b32 s28, s24, 11
  v_lshrrev_b32 v160, 4, v0
  v_bfe_u32 v161, v0, 2, 2
  v_and_b32 v162, 3, v0
  v_lshlrev_b32 v2, 11, v160
  v_lshl_add_u32 v2, v161, 7, v2
  v_lshl_add_u32 v2, v162, 3, v2
  v_bfe_u32 v163, v0, 3, 2
  s_lshl_b32 s33, s38, 1
  v_xor_b32 v163, s33, v163
  v_lshl_add_u32 v2, v163, 5, v2
  v_xor_b32 v3, 32, v2
  s_mov_b32 s3, 0xffff0000
  s_lshl_b32 s33, s38, 2
  v_add_u32 v163, s33, v160
  v_xor_b32 v163, v163, v11
  s_lshl_b32 s33, s39, 11
  s_lshl_b32 s34, s38, 10
  s_add_u32 s34, s34, s33
  s_add_u32 s34, s34, 90112
  v_lshl_add_u32 v224, v10, 7, s34
  v_lshl_add_u32 v224, v163, 4, v224
  v_add_u32 v225, 36864, v224
  v_and_b32 v164, 15, v0
  v_lshrrev_b32 v165, 1, v164
  v_xor_b32 v165, v165, v160
  s_add_u32 s33, s33, 90112
  v_lshl_add_u32 v226, v164, 7, s33
  v_lshl_add_u32 v226, v165, 4, v226
  v_xor_b32 v227, 64, v226
  v_add_u32 v228, 36864, v226
  v_add_u32 v229, 36864, v227
  s_mul_i32 s59, s81, 9
  s_min_u32 s34, s82, 2
  s_mul_i32 s34, s34, 3
  s_add_u32 s59, s59, s34
  s_add_u32 s58, s59, s38
  s_add_u32 s59, s59, 2
  v_lshrrev_b32 v165, 2, v0
  v_lshl_add_u32 v166, v165, 7, s33
  v_and_b32 v167, 1, v0
  v_lshl_add_u32 v166, v167, 3, v166
  v_bfe_u32 v167, v0, 1, 1
  v_xor_b32 v165, v10, v167
  s_lshr_b32 s33, s58, 2
  s_sub_u32 s33, s33, s27
  s_cselect_b32 s34, 9, 0
  s_add_u32 s33, s33, s34
  s_lshl_b32 s33, s33, 12
  s_and_b32 s34, s58, 3
  s_lshl_b32 s34, s34, 1
  v_xor_b32 v167, s34, v165
  v_lshl_add_u32 v14, v167, 4, v166
  v_add_u32 v14, s33, v14
  s_lshr_b32 s33, s59, 2
  s_sub_u32 s33, s33, s27
  s_cselect_b32 s34, 9, 0
  s_add_u32 s33, s33, s34
  s_lshl_b32 s33, s33, 12
  s_and_b32 s34, s59, 3
  s_lshl_b32 s34, s34, 1
  v_xor_b32 v167, s34, v165
  v_lshl_add_u32 v15, v167, 4, v166
  v_add_u32 v15, s33, v15
  v_bfe_u32 v165, v0, 2, 2
  v_cmp_eq_u32 vcc, v165, v160
  v_mov_b32 v165, 0x3f803f80
  v_mov_b32 v166, 0
  v_cndmask_b32 v232, v166, v165, vcc
  v_cndmask_b32 v233, v166, v165, vcc
  v_cndmask_b32 v234, v166, v165, vcc
  v_cndmask_b32 v235, v166, v165, vcc
  v_and_b32 v165, 1, v0
  v_lshlrev_b32 v165, 4, v165
  v_mov_b32 v167, 0xffff
  v_lshlrev_b32 v165, v165, v167
  v_and_b32 v165, v165, v232
  v_and_b32 v167, 2, v0
  v_cmp_eq_u32 vcc, 0, v167
  v_mov_b32 v240, 0
  v_mov_b32 v241, 0
  v_mov_b32 v244, 0
  v_mov_b32 v245, 0
  v_cndmask_b32 v242, v166, v165, vcc
  v_cndmask_b32 v243, v165, v166, vcc
  buffer_load_dwordx4 v[20:23], v13, s[4:7], s61 offen
  buffer_load_dwordx4 v[24:27], v13, s[4:7], s62 offen
  s_mov_b64 exec, 0
  s_cmp_eq_u32 s24, 1
  s_cbranch_scc1 L_pg1
  s_cmp_eq_u32 s24, 2
  s_cbranch_scc1 L_pg2
  s_cmp_eq_u32 s24, 3
  s_cbranch_scc1 L_pg3
  s_branch L_pg0
L_back:
  s_mov_b64 exec, -1
  buffer_load_dwordx4 v[28:31], v13, s[4:7], s63 offen
  buffer_load_dwordx4 v[32:35], v13, s[4:7], s64 offen
  buffer_load_dwordx4 v[36:39], v13, s[4:7], s65 offen
  buffer_load_dwordx4 v[40:43], v13, s[4:7], s66 offen
  buffer_load_dwordx4 v[44:47], v13, s[4:7], s67 offen
  buffer_load_dwordx4 v[48:51], v13, s[4:7], s88 offen
  v_add_u32 v12, s29, v12
  v_add_u32 v13, s29, v13
  s_mov_b32 s33, 0x3f803f80
  s_branch L_main
.p2align 12
L_main:
L_pg0:
  s_cbranch_execz L_pg4
  s_waitcnt vmcnt(15)
  v_dot2_f32_bf16 v208, s33, v52, 0
  v_dot2_f32_bf16 v210, v52, v52, 0
  s_nop 1
  v_dot2c_f32_bf16 v208, s33, v53
  v_dot2c_f32_bf16 v210, v53, v53
  v_dot2c_f32_bf16 v208, s33, v54
  v_dot2c_f32_bf16 v210, v54, v54
  v_dot2c_f32_bf16 v208, s33, v55
  v_dot2c_f32_bf16 v210, v55, v55
  v_dot2c_f32_bf16 v208, s33, v56
  v_dot2c_f32_bf16 v210, v56, v56
  v_dot2c_f32_bf16 v208, s33, v57
  v_dot2c_f32_bf16 v210, v57, v57
  v_dot2c_f32_bf16 v208, s33, v58
  v_dot2c_f32_bf16 v210, v58, v58
  v_dot2c_f32_bf16 v208, s33, v59
  v_dot2c_f32_bf16 v210, v59, v59
  v_dot2c_f32_bf16 v208, s33, v60
  v_dot2c_f32_bf16 v210, v60, v60
  v_dot2c_f32_bf16 v208, s33, v61
  v_dot2c_f32_bf16 v210, v61, v61
  v_dot2c_f32_bf16 v208, s33, v62
  v_dot2c_f32_bf16 v210, v62, v62
  v_dot2c_f32_bf16 v208, s33, v63
  v_dot2c_f32_bf16 v210, v63, v63
  s_waitcnt vmcnt(12)
  v_dot2c_f32_bf16 v208, s33, v64
  v_dot2c_f32_bf16 v210, v64, v64
  v_dot2c_f32_bf16 v208, s33, v65
  v_dot2c_f32_bf16 v210, v65, v65
  v_dot2c_f32_bf16 v208, s33, v66
  v_dot2c_f32_bf16 v210, v66, v66
  v_dot2c_f32_bf16 v208, s33, v67
  v_dot2c_f32_bf16 v210, v67, v67
  v_dot2c_f32_bf16 v208, s33, v68
  v_dot2c_f32_bf16 v210, v68, v68
  v_dot2c_f32_bf16 v208, s33, v69
  v_dot2c_f32_bf16 v210, v69, v69
  v_dot2c_f32_bf16 v208, s33, v70
  v_dot2c_f32_bf16 v210, v70, v70
  v_dot2c_f32_bf16 v208, s33, v71
  v_dot2c_f32_bf16 v210, v71, v71
  v_dot2c_f32_bf16 v208, s33, v72
  v_dot2c_f32_bf16 v210, v72, v72
  v_dot2c_f32_bf16 v208, s33, v73
  v_dot2c_f32_bf16 v210, v73, v73
  v_dot2c_f32_bf16 v208, s33, v74
  v_dot2c_f32_bf16 v210, v74, v74
  v_dot2c_f32_bf16 v208, s33, v75
  v_dot2c_f32_bf16 v210, v75, v75
  s_waitcnt vmcnt(9)
  v_dot2c_f32_bf16 v208, s33, v76
  v_dot2c_f32_bf16 v210, v76, v76
  v_dot2c_f32_bf16 v208, s33, v77
  v_dot2c_f32_bf16 v210, v77, v77
  v_dot2c_f32_bf16 v208, s33, v78
  v_dot2c_f32_bf16 v210, v78, v78
  v_dot2c_f32_bf16 v208, s33, v79
  v_dot2c_f32_bf16 v210, v79, v79
  v_dot2c_f32_bf16 v208, s33, v80
  v_dot2c_f32_bf16 v210, v80, v80
  v_dot2c_f32_bf16 v208, s33, v81
  v_dot2c_f32_bf16 v210, v81, v81
  v_dot2c_f32_bf16 v208, s33, v82
  v_dot2c_f32_bf16 v210, v82, v82
  v_dot2c_f32_bf16 v208, s33, v83
  v_dot2c_f32_bf16 v210, v83, v83
  v_dot2c_f32_bf16 v208, s33, v84
  v_dot2c_f32_bf16 v210, v84, v84
  v_dot2c_f32_bf16 v208, s33, v85
  v_dot2c_f32_bf16 v210, v85, v85
  v_dot2c_f32_bf16 v208, s33, v86
  v_dot2c_f32_bf16 v210, v86, v86
  v_dot2c_f32_bf16 v208, s33, v87
  v_dot2c_f32_bf16 v210, v87, v87
  buffer_load_dwordx4 v[88:91], v12, s[4:7], s60 offen
  buffer_load_dwordx4 v[92:95], v12, s[4:7], s61 offen
  v_lshlrev_b32 v160, 16, v52
  v_and_b32_e64 v161, s3, v52
  v_add_f32_dpp v208, v208, v208 quad_perm:[1,0,3,2] row_mask:0xf bank_mask:0xf
  v_add_f32_dpp v210, v210, v210 quad_perm:[1,0,3,2] row_mask:0xf bank_mask:0xf
  v_lshlrev_b32_e64 v162, 16, v53
  v_add_f32_dpp v208, v208, v208 quad_perm:[2,3,0,1] row_mask:0xf bank_mask:0xf
  v_add_f32_dpp v210, v210, v210 quad_perm:[2,3,0,1] row_mask:0xf bank_mask:0xf
  v_and_b32_e64 v163, s3, v53
  v_add_f32_dpp v208, v208, v208 row_half_mirror row_mask:0xf bank_mask:0xf
  v_add_f32_dpp v210, v210, v210 row_half_mirror row_mask:0xf bank_mask:0xf
  v_mul_f32 v208, 0x3ae38e39, v208
  v_mul_f32 v210, 0x3ae38e39, v210
  v_fma_f32 v210, -v208, v208, v210
  v_max_f32_e64 v210, 0, v210
  v_cvt_pk_bf16_f32 v208, v210, v208
  v_lshlrev_b32_e64 v210, 16, v208
  v_add_f32 v210, 0x3727c5ac, v210
  v_cvt_pk_bf16_f32 v210, v210, v210
  v_and_b32 v210, s3, v210
  v_sqrt_f32 v210, v210
  v_and_b32_e64 v208, s3, v208
  v_cvt_pk_bf16_f32 v210, v210, v210
  v_and_b32 v210, s3, v210
  v_rcp_f32 v210, v210
  v_lshlrev_b32_e64 v164, 16, v54
  v_mul_f32 v210, 0x3eeff558, v210
  v_mul_f32 v208, v208, v210
  v_and_b32 v165, s3, v54
  v_lshlrev_b32 v166, 16, v55
  v_and_b32 v167, s3, v55
  v_pk_fma_f32 v[160:161], v[160:161], v[210:211], v[208:209] op_sel_hi:[1,0,0] neg_lo:[0,0,1] neg_hi:[0,0,1]
  v_pk_fma_f32 v[162:163], v[162:163], v[210:211], v[208:209] op_sel_hi:[1,0,0] neg_lo:[0,0,1] neg_hi:[0,0,1]
  v_pk_fma_f32 v[164:165], v[164:165], v[210:211], v[208:209] op_sel_hi:[1,0,0] neg_lo:[0,0,1] neg_hi:[0,0,1]
  v_pk_fma_f32 v[166:167], v[166:167], v[210:211], v[208:209] op_sel_hi:[1,0,0] neg_lo:[0,0,1] neg_hi:[0,0,1]
  v_mfma_f32_16x16x32_bf16 v[168:171], v[242:245], v[56:59], 0
  s_sub_u32 s12, s74, 1024
  v_cvt_pk_bf16_f32 v52, v160, v161
  v_cvt_pk_bf16_f32 v53, v162, v163
  v_mfma_f32_16x16x32_bf16 v[172:175], v[240:243], v[56:59], 0
  s_subb_u32 s13, s75, 0
  v_cvt_pk_bf16_f32 v54, v164, v165
  v_cvt_pk_bf16_f32 v55, v166, v167
  ds_write_b128 v224, v[52:55] offset:0
  buffer_load_dwordx4 v[96:99], v12, s[4:7], s62 offen
  v_pk_fma_f32 v[168:169], v[168:169], v[210:211], v[208:209] op_sel_hi:[1,0,0] neg_lo:[0,0,1] neg_hi:[0,0,1]
  v_pk_fma_f32 v[170:171], v[170:171], v[210:211], v[208:209] op_sel_hi:[1,0,0] neg_lo:[0,0,1] neg_hi:[0,0,1]
  s_nop 0
  v_pk_fma_f32 v[172:173], v[172:173], v[210:211], v[208:209] op_sel_hi:[1,0,0] neg_lo:[0,0,1] neg_hi:[0,0,1]
  v_pk_fma_f32 v[174:175], v[174:175], v[210:211], v[208:209] op_sel_hi:[1,0,0] neg_lo:[0,0,1] neg_hi:[0,0,1]
  v_mfma_f32_16x16x32_bf16 v[160:163], v[242:245], v[60:63], 0
  s_mov_b32 s14, 5309440
  v_cvt_pk_bf16_f32 v56, v168, v169
  v_cvt_pk_bf16_f32 v57, v170, v171
  v_mfma_f32_16x16x32_bf16 v[164:167], v[240:243], v[60:63], 0
  s_mov_b32 s15, 0x20000
  v_cvt_pk_bf16_f32 v58, v172, v173
  v_cvt_pk_bf16_f32 v59, v174, v175
  ds_write_b128 v224, v[56:59] offset:4096
  buffer_load_dwordx4 v[100:103], v12, s[4:7], s63 offen
  v_pk_fma_f32 v[160:161], v[160:161], v[210:211], v[208:209] op_sel_hi:[1,0,0] neg_lo:[0,0,1] neg_hi:[0,0,1]
  v_pk_fma_f32 v[162:163], v[162:163], v[210:211], v[208:209] op_sel_hi:[1,0,0] neg_lo:[0,0,1] neg_hi:[0,0,1]
  s_nop 0
  v_pk_fma_f32 v[164:165], v[164:165], v[210:211], v[208:209] op_sel_hi:[1,0,0] neg_lo:[0,0,1] neg_hi:[0,0,1]
  v_pk_fma_f32 v[166:167], v[166:167], v[210:211], v[208:209] op_sel_hi:[1,0,0] neg_lo:[0,0,1] neg_hi:[0,0,1]
  v_mfma_f32_16x16x32_bf16 v[168:171], v[242:245], v[64:67], 0
  s_mov_b32 s8, s72
  v_cvt_pk_bf16_f32 v60, v160, v161
  v_cvt_pk_bf16_f32 v61, v162, v163
  v_mfma_f32_16x16x32_bf16 v[172:175], v[240:243], v[64:67], 0
  s_mov_b32 s9, s73
  v_cvt_pk_bf16_f32 v62, v164, v165
  v_cvt_pk_bf16_f32 v63, v166, v167
  ds_write_b128 v224, v[60:63] offset:8192
  buffer_load_dwordx4 v[104:107], v12, s[4:7], s64 offen
  v_pk_fma_f32 v[168:169], v[168:169], v[210:211], v[208:209] op_sel_hi:[1,0,0] neg_lo:[0,0,1] neg_hi:[0,0,1]
  v_pk_fma_f32 v[170:171], v[170:171], v[210:211], v[208:209] op_sel_hi:[1,0,0] neg_lo:[0,0,1] neg_hi:[0,0,1]
  s_nop 0
  v_pk_fma_f32 v[172:173], v[172:173], v[210:211], v[208:209] op_sel_hi:[1,0,0] neg_lo:[0,0,1] neg_hi:[0,0,1]
  v_pk_fma_f32 v[174:175], v[174:175], v[210:211], v[208:209] op_sel_hi:[1,0,0] neg_lo:[0,0,1] neg_hi:[0,0,1]
  v_mfma_f32_16x16x32_bf16 v[160:163], v[242:245], v[68:71], 0
  s_mov_b32 s10, 5308416
  v_cvt_pk_bf16_f32 v64, v168, v169
  v_cvt_pk_bf16_f32 v65, v170, v171
  v_mfma_f32_16x16x32_bf16 v[164:167], v[240:243], v[68:71], 0
  s_mov_b32 s11, 0x20000
  v_cvt_pk_bf16_f32 v66, v172, v173
  v_cvt_pk_bf16_f32 v67, v174, v175
  ds_write_b128 v224, v[64:67] offset:12288
  buffer_load_dwordx4 v[108:111], v12, s[4:7], s65 offen
  v_pk_fma_f32 v[160:161], v[160:161], v[210:211], v[208:209] op_sel_hi:[1,0,0] neg_lo:[0,0,1] neg_hi:[0,0,1]
  v_pk_fma_f32 v[162:163], v[162:163], v[210:211], v[208:209] op_sel_hi:[1,0,0] neg_lo:[0,0,1] neg_hi:[0,0,1]
  s_nop 0
  v_pk_fma_f32 v[164:165], v[164:165], v[210:211], v[208:209] op_sel_hi:[1,0,0] neg_lo:[0,0,1] neg_hi:[0,0,1]
  v_pk_fma_f32 v[166:167], v[166:167], v[210:211], v[208:209] op_sel_hi:[1,0,0] neg_lo:[0,0,1] neg_hi:[0,0,1]
  v_mfma_f32_16x16x32_bf16 v[168:171], v[242:245], v[72:75], 0
  s_mul_i32 s40, s60, 4608
  v_cvt_pk_bf16_f32 v68, v160, v161
  v_cvt_pk_bf16_f32 v69, v162, v163
  v_mfma_f32_16x16x32_bf16 v[172:175], v[240:243], v[72:75], 0
  s_add_u32 s41, s40, 294912
  v_cvt_pk_bf16_f32 v70, v164, v165
  v_cvt_pk_bf16_f32 v71, v166, v167
  s_waitcnt vmcnt(14)
  v_mfma_f32_16x16x32_bf16 v[236:239], v[232:235], v[16:19], 0
  ds_write_b128 v224, v[68:71] offset:16384
  buffer_load_dwordx4 v[112:115], v12, s[4:7], s66 offen
  v_pk_fma_f32 v[168:169], v[168:169], v[210:211], v[208:209] op_sel_hi:[1,0,0] neg_lo:[0,0,1] neg_hi:[0,0,1]
  v_pk_fma_f32 v[170:171], v[170:171], v[210:211], v[208:209] op_sel_hi:[1,0,0] neg_lo:[0,0,1] neg_hi:[0,0,1]
  v_pk_fma_f32 v[172:173], v[172:173], v[210:211], v[208:209] op_sel_hi:[1,0,0] neg_lo:[0,0,1] neg_hi:[0,0,1]
  v_pk_fma_f32 v[174:175], v[174:175], v[210:211], v[208:209] op_sel_hi:[1,0,0] neg_lo:[0,0,1] neg_hi:[0,0,1]
  v_mfma_f32_16x16x32_bf16 v[160:163], v[242:245], v[76:79], 0
  s_mul_i32 s42, s61, 4608
  v_cvt_pk_bf16_f32 v72, v168, v169
  v_cvt_pk_bf16_f32 v73, v170, v171
  v_mfma_f32_16x16x32_bf16 v[164:167], v[240:243], v[76:79], 0
  s_add_u32 s43, s42, 294912
  v_cvt_pk_bf16_f32 v74, v172, v173
  v_cvt_pk_bf16_f32 v75, v174, v175
  s_waitcnt vmcnt(13)
  v_mfma_f32_16x16x32_bf16 v[236:239], v[232:235], v[20:23], v[236:239]
  ds_write_b128 v224, v[72:75] offset:20480
  v_mfma_f32_16x16x32_bf16 v[236:239], v[232:235], v[24:27], v[236:239]
  buffer_load_dwordx4 v[116:119], v12, s[4:7], s67 offen
  v_pk_fma_f32 v[160:161], v[160:161], v[210:211], v[208:209] op_sel_hi:[1,0,0] neg_lo:[0,0,1] neg_hi:[0,0,1]
  v_pk_fma_f32 v[162:163], v[162:163], v[210:211], v[208:209] op_sel_hi:[1,0,0] neg_lo:[0,0,1] neg_hi:[0,0,1]
  v_pk_fma_f32 v[164:165], v[164:165], v[210:211], v[208:209] op_sel_hi:[1,0,0] neg_lo:[0,0,1] neg_hi:[0,0,1]
  v_pk_fma_f32 v[166:167], v[166:167], v[210:211], v[208:209] op_sel_hi:[1,0,0] neg_lo:[0,0,1] neg_hi:[0,0,1]
  v_mfma_f32_16x16x32_bf16 v[168:171], v[242:245], v[80:83], 0
  s_mul_i32 s44, s62, 4608
  v_cvt_pk_bf16_f32 v76, v160, v161
  v_cvt_pk_bf16_f32 v77, v162, v163
  v_mfma_f32_16x16x32_bf16 v[172:175], v[240:243], v[80:83], 0
  s_add_u32 s45, s44, 294912
  v_cvt_pk_bf16_f32 v78, v164, v165
  v_cvt_pk_bf16_f32 v79, v166, v167
  s_waitcnt vmcnt(12)
  v_mfma_f32_16x16x32_bf16 v[236:239], v[232:235], v[28:31], v[236:239]
  ds_write_b128 v224, v[76:79] offset:24576
  v_mfma_f32_16x16x32_bf16 v[236:239], v[232:235], v[32:35], v[236:239]
  buffer_load_dwordx4 v[120:123], v12, s[4:7], s88 offen
  v_pk_fma_f32 v[168:169], v[168:169], v[210:211], v[208:209] op_sel_hi:[1,0,0] neg_lo:[0,0,1] neg_hi:[0,0,1]
  v_pk_fma_f32 v[170:171], v[170:171], v[210:211], v[208:209] op_sel_hi:[1,0,0] neg_lo:[0,0,1] neg_hi:[0,0,1]
  v_pk_fma_f32 v[172:173], v[172:173], v[210:211], v[208:209] op_sel_hi:[1,0,0] neg_lo:[0,0,1] neg_hi:[0,0,1]
  v_pk_fma_f32 v[174:175], v[174:175], v[210:211], v[208:209] op_sel_hi:[1,0,0] neg_lo:[0,0,1] neg_hi:[0,0,1]
  v_mfma_f32_16x16x32_bf16 v[160:163], v[242:245], v[84:87], 0
  s_mul_i32 s46, s63, 4608
  v_cvt_pk_bf16_f32 v80, v168, v169
  v_cvt_pk_bf16_f32 v81, v170, v171
  v_mfma_f32_16x16x32_bf16 v[164:167], v[240:243], v[84:87], 0
  s_add_u32 s47, s46, 294912
  v_cvt_pk_bf16_f32 v82, v172, v173
  v_cvt_pk_bf16_f32 v83, v174, v175
  s_waitcnt vmcnt(11)
  v_mfma_f32_16x16x32_bf16 v[236:239], v[232:235], v[36:39], v[236:239]
  ds_write_b128 v224, v[80:83] offset:28672
  v_mfma_f32_16x16x32_bf16 v[236:239], v[232:235], v[40:43], v[236:239]
  v_pk_fma_f32 v[160:161], v[160:161], v[210:211], v[208:209] op_sel_hi:[1,0,0] neg_lo:[0,0,1] neg_hi:[0,0,1]
  v_pk_fma_f32 v[162:163], v[162:163], v[210:211], v[208:209] op_sel_hi:[1,0,0] neg_lo:[0,0,1] neg_hi:[0,0,1]
  v_pk_fma_f32 v[164:165], v[164:165], v[210:211], v[208:209] op_sel_hi:[1,0,0] neg_lo:[0,0,1] neg_hi:[0,0,1]
  v_pk_fma_f32 v[166:167], v[166:167], v[210:211], v[208:209] op_sel_hi:[1,0,0] neg_lo:[0,0,1] neg_hi:[0,0,1]
  v_cvt_pk_bf16_f32 v84, v160, v161
  v_cvt_pk_bf16_f32 v85, v162, v163
  v_cvt_pk_bf16_f32 v86, v164, v165
  v_cvt_pk_bf16_f32 v87, v166, v167
  s_waitcnt vmcnt(9)
  v_mfma_f32_16x16x32_bf16 v[236:239], v[232:235], v[44:47], v[236:239]
  ds_write_b128 v224, v[84:87] offset:32768
  v_mfma_f32_16x16x32_bf16 v[236:239], v[232:235], v[48:51], v[236:239]
  buffer_load_dwordx4 v[124:127], v13, s[4:7], s60 offen
  v_dot2_f32_bf16 v210, v16, v16, 0
  s_nop 1
  s_nop 0
  v_dot2c_f32_bf16 v210, v17, v17
  v_dot2c_f32_bf16 v210, v18, v18
  v_dot2c_f32_bf16 v210, v19, v19
  v_dot2c_f32_bf16 v210, v20, v20
  v_dot2c_f32_bf16 v210, v21, v21
  v_dot2c_f32_bf16 v210, v22, v22
  v_dot2c_f32_bf16 v210, v23, v23
  v_dot2c_f32_bf16 v210, v24, v24
  v_dot2c_f32_bf16 v210, v25, v25
  v_dot2c_f32_bf16 v210, v26, v26
  v_dot2c_f32_bf16 v210, v27, v27
  v_dot2c_f32_bf16 v210, v28, v28
  v_dot2c_f32_bf16 v210, v29, v29
  v_dot2c_f32_bf16 v210, v30, v30
  v_dot2c_f32_bf16 v210, v31, v31
  v_dot2c_f32_bf16 v210, v32, v32
  v_dot2c_f32_bf16 v210, v33, v33
  buffer_load_dwordx4 v[128:131], v13, s[4:7], s61 offen
  v_dot2c_f32_bf16 v210, v34, v34
  v_dot2c_f32_bf16 v210, v35, v35
  v_dot2c_f32_bf16 v210, v36, v36
  v_dot2c_f32_bf16 v210, v37, v37
  v_dot2c_f32_bf16 v210, v38, v38
  v_dot2c_f32_bf16 v210, v39, v39
  v_dot2c_f32_bf16 v210, v40, v40
  v_dot2c_f32_bf16 v210, v41, v41
  v_dot2c_f32_bf16 v210, v42, v42
  v_dot2c_f32_bf16 v210, v43, v43
  v_dot2c_f32_bf16 v210, v44, v44
  v_dot2c_f32_bf16 v210, v45, v45
  v_dot2c_f32_bf16 v210, v46, v46
  v_dot2c_f32_bf16 v210, v47, v47
  v_dot2c_f32_bf16 v210, v48, v48
  v_dot2c_f32_bf16 v210, v49, v49
  v_dot2c_f32_bf16 v210, v50, v50
  v_dot2c_f32_bf16 v210, v51, v51
  s_waitcnt lgkmcnt(0)
  s_cmp_eq_u32 s38, 0
  s_cbranch_scc1 L_ln1a
  s_barrier
L_ln1a:
  v_lshlrev_b32 v160, 16, v16
  v_add_f32_dpp v208, v236, v236 quad_perm:[1,0,3,2] row_mask:0xf bank_mask:0xf
  v_add_f32_dpp v210, v210, v210 quad_perm:[1,0,3,2] row_mask:0xf bank_mask:0xf
  v_and_b32_e64 v161, s3, v16
  v_add_f32_dpp v208, v208, v208 quad_perm:[2,3,0,1] row_mask:0xf bank_mask:0xf
  v_add_f32_dpp v210, v210, v210 quad_perm:[2,3,0,1] row_mask:0xf bank_mask:0xf
  v_lshlrev_b32_e64 v162, 16, v17
  v_add_f32_dpp v208, v208, v208 row_half_mirror row_mask:0xf bank_mask:0xf
  v_add_f32_dpp v210, v210, v210 row_half_mirror row_mask:0xf bank_mask:0xf
  v_mul_f32 v208, 0x3ae38e39, v208
  v_mul_f32 v210, 0x3ae38e39, v210
  v_fma_f32 v210, -v208, v208, v210
  v_max_f32_e64 v210, 0, v210
  s_cbranch_scc0 L_ln1b
  s_barrier
L_ln1b:
  v_cvt_pk_bf16_f32 v208, v210, v208
  v_lshlrev_b32_e64 v210, 16, v208
  v_add_f32 v210, 0x3727c5ac, v210
  v_cvt_pk_bf16_f32 v210, v210, v210
  v_and_b32 v210, s3, v210
  v_sqrt_f32 v210, v210
  v_and_b32_e64 v208, s3, v208
  v_cvt_pk_bf16_f32 v210, v210, v210
  v_and_b32 v210, s3, v210
  v_rcp_f32 v210, v210
  v_and_b32_e64 v163, s3, v17
  v_mul_f32 v210, 0x3eeff558, v210
  v_mul_f32 v208, v208, v210
  v_lshlrev_b32 v164, 16, v18
  v_and_b32 v165, s3, v18
  v_lshlrev_b32 v166, 16, v19
  v_and_b32_e64 v167, s3, v19
  v_pk_fma_f32 v[160:161], v[160:161], v[210:211], v[208:209] op_sel_hi:[1,0,0] neg_lo:[0,0,1] neg_hi:[0,0,1]
  v_pk_fma_f32 v[162:163], v[162:163], v[210:211], v[208:209] op_sel_hi:[1,0,0] neg_lo:[0,0,1] neg_hi:[0,0,1]
  v_pk_fma_f32 v[164:165], v[164:165], v[210:211], v[208:209] op_sel_hi:[1,0,0] neg_lo:[0,0,1] neg_hi:[0,0,1]
  v_pk_fma_f32 v[166:167], v[166:167], v[210:211], v[208:209] op_sel_hi:[1,0,0] neg_lo:[0,0,1] neg_hi:[0,0,1]
  v_mfma_f32_16x16x32_bf16 v[168:171], v[242:245], v[20:23], 0
  s_mul_i32 s48, s64, 4608
  v_cvt_pk_bf16_f32 v16, v160, v161
  v_cvt_pk_bf16_f32 v17, v162, v163
  v_mfma_f32_16x16x32_bf16 v[172:175], v[240:243], v[20:23], 0
  s_add_u32 s49, s48, 294912
  v_cvt_pk_bf16_f32 v18, v164, v165
  v_cvt_pk_bf16_f32 v19, v166, v167
  s_waitcnt vmcnt(8)
  v_mfma_f32_16x16x32_bf16 v[236:239], v[232:235], v[88:91], 0
  ds_read_b128 a[0:3], v226 offset:0
  ds_read_b128 a[16:19], v227 offset:0
  ds_read_b64_tr_b16 v[80:81], v14 offset:0
  ds_write_b128 v225, v[16:19] offset:0
  s_nop 0
  buffer_load_dwordx4 v[132:135], v13, s[4:7], s62 offen
  v_pk_fma_f32 v[168:169], v[168:169], v[210:211], v[208:209] op_sel_hi:[1,0,0] neg_lo:[0,0,1] neg_hi:[0,0,1]
  v_pk_fma_f32 v[170:171], v[170:171], v[210:211], v[208:209] op_sel_hi:[1,0,0] neg_lo:[0,0,1] neg_hi:[0,0,1]
  v_pk_fma_f32 v[172:173], v[172:173], v[210:211], v[208:209] op_sel_hi:[1,0,0] neg_lo:[0,0,1] neg_hi:[0,0,1]
  v_pk_fma_f32 v[174:175], v[174:175], v[210:211], v[208:209] op_sel_hi:[1,0,0] neg_lo:[0,0,1] neg_hi:[0,0,1]
  v_mfma_f32_16x16x32_bf16 v[160:163], v[242:245], v[24:27], 0
  s_mul_i32 s50, s65, 4608
  v_cvt_pk_bf16_f32 v20, v168, v169
  v_cvt_pk_bf16_f32 v21, v170, v171
  v_mfma_f32_16x16x32_bf16 v[164:167], v[240:243], v[24:27], 0
  s_add_u32 s51, s50, 294912
  v_cvt_pk_bf16_f32 v22, v172, v173
  v_cvt_pk_bf16_f32 v23, v174, v175
  v_mfma_f32_16x16x32_bf16 v[236:239], v[232:235], v[92:95], v[236:239]
  ds_read_b128 a[32:35], v226 offset:4096
  ds_read_b128 a[48:51], v227 offset:4096
  ds_read_b64_tr_b16 v[84:85], v15 offset:0
  ds_write_b128 v225, v[20:23] offset:4096
  buffer_load_dwordx4 v[136:139], v13, s[4:7], s63 offen
  v_pk_fma_f32 v[160:161], v[160:161], v[210:211], v[208:209] op_sel_hi:[1,0,0] neg_lo:[0,0,1] neg_hi:[0,0,1]
  v_pk_fma_f32 v[162:163], v[162:163], v[210:211], v[208:209] op_sel_hi:[1,0,0] neg_lo:[0,0,1] neg_hi:[0,0,1]
  v_pk_fma_f32 v[164:165], v[164:165], v[210:211], v[208:209] op_sel_hi:[1,0,0] neg_lo:[0,0,1] neg_hi:[0,0,1]
  v_pk_fma_f32 v[166:167], v[166:167], v[210:211], v[208:209] op_sel_hi:[1,0,0] neg_lo:[0,0,1] neg_hi:[0,0,1]
  v_mfma_f32_16x16x32_bf16 v[168:171], v[242:245], v[28:31], 0
  s_mul_i32 s52, s66, 4608
  v_cvt_pk_bf16_f32 v24, v160, v161
  v_cvt_pk_bf16_f32 v25, v162, v163
  v_mfma_f32_16x16x32_bf16 v[172:175], v[240:243], v[28:31], 0
  s_add_u32 s53, s52, 294912
  v_cvt_pk_bf16_f32 v26, v164, v165
  v_cvt_pk_bf16_f32 v27, v166, v167
  v_mfma_f32_16x16x32_bf16 v[236:239], v[232:235], v[96:99], v[236:239]
  ds_read_b128 a[64:67], v226 offset:8192
  ds_read_b128 a[80:83], v227 offset:8192
  ds_write_b128 v225, v[24:27] offset:8192
  buffer_load_dwordx4 v[140:143], v13, s[4:7], s64 offen
  v_pk_fma_f32 v[168:169], v[168:169], v[210:211], v[208:209] op_sel_hi:[1,0,0] neg_lo:[0,0,1] neg_hi:[0,0,1]
  v_pk_fma_f32 v[170:171], v[170:171], v[210:211], v[208:209] op_sel_hi:[1,0,0] neg_lo:[0,0,1] neg_hi:[0,0,1]
  v_pk_fma_f32 v[172:173], v[172:173], v[210:211], v[208:209] op_sel_hi:[1,0,0] neg_lo:[0,0,1] neg_hi:[0,0,1]
  v_pk_fma_f32 v[174:175], v[174:175], v[210:211], v[208:209] op_sel_hi:[1,0,0] neg_lo:[0,0,1] neg_hi:[0,0,1]
  v_mfma_f32_16x16x32_bf16 v[160:163], v[242:245], v[32:35], 0
  s_mul_i32 s54, s67, 4608
  v_cvt_pk_bf16_f32 v28, v168, v169
  v_cvt_pk_bf16_f32 v29, v170, v171
  v_mfma_f32_16x16x32_bf16 v[164:167], v[240:243], v[32:35], 0
  s_add_u32 s55, s54, 294912
  v_cvt_pk_bf16_f32 v30, v172, v173
  v_cvt_pk_bf16_f32 v31, v174, v175
  s_waitcnt vmcnt(8)
  v_mfma_f32_16x16x32_bf16 v[236:239], v[232:235], v[100:103], v[236:239]
  ds_read_b128 a[96:99], v226 offset:12288
  ds_read_b128 a[112:115], v227 offset:12288
  ds_write_b128 v225, v[28:31] offset:12288
  buffer_load_dwordx4 v[144:147], v13, s[4:7], s65 offen
  s_nop 0
  v_pk_fma_f32 v[160:161], v[160:161], v[210:211], v[208:209] op_sel_hi:[1,0,0] neg_lo:[0,0,1] neg_hi:[0,0,1]
  v_pk_fma_f32 v[162:163], v[162:163], v[210:211], v[208:209] op_sel_hi:[1,0,0] neg_lo:[0,0,1] neg_hi:[0,0,1]
  v_pk_fma_f32 v[164:165], v[164:165], v[210:211], v[208:209] op_sel_hi:[1,0,0] neg_lo:[0,0,1] neg_hi:[0,0,1]
  v_pk_fma_f32 v[166:167], v[166:167], v[210:211], v[208:209] op_sel_hi:[1,0,0] neg_lo:[0,0,1] neg_hi:[0,0,1]
  v_mfma_f32_16x16x32_bf16 v[168:171], v[242:245], v[36:39], 0
  s_mul_i32 s56, s88, 4608
  v_cvt_pk_bf16_f32 v32, v160, v161
  v_cvt_pk_bf16_f32 v33, v162, v163
  v_mfma_f32_16x16x32_bf16 v[172:175], v[240:243], v[36:39], 0
  s_add_u32 s57, s56, 294912
  v_cvt_pk_bf16_f32 v34, v164, v165
  v_cvt_pk_bf16_f32 v35, v166, v167
  v_mfma_f32_16x16x32_bf16 v[236:239], v[232:235], v[104:107], v[236:239]
  ds_read_b128 a[128:131], v226 offset:16384
  ds_read_b128 a[144:147], v227 offset:16384
  ds_write_b128 v225, v[32:35] offset:16384
  buffer_load_dwordx4 v[148:151], v13, s[4:7], s66 offen
  v_pk_fma_f32 v[168:169], v[168:169], v[210:211], v[208:209] op_sel_hi:[1,0,0] neg_lo:[0,0,1] neg_hi:[0,0,1]
  v_pk_fma_f32 v[170:171], v[170:171], v[210:211], v[208:209] op_sel_hi:[1,0,0] neg_lo:[0,0,1] neg_hi:[0,0,1]
  v_pk_fma_f32 v[172:173], v[172:173], v[210:211], v[208:209] op_sel_hi:[1,0,0] neg_lo:[0,0,1] neg_hi:[0,0,1]
  v_pk_fma_f32 v[174:175], v[174:175], v[210:211], v[208:209] op_sel_hi:[1,0,0] neg_lo:[0,0,1] neg_hi:[0,0,1]
  v_mfma_f32_16x16x32_bf16 v[160:163], v[242:245], v[40:43], 0
  v_cvt_pk_bf16_f32 v36, v168, v169
  v_cvt_pk_bf16_f32 v37, v170, v171
  v_mfma_f32_16x16x32_bf16 v[164:167], v[240:243], v[40:43], 0
  v_cvt_pk_bf16_f32 v38, v172, v173
  v_cvt_pk_bf16_f32 v39, v174, v175
  v_mfma_f32_16x16x32_bf16 v[236:239], v[232:235], v[108:111], v[236:239]
  ds_read_b128 a[160:163], v226 offset:20480
  ds_read_b128 a[176:179], v227 offset:20480
  ds_write_b128 v225, v[36:39] offset:20480
  buffer_load_dwordx4 v[152:155], v13, s[4:7], s67 offen
  v_pk_fma_f32 v[160:161], v[160:161], v[210:211], v[208:209] op_sel_hi:[1,0,0] neg_lo:[0,0,1] neg_hi:[0,0,1]
  v_pk_fma_f32 v[162:163], v[162:163], v[210:211], v[208:209] op_sel_hi:[1,0,0] neg_lo:[0,0,1] neg_hi:[0,0,1]
  v_pk_fma_f32 v[164:165], v[164:165], v[210:211], v[208:209] op_sel_hi:[1,0,0] neg_lo:[0,0,1] neg_hi:[0,0,1]
  v_pk_fma_f32 v[166:167], v[166:167], v[210:211], v[208:209] op_sel_hi:[1,0,0] neg_lo:[0,0,1] neg_hi:[0,0,1]
  v_mfma_f32_16x16x32_bf16 v[168:171], v[242:245], v[44:47], 0
  v_cvt_pk_bf16_f32 v40, v160, v161
  v_cvt_pk_bf16_f32 v41, v162, v163
  v_mfma_f32_16x16x32_bf16 v[172:175], v[240:243], v[44:47], 0
  v_cvt_pk_bf16_f32 v42, v164, v165
  v_cvt_pk_bf16_f32 v43, v166, v167
  s_waitcnt vmcnt(8)
  v_mfma_f32_16x16x32_bf16 v[236:239], v[232:235], v[112:115], v[236:239]
  ds_read_b128 a[192:195], v226 offset:24576
  ds_read_b128 a[208:211], v227 offset:24576
  ds_write_b128 v225, v[40:43] offset:24576
  buffer_load_dwordx4 v[156:159], v13, s[4:7], s88 offen
  s_nop 0
  v_pk_fma_f32 v[168:169], v[168:169], v[210:211], v[208:209] op_sel_hi:[1,0,0] neg_lo:[0,0,1] neg_hi:[0,0,1]
  v_pk_fma_f32 v[170:171], v[170:171], v[210:211], v[208:209] op_sel_hi:[1,0,0] neg_lo:[0,0,1] neg_hi:[0,0,1]
  v_pk_fma_f32 v[172:173], v[172:173], v[210:211], v[208:209] op_sel_hi:[1,0,0] neg_lo:[0,0,1] neg_hi:[0,0,1]
  v_pk_fma_f32 v[174:175], v[174:175], v[210:211], v[208:209] op_sel_hi:[1,0,0] neg_lo:[0,0,1] neg_hi:[0,0,1]
  v_mfma_f32_16x16x32_bf16 v[160:163], v[242:245], v[48:51], 0
  v_cvt_pk_bf16_f32 v44, v168, v169
  v_cvt_pk_bf16_f32 v45, v170, v171
  v_mfma_f32_16x16x32_bf16 v[164:167], v[240:243], v[48:51], 0
  v_cvt_pk_bf16_f32 v46, v172, v173
  v_cvt_pk_bf16_f32 v47, v174, v175
  v_mfma_f32_16x16x32_bf16 v[236:239], v[232:235], v[116:119], v[236:239]
  ds_read_b128 a[224:227], v226 offset:28672
  ds_read_b128 a[240:243], v227 offset:28672
  ds_write_b128 v225, v[44:47] offset:28672
  v_pk_fma_f32 v[160:161], v[160:161], v[210:211], v[208:209] op_sel_hi:[1,0,0] neg_lo:[0,0,1] neg_hi:[0,0,1]
  v_pk_fma_f32 v[162:163], v[162:163], v[210:211], v[208:209] op_sel_hi:[1,0,0] neg_lo:[0,0,1] neg_hi:[0,0,1]
  v_pk_fma_f32 v[164:165], v[164:165], v[210:211], v[208:209] op_sel_hi:[1,0,0] neg_lo:[0,0,1] neg_hi:[0,0,1]
  v_pk_fma_f32 v[166:167], v[166:167], v[210:211], v[208:209] op_sel_hi:[1,0,0] neg_lo:[0,0,1] neg_hi:[0,0,1]
  v_cvt_pk_bf16_f32 v48, v160, v161
  v_cvt_pk_bf16_f32 v49, v162, v163
  v_cvt_pk_bf16_f32 v50, v164, v165
  v_cvt_pk_bf16_f32 v51, v166, v167
  v_mfma_f32_16x16x32_bf16 v[236:239], v[232:235], v[120:123], v[236:239]
  ds_read_b128 v[176:179], v226 offset:32768
  ds_read_b128 v[192:195], v227 offset:32768
  ds_write_b128 v225, v[48:51] offset:32768
  s_add_u32 m0, s28, 0
  v_dot2_f32_bf16 v210, v88, v88, 0
  s_nop 1
  s_nop 0
  v_dot2c_f32_bf16 v210, v89, v89
  v_dot2c_f32_bf16 v210, v90, v90
  v_dot2c_f32_bf16 v210, v91, v91
  v_dot2c_f32_bf16 v210, v92, v92
  v_dot2c_f32_bf16 v210, v93, v93
  v_dot2c_f32_bf16 v210, v94, v94
  v_dot2c_f32_bf16 v210, v95, v95
  v_dot2c_f32_bf16 v210, v96, v96
  v_dot2c_f32_bf16 v210, v97, v97
  v_dot2c_f32_bf16 v210, v98, v98
  v_dot2c_f32_bf16 v210, v99, v99
  buffer_load_dwordx4 v1, s[8:11], s40 offen lds
  v_dot2c_f32_bf16 v210, v100, v100
  v_dot2c_f32_bf16 v210, v101, v101
  v_dot2c_f32_bf16 v210, v102, v102
  v_dot2c_f32_bf16 v210, v103, v103
  v_dot2c_f32_bf16 v210, v104, v104
  v_dot2c_f32_bf16 v210, v105, v105
  v_dot2c_f32_bf16 v210, v106, v106
  v_dot2c_f32_bf16 v210, v107, v107
  v_dot2c_f32_bf16 v210, v108, v108
  v_dot2c_f32_bf16 v210, v109, v109
  v_dot2c_f32_bf16 v210, v110, v110
  v_dot2c_f32_bf16 v210, v111, v111
  buffer_load_dwordx4 v1, s[12:15], s40 offen offset:1024 lds
  v_dot2c_f32_bf16 v210, v112, v112
  v_dot2c_f32_bf16 v210, v113, v113
  v_dot2c_f32_bf16 v210, v114, v114
  v_dot2c_f32_bf16 v210, v115, v115
  v_dot2c_f32_bf16 v210, v116, v116
  v_dot2c_f32_bf16 v210, v117, v117
  v_dot2c_f32_bf16 v210, v118, v118
  v_dot2c_f32_bf16 v210, v119, v119
  v_dot2c_f32_bf16 v210, v120, v120
  v_dot2c_f32_bf16 v210, v121, v121
  v_dot2c_f32_bf16 v210, v122, v122
  v_dot2c_f32_bf16 v210, v123, v123
  s_waitcnt lgkmcnt(0)
  s_cmp_eq_u32 s38, 0
  s_cbranch_scc1 L_ln2a
  s_barrier
L_ln2a:
  v_lshlrev_b32_e64 v160, 16, v88
  v_add_f32_dpp v208, v236, v236 quad_perm:[1,0,3,2] row_mask:0xf bank_mask:0xf
  v_add_f32_dpp v210, v210, v210 quad_perm:[1,0,3,2] row_mask:0xf bank_mask:0xf
  v_and_b32_e64 v161, s3, v88
  v_add_f32_dpp v208, v208, v208 quad_perm:[2,3,0,1] row_mask:0xf bank_mask:0xf
  v_add_f32_dpp v210, v210, v210 quad_perm:[2,3,0,1] row_mask:0xf bank_mask:0xf
  v_lshlrev_b32_e64 v162, 16, v89
  v_add_f32_dpp v208, v208, v208 row_half_mirror row_mask:0xf bank_mask:0xf
  v_add_f32_dpp v210, v210, v210 row_half_mirror row_mask:0xf bank_mask:0xf
  v_mul_f32 v208, 0x3ae38e39, v208
  v_mul_f32 v210, 0x3ae38e39, v210
  v_fma_f32 v210, -v208, v208, v210
  v_max_f32_e64 v210, 0, v210
  s_cbranch_scc0 L_ln2b
  s_barrier
L_ln2b:
  v_cvt_pk_bf16_f32 v208, v210, v208
  v_lshlrev_b32_e64 v210, 16, v208
  v_add_f32 v210, 0x3727c5ac, v210
  v_cvt_pk_bf16_f32 v210, v210, v210
  v_and_b32 v210, s3, v210
  v_sqrt_f32 v210, v210
  v_and_b32_e64 v208, s3, v208
  v_cvt_pk_bf16_f32 v210, v210, v210
  v_and_b32 v210, s3, v210
  v_rcp_f32 v210, v210
  v_and_b32_e64 v163, s3, v89
  v_mul_f32 v210, 0x3eeff558, v210
  v_mul_f32 v208, v208, v210
  v_lshlrev_b32 v164, 16, v90
  v_and_b32 v165, s3, v90
  v_lshlrev_b32 v166, 16, v91
  v_and_b32_e64 v167, s3, v91
  v_pk_fma_f32 v[160:161], v[160:161], v[210:211], v[208:209] op_sel_hi:[1,0,0] neg_lo:[0,0,1] neg_hi:[0,0,1]
  v_pk_fma_f32 v[162:163], v[162:163], v[210:211], v[208:209] op_sel_hi:[1,0,0] neg_lo:[0,0,1] neg_hi:[0,0,1]
  v_pk_fma_f32 v[164:165], v[164:165], v[210:211], v[208:209] op_sel_hi:[1,0,0] neg_lo:[0,0,1] neg_hi:[0,0,1]
  v_pk_fma_f32 v[166:167], v[166:167], v[210:211], v[208:209] op_sel_hi:[1,0,0] neg_lo:[0,0,1] neg_hi:[0,0,1]
  v_mfma_f32_16x16x32_bf16 v[168:171], v[242:245], v[92:95], 0
  v_cvt_pk_bf16_f32 v88, v160, v161
  v_cvt_pk_bf16_f32 v89, v162, v163
  v_mfma_f32_16x16x32_bf16 v[172:175], v[240:243], v[92:95], 0
  v_cvt_pk_bf16_f32 v90, v164, v165
  v_cvt_pk_bf16_f32 v91, v166, v167
  s_waitcnt vmcnt(8)
  v_mfma_f32_16x16x32_bf16 v[236:239], v[232:235], v[124:127], 0
  s_add_u32 m0, s28, 8192
  ds_read_b128 a[4:7], v228 offset:0
  ds_read_b128 a[20:23], v229 offset:0
  ds_read_b64_tr_b16 v[82:83], v14 offset:36864
  s_nop 0
  ds_write_b128 v224, v[88:91] offset:0
  buffer_load_dwordx4 v1, s[8:11], s41 offen lds
  v_pk_fma_f32 v[168:169], v[168:169], v[210:211], v[208:209] op_sel_hi:[1,0,0] neg_lo:[0,0,1] neg_hi:[0,0,1]
  v_pk_fma_f32 v[170:171], v[170:171], v[210:211], v[208:209] op_sel_hi:[1,0,0] neg_lo:[0,0,1] neg_hi:[0,0,1]
  v_pk_fma_f32 v[172:173], v[172:173], v[210:211], v[208:209] op_sel_hi:[1,0,0] neg_lo:[0,0,1] neg_hi:[0,0,1]
  v_pk_fma_f32 v[174:175], v[174:175], v[210:211], v[208:209] op_sel_hi:[1,0,0] neg_lo:[0,0,1] neg_hi:[0,0,1]
  v_mfma_f32_16x16x32_bf16 v[160:163], v[242:245], v[96:99], 0
  v_cvt_pk_bf16_f32 v92, v168, v169
  v_cvt_pk_bf16_f32 v93, v170, v171
  v_mfma_f32_16x16x32_bf16 v[164:167], v[240:243], v[96:99], 0
  v_cvt_pk_bf16_f32 v94, v172, v173
  v_cvt_pk_bf16_f32 v95, v174, v175
  v_mfma_f32_16x16x32_bf16 v[236:239], v[232:235], v[128:131], v[236:239]
  ds_read_b128 a[36:39], v228 offset:4096
  ds_read_b128 a[52:55], v229 offset:4096
  ds_read_b64_tr_b16 v[86:87], v15 offset:36864
  ds_write_b128 v224, v[92:95] offset:4096
  buffer_load_dwordx4 v1, s[12:15], s41 offen offset:1024 lds
  v_pk_fma_f32 v[160:161], v[160:161], v[210:211], v[208:209] op_sel_hi:[1,0,0] neg_lo:[0,0,1] neg_hi:[0,0,1]
  v_pk_fma_f32 v[162:163], v[162:163], v[210:211], v[208:209] op_sel_hi:[1,0,0] neg_lo:[0,0,1] neg_hi:[0,0,1]
  v_pk_fma_f32 v[164:165], v[164:165], v[210:211], v[208:209] op_sel_hi:[1,0,0] neg_lo:[0,0,1] neg_hi:[0,0,1]
  v_pk_fma_f32 v[166:167], v[166:167], v[210:211], v[208:209] op_sel_hi:[1,0,0] neg_lo:[0,0,1] neg_hi:[0,0,1]
  v_mfma_f32_16x16x32_bf16 v[168:171], v[242:245], v[100:103], 0
  v_cvt_pk_bf16_f32 v96, v160, v161
  v_cvt_pk_bf16_f32 v97, v162, v163
  v_mfma_f32_16x16x32_bf16 v[172:175], v[240:243], v[100:103], 0
  v_cvt_pk_bf16_f32 v98, v164, v165
  v_cvt_pk_bf16_f32 v99, v166, v167
  v_mfma_f32_16x16x32_bf16 v[236:239], v[232:235], v[132:135], v[236:239]
  s_add_u32 m0, s28, 16384
  ds_read_b128 a[68:71], v228 offset:8192
  ds_read_b128 a[84:87], v229 offset:8192
  ds_write_b128 v224, v[96:99] offset:8192
  buffer_load_dwordx4 v1, s[8:11], s42 offen lds
  v_pk_fma_f32 v[168:169], v[168:169], v[210:211], v[208:209] op_sel_hi:[1,0,0] neg_lo:[0,0,1] neg_hi:[0,0,1]
  v_pk_fma_f32 v[170:171], v[170:171], v[210:211], v[208:209] op_sel_hi:[1,0,0] neg_lo:[0,0,1] neg_hi:[0,0,1]
  v_pk_fma_f32 v[172:173], v[172:173], v[210:211], v[208:209] op_sel_hi:[1,0,0] neg_lo:[0,0,1] neg_hi:[0,0,1]
  v_pk_fma_f32 v[174:175], v[174:175], v[210:211], v[208:209] op_sel_hi:[1,0,0] neg_lo:[0,0,1] neg_hi:[0,0,1]
  v_mfma_f32_16x16x32_bf16 v[160:163], v[242:245], v[104:107], 0
  v_cvt_pk_bf16_f32 v100, v168, v169
  v_cvt_pk_bf16_f32 v101, v170, v171
  v_mfma_f32_16x16x32_bf16 v[164:167], v[240:243], v[104:107], 0
  v_cvt_pk_bf16_f32 v102, v172, v173
  v_cvt_pk_bf16_f32 v103, v174, v175
  s_waitcnt vmcnt(8)
  v_mfma_f32_16x16x32_bf16 v[236:239], v[232:235], v[136:139], v[236:239]
  ds_read_b128 a[100:103], v228 offset:12288
  ds_read_b128 a[116:119], v229 offset:12288
  ds_write_b128 v224, v[100:103] offset:12288
  buffer_load_dwordx4 v1, s[12:15], s42 offen offset:1024 lds
  s_nop 0
  v_pk_fma_f32 v[160:161], v[160:161], v[210:211], v[208:209] op_sel_hi:[1,0,0] neg_lo:[0,0,1] neg_hi:[0,0,1]
  v_pk_fma_f32 v[162:163], v[162:163], v[210:211], v[208:209] op_sel_hi:[1,0,0] neg_lo:[0,0,1] neg_hi:[0,0,1]
  v_pk_fma_f32 v[164:165], v[164:165], v[210:211], v[208:209] op_sel_hi:[1,0,0] neg_lo:[0,0,1] neg_hi:[0,0,1]
  v_pk_fma_f32 v[166:167], v[166:167], v[210:211], v[208:209] op_sel_hi:[1,0,0] neg_lo:[0,0,1] neg_hi:[0,0,1]
L_pg1:
  s_cbranch_execz L_pg5
  v_mfma_f32_16x16x32_bf16 v[168:171], v[242:245], v[108:111], 0
  v_cvt_pk_bf16_f32 v104, v160, v161
  v_cvt_pk_bf16_f32 v105, v162, v163
  v_mfma_f32_16x16x32_bf16 v[172:175], v[240:243], v[108:111], 0
  v_cvt_pk_bf16_f32 v106, v164, v165
  v_cvt_pk_bf16_f32 v107, v166, v167
  v_mfma_f32_16x16x32_bf16 v[236:239], v[232:235], v[140:143], v[236:239]
  s_add_u32 m0, s28, 24576
  ds_read_b128 a[132:135], v228 offset:16384
  ds_read_b128 a[148:151], v229 offset:16384
  ds_write_b128 v224, v[104:107] offset:16384
  s_nop 0
  buffer_load_dwordx4 v1, s[8:11], s43 offen lds
  v_pk_fma_f32 v[168:169], v[168:169], v[210:211], v[208:209] op_sel_hi:[1,0,0] neg_lo:[0,0,1] neg_hi:[0,0,1]
  v_pk_fma_f32 v[170:171], v[170:171], v[210:211], v[208:209] op_sel_hi:[1,0,0] neg_lo:[0,0,1] neg_hi:[0,0,1]
  v_pk_fma_f32 v[172:173], v[172:173], v[210:211], v[208:209] op_sel_hi:[1,0,0] neg_lo:[0,0,1] neg_hi:[0,0,1]
  v_pk_fma_f32 v[174:175], v[174:175], v[210:211], v[208:209] op_sel_hi:[1,0,0] neg_lo:[0,0,1] neg_hi:[0,0,1]
  v_mfma_f32_16x16x32_bf16 v[160:163], v[242:245], v[112:115], 0
  v_cvt_pk_bf16_f32 v108, v168, v169
  v_cvt_pk_bf16_f32 v109, v170, v171
  v_mfma_f32_16x16x32_bf16 v[164:167], v[240:243], v[112:115], 0
  v_cvt_pk_bf16_f32 v110, v172, v173
  v_cvt_pk_bf16_f32 v111, v174, v175
  v_mfma_f32_16x16x32_bf16 v[236:239], v[232:235], v[144:147], v[236:239]
  ds_read_b128 a[164:167], v228 offset:20480
  ds_read_b128 a[180:183], v229 offset:20480
  ds_write_b128 v224, v[108:111] offset:20480
  buffer_load_dwordx4 v1, s[12:15], s43 offen offset:1024 lds
  v_pk_fma_f32 v[160:161], v[160:161], v[210:211], v[208:209] op_sel_hi:[1,0,0] neg_lo:[0,0,1] neg_hi:[0,0,1]
  v_pk_fma_f32 v[162:163], v[162:163], v[210:211], v[208:209] op_sel_hi:[1,0,0] neg_lo:[0,0,1] neg_hi:[0,0,1]
  v_pk_fma_f32 v[164:165], v[164:165], v[210:211], v[208:209] op_sel_hi:[1,0,0] neg_lo:[0,0,1] neg_hi:[0,0,1]
  v_pk_fma_f32 v[166:167], v[166:167], v[210:211], v[208:209] op_sel_hi:[1,0,0] neg_lo:[0,0,1] neg_hi:[0,0,1]
  v_mfma_f32_16x16x32_bf16 v[168:171], v[242:245], v[116:119], 0
  v_cvt_pk_bf16_f32 v112, v160, v161
  v_cvt_pk_bf16_f32 v113, v162, v163
  v_mfma_f32_16x16x32_bf16 v[172:175], v[240:243], v[116:119], 0
  v_cvt_pk_bf16_f32 v114, v164, v165
  v_cvt_pk_bf16_f32 v115, v166, v167
  s_waitcnt vmcnt(8)
  v_mfma_f32_16x16x32_bf16 v[236:239], v[232:235], v[148:151], v[236:239]
  s_add_u32 m0, s28, 32768
  ds_read_b128 a[196:199], v228 offset:24576
  ds_read_b128 a[212:215], v229 offset:24576
  ds_write_b128 v224, v[112:115] offset:24576
  s_nop 0
  buffer_load_dwordx4 v1, s[8:11], s44 offen lds
  v_pk_fma_f32 v[168:169], v[168:169], v[210:211], v[208:209] op_sel_hi:[1,0,0] neg_lo:[0,0,1] neg_hi:[0,0,1]
  v_pk_fma_f32 v[170:171], v[170:171], v[210:211], v[208:209] op_sel_hi:[1,0,0] neg_lo:[0,0,1] neg_hi:[0,0,1]
  v_pk_fma_f32 v[172:173], v[172:173], v[210:211], v[208:209] op_sel_hi:[1,0,0] neg_lo:[0,0,1] neg_hi:[0,0,1]
  v_pk_fma_f32 v[174:175], v[174:175], v[210:211], v[208:209] op_sel_hi:[1,0,0] neg_lo:[0,0,1] neg_hi:[0,0,1]
  v_mfma_f32_16x16x32_bf16 v[160:163], v[242:245], v[120:123], 0
  v_cvt_pk_bf16_f32 v116, v168, v169
  v_cvt_pk_bf16_f32 v117, v170, v171
  v_mfma_f32_16x16x32_bf16 v[164:167], v[240:243], v[120:123], 0
  v_cvt_pk_bf16_f32 v118, v172, v173
  v_cvt_pk_bf16_f32 v119, v174, v175
  v_mfma_f32_16x16x32_bf16 v[236:239], v[232:235], v[152:155], v[236:239]
  ds_read_b128 a[228:231], v228 offset:28672
  ds_read_b128 a[244:247], v229 offset:28672
  ds_write_b128 v224, v[116:119] offset:28672
  buffer_load_dwordx4 v1, s[12:15], s44 offen offset:1024 lds
  v_pk_fma_f32 v[160:161], v[160:161], v[210:211], v[208:209] op_sel_hi:[1,0,0] neg_lo:[0,0,1] neg_hi:[0,0,1]
  v_pk_fma_f32 v[162:163], v[162:163], v[210:211], v[208:209] op_sel_hi:[1,0,0] neg_lo:[0,0,1] neg_hi:[0,0,1]
  v_pk_fma_f32 v[164:165], v[164:165], v[210:211], v[208:209] op_sel_hi:[1,0,0] neg_lo:[0,0,1] neg_hi:[0,0,1]
  v_pk_fma_f32 v[166:167], v[166:167], v[210:211], v[208:209] op_sel_hi:[1,0,0] neg_lo:[0,0,1] neg_hi:[0,0,1]
  v_cvt_pk_bf16_f32 v120, v160, v161
  v_cvt_pk_bf16_f32 v121, v162, v163
  v_cvt_pk_bf16_f32 v122, v164, v165
  v_cvt_pk_bf16_f32 v123, v166, v167
  v_mfma_f32_16x16x32_bf16 v[236:239], v[232:235], v[156:159], v[236:239]
  ds_read_b128 v[180:183], v228 offset:32768
  ds_read_b128 v[196:199], v229 offset:32768
  ds_write_b128 v224, v[120:123] offset:32768
  v_dot2_f32_bf16 v210, v124, v124, 0
  s_nop 1
  s_nop 0
  v_dot2c_f32_bf16 v210, v125, v125
  v_dot2c_f32_bf16 v210, v126, v126
  v_dot2c_f32_bf16 v210, v127, v127
  v_dot2c_f32_bf16 v210, v128, v128
  v_dot2c_f32_bf16 v210, v129, v129
  v_dot2c_f32_bf16 v210, v130, v130
  v_dot2c_f32_bf16 v210, v131, v131
  v_dot2c_f32_bf16 v210, v132, v132
  v_dot2c_f32_bf16 v210, v133, v133
  v_dot2c_f32_bf16 v210, v134, v134
  v_dot2c_f32_bf16 v210, v135, v135
  v_dot2c_f32_bf16 v210, v136, v136
  v_dot2c_f32_bf16 v210, v137, v137
  v_dot2c_f32_bf16 v210, v138, v138
  v_dot2c_f32_bf16 v210, v139, v139
  v_dot2c_f32_bf16 v210, v140, v140
  v_dot2c_f32_bf16 v210, v141, v141
  v_dot2c_f32_bf16 v210, v142, v142
  v_dot2c_f32_bf16 v210, v143, v143
  v_dot2c_f32_bf16 v210, v144, v144
  v_dot2c_f32_bf16 v210, v145, v145
  v_dot2c_f32_bf16 v210, v146, v146
  v_dot2c_f32_bf16 v210, v147, v147
  v_dot2c_f32_bf16 v210, v148, v148
  v_dot2c_f32_bf16 v210, v149, v149
  v_dot2c_f32_bf16 v210, v150, v150
  v_dot2c_f32_bf16 v210, v151, v151
  v_dot2c_f32_bf16 v210, v152, v152
  v_dot2c_f32_bf16 v210, v153, v153
  v_dot2c_f32_bf16 v210, v154, v154
  v_dot2c_f32_bf16 v210, v155, v155
  v_dot2c_f32_bf16 v210, v156, v156
  v_dot2c_f32_bf16 v210, v157, v157
  v_dot2c_f32_bf16 v210, v158, v158
  v_dot2c_f32_bf16 v210, v159, v159
  s_waitcnt lgkmcnt(0)
  s_cmp_eq_u32 s38, 0
  s_cbranch_scc1 L_ln3a
  s_barrier
L_ln3a:
  v_lshlrev_b32 v160, 16, v124
  v_add_f32_dpp v208, v236, v236 quad_perm:[1,0,3,2] row_mask:0xf bank_mask:0xf
  v_add_f32_dpp v210, v210, v210 quad_perm:[1,0,3,2] row_mask:0xf bank_mask:0xf
  v_and_b32_e64 v161, s3, v124
  v_add_f32_dpp v208, v208, v208 quad_perm:[2,3,0,1] row_mask:0xf bank_mask:0xf
  v_add_f32_dpp v210, v210, v210 quad_perm:[2,3,0,1] row_mask:0xf bank_mask:0xf
  v_lshlrev_b32_e64 v162, 16, v125
  v_add_f32_dpp v208, v208, v208 row_half_mirror row_mask:0xf bank_mask:0xf
  v_add_f32_dpp v210, v210, v210 row_half_mirror row_mask:0xf bank_mask:0xf
  v_mul_f32 v208, 0x3ae38e39, v208
  v_mul_f32 v210, 0x3ae38e39, v210
  v_fma_f32 v210, -v208, v208, v210
  v_max_f32_e64 v210, 0, v210
  s_cbranch_scc0 L_ln3b
  s_barrier
L_ln3b:
  v_cvt_pk_bf16_f32 v208, v210, v208
  v_lshlrev_b32_e64 v210, 16, v208
  v_add_f32 v210, 0x3727c5ac, v210
  v_cvt_pk_bf16_f32 v210, v210, v210
  v_and_b32 v210, s3, v210
  v_sqrt_f32 v210, v210
  v_and_b32_e64 v208, s3, v208
  v_cvt_pk_bf16_f32 v210, v210, v210
  v_and_b32 v210, s3, v210
  v_rcp_f32 v210, v210
  v_and_b32_e64 v163, s3, v125
  v_mul_f32 v210, 0x3eeff558, v210
  v_mul_f32 v208, v208, v210
  v_lshlrev_b32 v164, 16, v126
  v_and_b32 v165, s3, v126
  v_lshlrev_b32 v166, 16, v127
  v_and_b32_e64 v167, s3, v127
  v_pk_fma_f32 v[160:161], v[160:161], v[210:211], v[208:209] op_sel_hi:[1,0,0] neg_lo:[0,0,1] neg_hi:[0,0,1]
  v_pk_fma_f32 v[162:163], v[162:163], v[210:211], v[208:209] op_sel_hi:[1,0,0] neg_lo:[0,0,1] neg_hi:[0,0,1]
  v_pk_fma_f32 v[164:165], v[164:165], v[210:211], v[208:209] op_sel_hi:[1,0,0] neg_lo:[0,0,1] neg_hi:[0,0,1]
  v_pk_fma_f32 v[166:167], v[166:167], v[210:211], v[208:209] op_sel_hi:[1,0,0] neg_lo:[0,0,1] neg_hi:[0,0,1]
  v_cvt_pk_bf16_f32 v124, v160, v161
  v_cvt_pk_bf16_f32 v125, v162, v163
  v_mfma_f32_16x16x32_bf16 v[168:171], v[242:245], v[128:131], 0
  v_cvt_pk_bf16_f32 v126, v164, v165
  v_cvt_pk_bf16_f32 v127, v166, v167
  v_mfma_f32_16x16x32_bf16 v[172:175], v[240:243], v[128:131], 0
  ds_read_b128 a[8:11], v226 offset:0
  ds_read_b128 a[24:27], v227 offset:0
  ds_read_b64_tr_b16 v[88:89], v14 offset:0
  ds_write_b128 v225, v[124:127] offset:0
  s_nop 0
  v_pk_fma_f32 v[168:169], v[168:169], v[210:211], v[208:209] op_sel_hi:[1,0,0] neg_lo:[0,0,1] neg_hi:[0,0,1]
  v_pk_fma_f32 v[170:171], v[170:171], v[210:211], v[208:209] op_sel_hi:[1,0,0] neg_lo:[0,0,1] neg_hi:[0,0,1]
  s_nop 0
  v_pk_fma_f32 v[172:173], v[172:173], v[210:211], v[208:209] op_sel_hi:[1,0,0] neg_lo:[0,0,1] neg_hi:[0,0,1]
  v_pk_fma_f32 v[174:175], v[174:175], v[210:211], v[208:209] op_sel_hi:[1,0,0] neg_lo:[0,0,1] neg_hi:[0,0,1]
  v_cvt_pk_bf16_f32 v128, v168, v169
  v_cvt_pk_bf16_f32 v129, v170, v171
  v_mfma_f32_16x16x32_bf16 v[160:163], v[242:245], v[132:135], 0
  v_cvt_pk_bf16_f32 v130, v172, v173
  v_cvt_pk_bf16_f32 v131, v174, v175
  v_mfma_f32_16x16x32_bf16 v[164:167], v[240:243], v[132:135], 0
  ds_read_b128 a[40:43], v226 offset:4096
  ds_read_b128 a[56:59], v227 offset:4096
  ds_read_b64_tr_b16 v[92:93], v15 offset:0
  ds_write_b128 v225, v[128:131] offset:4096
  s_nop 0
  v_pk_fma_f32 v[160:161], v[160:161], v[210:211], v[208:209] op_sel_hi:[1,0,0] neg_lo:[0,0,1] neg_hi:[0,0,1]
  v_pk_fma_f32 v[162:163], v[162:163], v[210:211], v[208:209] op_sel_hi:[1,0,0] neg_lo:[0,0,1] neg_hi:[0,0,1]
  s_nop 0
  v_pk_fma_f32 v[164:165], v[164:165], v[210:211], v[208:209] op_sel_hi:[1,0,0] neg_lo:[0,0,1] neg_hi:[0,0,1]
  v_pk_fma_f32 v[166:167], v[166:167], v[210:211], v[208:209] op_sel_hi:[1,0,0] neg_lo:[0,0,1] neg_hi:[0,0,1]
  v_cvt_pk_bf16_f32 v132, v160, v161
  v_cvt_pk_bf16_f32 v133, v162, v163
  v_mfma_f32_16x16x32_bf16 v[168:171], v[242:245], v[136:139], 0
  v_cvt_pk_bf16_f32 v134, v164, v165
  v_cvt_pk_bf16_f32 v135, v166, v167
  v_mfma_f32_16x16x32_bf16 v[172:175], v[240:243], v[136:139], 0
  ds_read_b128 a[72:75], v226 offset:8192
  ds_read_b128 a[88:91], v227 offset:8192
  ds_write_b128 v225, v[132:135] offset:8192
  s_nop 1
  v_pk_fma_f32 v[168:169], v[168:169], v[210:211], v[208:209] op_sel_hi:[1,0,0] neg_lo:[0,0,1] neg_hi:[0,0,1]
  v_pk_fma_f32 v[170:171], v[170:171], v[210:211], v[208:209] op_sel_hi:[1,0,0] neg_lo:[0,0,1] neg_hi:[0,0,1]
  s_nop 0
  v_pk_fma_f32 v[172:173], v[172:173], v[210:211], v[208:209] op_sel_hi:[1,0,0] neg_lo:[0,0,1] neg_hi:[0,0,1]
  v_pk_fma_f32 v[174:175], v[174:175], v[210:211], v[208:209] op_sel_hi:[1,0,0] neg_lo:[0,0,1] neg_hi:[0,0,1]
  v_cvt_pk_bf16_f32 v136, v168, v169
  v_cvt_pk_bf16_f32 v137, v170, v171
  v_mfma_f32_16x16x32_bf16 v[160:163], v[242:245], v[140:143], 0
  v_cvt_pk_bf16_f32 v138, v172, v173
  v_cvt_pk_bf16_f32 v139, v174, v175
  v_mfma_f32_16x16x32_bf16 v[164:167], v[240:243], v[140:143], 0
  ds_read_b128 a[104:107], v226 offset:12288
  ds_read_b128 a[120:123], v227 offset:12288
  ds_write_b128 v225, v[136:139] offset:12288
  s_nop 1
  v_pk_fma_f32 v[160:161], v[160:161], v[210:211], v[208:209] op_sel_hi:[1,0,0] neg_lo:[0,0,1] neg_hi:[0,0,1]
  v_pk_fma_f32 v[162:163], v[162:163], v[210:211], v[208:209] op_sel_hi:[1,0,0] neg_lo:[0,0,1] neg_hi:[0,0,1]
  s_nop 0
  v_pk_fma_f32 v[164:165], v[164:165], v[210:211], v[208:209] op_sel_hi:[1,0,0] neg_lo:[0,0,1] neg_hi:[0,0,1]
  v_pk_fma_f32 v[166:167], v[166:167], v[210:211], v[208:209] op_sel_hi:[1,0,0] neg_lo:[0,0,1] neg_hi:[0,0,1]
  v_cvt_pk_bf16_f32 v140, v160, v161
  v_cvt_pk_bf16_f32 v141, v162, v163
  v_mfma_f32_16x16x32_bf16 v[168:171], v[242:245], v[144:147], 0
  v_cvt_pk_bf16_f32 v142, v164, v165
  v_cvt_pk_bf16_f32 v143, v166, v167
  v_mfma_f32_16x16x32_bf16 v[172:175], v[240:243], v[144:147], 0
  ds_read_b128 a[136:139], v226 offset:16384
  ds_read_b128 a[152:155], v227 offset:16384
  ds_write_b128 v225, v[140:143] offset:16384
  s_nop 1
  v_pk_fma_f32 v[168:169], v[168:169], v[210:211], v[208:209] op_sel_hi:[1,0,0] neg_lo:[0,0,1] neg_hi:[0,0,1]
  v_pk_fma_f32 v[170:171], v[170:171], v[210:211], v[208:209] op_sel_hi:[1,0,0] neg_lo:[0,0,1] neg_hi:[0,0,1]
  s_nop 0
  v_pk_fma_f32 v[172:173], v[172:173], v[210:211], v[208:209] op_sel_hi:[1,0,0] neg_lo:[0,0,1] neg_hi:[0,0,1]
  v_pk_fma_f32 v[174:175], v[174:175], v[210:211], v[208:209] op_sel_hi:[1,0,0] neg_lo:[0,0,1] neg_hi:[0,0,1]
  v_cvt_pk_bf16_f32 v144, v168, v169
  v_cvt_pk_bf16_f32 v145, v170, v171
  v_mfma_f32_16x16x32_bf16 v[160:163], v[242:245], v[148:151], 0
  v_cvt_pk_bf16_f32 v146, v172, v173
  v_cvt_pk_bf16_f32 v147, v174, v175
  v_mfma_f32_16x16x32_bf16 v[164:167], v[240:243], v[148:151], 0
  ds_read_b128 a[168:171], v226 offset:20480
  ds_read_b128 a[184:187], v227 offset:20480
  ds_write_b128 v225, v[144:147] offset:20480
  s_nop 1
  v_pk_fma_f32 v[160:161], v[160:161], v[210:211], v[208:209] op_sel_hi:[1,0,0] neg_lo:[0,0,1] neg_hi:[0,0,1]
  v_pk_fma_f32 v[162:163], v[162:163], v[210:211], v[208:209] op_sel_hi:[1,0,0] neg_lo:[0,0,1] neg_hi:[0,0,1]
  s_nop 0
  v_pk_fma_f32 v[164:165], v[164:165], v[210:211], v[208:209] op_sel_hi:[1,0,0] neg_lo:[0,0,1] neg_hi:[0,0,1]
  v_pk_fma_f32 v[166:167], v[166:167], v[210:211], v[208:209] op_sel_hi:[1,0,0] neg_lo:[0,0,1] neg_hi:[0,0,1]
  v_cvt_pk_bf16_f32 v148, v160, v161
  v_cvt_pk_bf16_f32 v149, v162, v163
  v_mfma_f32_16x16x32_bf16 v[168:171], v[242:245], v[152:155], 0
  v_cvt_pk_bf16_f32 v150, v164, v165
  v_cvt_pk_bf16_f32 v151, v166, v167
  v_mfma_f32_16x16x32_bf16 v[172:175], v[240:243], v[152:155], 0
  ds_read_b128 a[200:203], v226 offset:24576
  ds_read_b128 a[216:219], v227 offset:24576
  ds_write_b128 v225, v[148:151] offset:24576
  s_nop 1
  v_pk_fma_f32 v[168:169], v[168:169], v[210:211], v[208:209] op_sel_hi:[1,0,0] neg_lo:[0,0,1] neg_hi:[0,0,1]
  v_pk_fma_f32 v[170:171], v[170:171], v[210:211], v[208:209] op_sel_hi:[1,0,0] neg_lo:[0,0,1] neg_hi:[0,0,1]
  s_nop 0
  v_pk_fma_f32 v[172:173], v[172:173], v[210:211], v[208:209] op_sel_hi:[1,0,0] neg_lo:[0,0,1] neg_hi:[0,0,1]
  v_pk_fma_f32 v[174:175], v[174:175], v[210:211], v[208:209] op_sel_hi:[1,0,0] neg_lo:[0,0,1] neg_hi:[0,0,1]
  v_cvt_pk_bf16_f32 v152, v168, v169
  v_cvt_pk_bf16_f32 v153, v170, v171
  v_mfma_f32_16x16x32_bf16 v[160:163], v[242:245], v[156:159], 0
  v_cvt_pk_bf16_f32 v154, v172, v173
  v_cvt_pk_bf16_f32 v155, v174, v175
  v_mfma_f32_16x16x32_bf16 v[164:167], v[240:243], v[156:159], 0
  ds_read_b128 a[232:235], v226 offset:28672
  ds_read_b128 a[248:251], v227 offset:28672
  ds_write_b128 v225, v[152:155] offset:28672
  s_nop 1
  v_pk_fma_f32 v[160:161], v[160:161], v[210:211], v[208:209] op_sel_hi:[1,0,0] neg_lo:[0,0,1] neg_hi:[0,0,1]
  v_pk_fma_f32 v[162:163], v[162:163], v[210:211], v[208:209] op_sel_hi:[1,0,0] neg_lo:[0,0,1] neg_hi:[0,0,1]
  s_nop 0
  v_pk_fma_f32 v[164:165], v[164:165], v[210:211], v[208:209] op_sel_hi:[1,0,0] neg_lo:[0,0,1] neg_hi:[0,0,1]
  v_pk_fma_f32 v[166:167], v[166:167], v[210:211], v[208:209] op_sel_hi:[1,0,0] neg_lo:[0,0,1] neg_hi:[0,0,1]
  v_cvt_pk_bf16_f32 v156, v160, v161
  v_cvt_pk_bf16_f32 v157, v162, v163
  v_cvt_pk_bf16_f32 v158, v164, v165
  v_cvt_pk_bf16_f32 v159, v166, v167
  ds_read_b128 v[184:187], v226 offset:32768
  ds_read_b128 v[200:203], v227 offset:32768
  ds_write_b128 v225, v[156:159] offset:32768
  s_waitcnt vmcnt(2) lgkmcnt(0)
  s_barrier
  s_add_u32 m0, s28, 40960
  ds_read_b64_tr_b16 v[144:145], v2 offset:0
  ds_read_b64_tr_b16 v[146:147], v2 offset:512
  ds_read_b64_tr_b16 v[160:161], v2 offset:8192
  ds_read_b64_tr_b16 v[162:163], v2 offset:8704
  ds_read_b128 a[12:15], v228 offset:0
  ds_read_b128 a[28:31], v229 offset:0
  ds_read_b64_tr_b16 v[148:149], v2 offset:1024
  ds_read_b64_tr_b16 v[150:151], v2 offset:1536
  ds_read_b64_tr_b16 v[164:165], v2 offset:9216
  ds_read_b64_tr_b16 v[166:167], v2 offset:9728
  buffer_load_dwordx4 v1, s[8:11], s45 offen lds
  buffer_load_dwordx4 v1, s[12:15], s45 offen offset:1024 lds
  s_waitcnt lgkmcnt(4)
  v_mfma_f32_16x16x32_bf16 v[16:19], v[144:147], a[0:3], 0
  s_mov_b32 s76, s94
  ds_read_b64_tr_b16 v[90:91], v14 offset:36864
  ds_read_b64_tr_b16 v[94:95], v15 offset:36864
  v_mfma_f32_16x16x32_bf16 v[16:19], v[160:163], a[16:19], v[16:19]
  s_mov_b32 s77, s95
  ds_read_b64_tr_b16 v[152:153], v3 offset:0
  s_mov_b32 s20, s94
  v_mfma_f32_16x16x32_bf16 v[20:23], v[160:163], a[20:23], 0
  s_add_u32 m0, s28, 49152
  ds_read_b64_tr_b16 v[154:155], v3 offset:512
  s_mov_b32 s21, s95
  v_mfma_f32_16x16x32_bf16 v[20:23], v[144:147], a[4:7], v[20:23]
  buffer_load_dwordx4 v1, s[8:11], s46 offen lds
  v_mfma_f32_16x16x32_bf16 v[24:27], v[144:147], a[8:11], 0
  s_mov_b32 s22, 67108864
  ds_read_b64_tr_b16 v[168:169], v3 offset:8192
  s_mov_b32 s23, 0x20000
  v_mfma_f32_16x16x32_bf16 v[24:27], v[160:163], a[24:27], v[24:27]
  ds_read_b64_tr_b16 v[170:171], v3 offset:8704
  v_lshlrev_b32 v9, 4, v0
  v_mfma_f32_16x16x32_bf16 v[28:31], v[160:163], a[28:31], 0
  buffer_load_dwordx4 v1, s[12:15], s46 offen offset:1024 lds
  v_mfma_f32_16x16x32_bf16 v[28:31], v[144:147], a[12:15], v[28:31]
  s_waitcnt lgkmcnt(6)
  ds_read_b128 a[44:47], v228 offset:4096
  ds_read_b128 a[60:63], v229 offset:4096
  v_mfma_f32_16x16x32_bf16 v[44:47], v[148:151], a[12:15], 0
  s_movk_i32 s33, 128
  ds_read_b64_tr_b16 v[156:157], v3 offset:1024
  v_mfma_f32_16x16x32_bf16 v[44:47], v[164:167], a[28:31], v[44:47]
  s_add_u32 m0, s28, 57344
  ds_read_b64_tr_b16 v[158:159], v3 offset:1536
  s_cmp_eq_u32 s82, 3
  v_mfma_f32_16x16x32_bf16 v[40:43], v[164:167], a[24:27], 0
  buffer_load_dwordx4 v1, s[8:11], s47 offen lds
  v_mfma_f32_16x16x32_bf16 v[40:43], v[148:151], a[8:11], v[40:43]
  s_cselect_b32 s34, s33, 2147483632
  ds_read_b128 a[76:79], v228 offset:8192
  ds_read_b128 a[92:95], v229 offset:8192
  v_mfma_f32_16x16x32_bf16 v[36:39], v[148:151], a[4:7], 0
  s_cselect_b32 s31, 2304, s33
  ds_read_b64_tr_b16 v[172:173], v3 offset:9216
  s_cselect_b32 s88, s33, 256
  v_mfma_f32_16x16x32_bf16 v[36:39], v[164:167], a[20:23], v[36:39]
  s_cselect_b32 s35, 5, 3
  ds_read_b64_tr_b16 v[174:175], v3 offset:9728
  s_lshl_b32 s26, s25, 2
  v_mfma_f32_16x16x32_bf16 v[32:35], v[164:167], a[16:19], 0
  buffer_load_dwordx4 v1, s[12:15], s47 offen offset:1024 lds
  v_mfma_f32_16x16x32_bf16 v[32:35], v[148:151], a[0:3], v[32:35]
  s_waitcnt lgkmcnt(8)
  ds_read_b128 a[108:111], v228 offset:12288
  ds_read_b128 a[124:127], v229 offset:12288
  v_mfma_f32_16x16x32_bf16 v[48:51], v[152:155], a[0:3], 0
  s_add_u32 s26, s26, s81
  ds_read_b128 a[140:143], v228 offset:16384
  ds_read_b128 a[156:159], v229 offset:16384
  v_mfma_f32_16x16x32_bf16 v[48:51], v[168:171], a[16:19], v[48:51]
  s_and_b32 s33, s26, s91
  ds_read_b64_tr_b16 v[144:145], v2 offset:16384
  s_lshl_b32 s33, s33, 7
  v_mfma_f32_16x16x32_bf16 v[52:55], v[168:171], a[20:23], 0
  s_add_u32 s90, s33, 54525952
  ds_read_b64_tr_b16 v[146:147], v2 offset:16896
  s_lshl_b32 s33, s82, 2
  v_mfma_f32_16x16x32_bf16 v[52:55], v[152:155], a[4:7], v[52:55]
  s_add_u32 s36, s90, s33
  ds_read_b128 a[172:175], v228 offset:20480
  ds_read_b128 a[188:191], v229 offset:20480
  v_mfma_f32_16x16x32_bf16 v[56:59], v[152:155], a[8:11], 0
  ds_read_b64_tr_b16 v[160:161], v2 offset:24576
  v_mov_b32 v216, 2147483632
  v_mfma_f32_16x16x32_bf16 v[56:59], v[168:171], a[24:27], v[56:59]
  s_add_u32 m0, s28, 65536
  ds_read_b64_tr_b16 v[162:163], v2 offset:25088
  v_mov_b32 v219, 0
  v_mfma_f32_16x16x32_bf16 v[60:63], v[168:171], a[28:31], 0
  buffer_load_dwordx4 v1, s[8:11], s48 offen lds
  v_mfma_f32_16x16x32_bf16 v[60:63], v[152:155], a[12:15], v[60:63]
  s_waitcnt lgkmcnt(10)
  ds_read_b128 a[204:207], v228 offset:24576
  ds_read_b128 a[220:223], v229 offset:24576
  v_mfma_f32_16x16x32_bf16 v[76:79], v[156:159], a[12:15], 0
  s_cmp_eq_u32 s24, 0
  ds_read_b64_tr_b16 v[148:149], v2 offset:17408
  s_cselect_b32 s33, 0, 2147483632
  v_mfma_f32_16x16x32_bf16 v[76:79], v[172:175], a[28:31], v[76:79]
  s_cselect_b32 s34, s34, 2147483632
  ds_read_b64_tr_b16 v[150:151], v2 offset:17920
  v_writelane_b32 v216, s33, 0
  v_mfma_f32_16x16x32_bf16 v[72:75], v[172:175], a[24:27], 0
  ds_read_b128 a[236:239], v228 offset:28672
  ds_read_b128 a[252:255], v229 offset:28672
  v_mfma_f32_16x16x32_bf16 v[72:75], v[156:159], a[8:11], v[72:75]
  ds_read_b128 v[188:191], v228 offset:32768
  ds_read_b128 v[204:207], v229 offset:32768
  v_mfma_f32_16x16x32_bf16 v[68:71], v[156:159], a[4:7], 0
  ds_read_b64_tr_b16 v[164:165], v2 offset:25600
  v_writelane_b32 v216, s34, 1
  v_mfma_f32_16x16x32_bf16 v[68:71], v[172:175], a[20:23], v[68:71]
  s_mul_i32 s30, s25, 1179648
  ds_read_b64_tr_b16 v[166:167], v2 offset:26112
  s_lshl_b32 s34, s37, 11
  v_mfma_f32_16x16x32_bf16 v[64:67], v[172:175], a[16:19], 0
  buffer_load_dwordx4 v1, s[12:15], s48 offen offset:1024 lds
  v_mfma_f32_16x16x32_bf16 v[64:67], v[156:159], a[0:3], v[64:67]
  s_waitcnt lgkmcnt(10)
  s_add_u32 s37, s30, s34
  s_add_u32 s30, s36, 0x8000
  v_mfma_f32_16x16x32_bf16 v[16:19], v[144:147], a[32:35], v[16:19]
  s_mov_b32 s4, s92
  s_mov_b32 s5, s93
  s_cmp_eq_u32 s24, 0
  v_mfma_f32_16x16x32_bf16 v[16:19], v[160:163], a[48:51], v[16:19]
  s_cselect_b32 s6, 256, 0
  ds_read_b64_tr_b16 v[152:153], v3 offset:16384
  s_cselect_b32 s34, 4, 0
  v_mfma_f32_16x16x32_bf16 v[20:23], v[160:163], a[52:55], v[20:23]
  s_add_u32 m0, s28, 73728
  ds_read_b64_tr_b16 v[154:155], v3 offset:16896
  v_lshlrev_b32 v220, 5, v11
  v_mfma_f32_16x16x32_bf16 v[20:23], v[144:147], a[36:39], v[20:23]
  buffer_load_dwordx4 v1, s[8:11], s49 offen lds
  v_mfma_f32_16x16x32_bf16 v[24:27], v[144:147], a[40:43], v[24:27]
  ds_read_b64_tr_b16 v[168:169], v3 offset:24576
  v_mov_b32_e64 v223, s34
  v_mfma_f32_16x16x32_bf16 v[24:27], v[160:163], a[56:59], v[24:27]
  ds_read_b64_tr_b16 v[170:171], v3 offset:25088
  v_mfma_f32_16x16x32_bf16 v[28:31], v[160:163], a[60:63], v[28:31]
  buffer_load_dwordx4 v1, s[12:15], s49 offen offset:1024 lds
  v_mfma_f32_16x16x32_bf16 v[28:31], v[144:147], a[44:47], v[28:31]
  s_waitcnt lgkmcnt(4)
  v_mfma_f32_16x16x32_bf16 v[44:47], v[148:151], a[44:47], v[44:47]
  ds_read_b64_tr_b16 v[156:157], v3 offset:17408
  v_add_u32 v4, 0x10000, v2
  v_mfma_f32_16x16x32_bf16 v[44:47], v[164:167], a[60:63], v[44:47]
  s_add_u32 m0, s28, 81920
  ds_read_b64_tr_b16 v[158:159], v3 offset:17920
  v_add_u32 v5, 0x10000, v3
  v_mfma_f32_16x16x32_bf16 v[40:43], v[164:167], a[56:59], v[40:43]
  buffer_load_dwordx4 v1, s[8:11], s50 offen lds
  v_mfma_f32_16x16x32_bf16 v[40:43], v[148:151], a[40:43], v[40:43]
  s_lshl_b32 s33, s24, 12
  s_add_u32 s33, s33, 147456
  s_lshl_b32 s34, s38, 10
  v_mfma_f32_16x16x32_bf16 v[36:39], v[148:151], a[36:39], v[36:39]
  s_add_u32 s34, s34, 2048
  ds_read_b64_tr_b16 v[172:173], v3 offset:25600
  v_and_b32 v96, 15, v0
  v_mfma_f32_16x16x32_bf16 v[36:39], v[164:167], a[52:55], v[36:39]
  ds_read_b64_tr_b16 v[174:175], v3 offset:26112
  v_lshl_add_u32 v96, v96, 7, s33
  v_mfma_f32_16x16x32_bf16 v[32:35], v[164:167], a[48:51], v[32:35]
  buffer_load_dwordx4 v1, s[12:15], s50 offen offset:1024 lds
  v_mfma_f32_16x16x32_bf16 v[32:35], v[148:151], a[32:35], v[32:35]
  s_waitcnt vmcnt(6) lgkmcnt(4)
  v_bfe_u32 v97, v0, 4, 1
  v_lshrrev_b32 v98, 5, v0
  v_mfma_f32_16x16x32_bf16 v[48:51], v[152:155], a[32:35], v[48:51]
  s_barrier
  v_mfma_f32_16x16x32_bf16 v[48:51], v[168:171], a[48:51], v[48:51]
  ds_read_b64_tr_b16 v[144:145], v2 offset:32768
  v_xor_b32 v97, s83, v97
  v_mfma_f32_16x16x32_bf16 v[52:55], v[168:171], a[52:55], v[52:55]
  ds_read_b64_tr_b16 v[146:147], v2 offset:33280
  v_lshl_or_b32 v97, v97, 1, v98
  v_mfma_f32_16x16x32_bf16 v[52:55], v[152:155], a[36:39], v[52:55]
  v_xor_b32_e64 v97, v97, v11
  v_lshl_add_u32 v96, v97, 4, v96
  v_mfma_f32_16x16x32_bf16 v[56:59], v[152:155], a[40:43], v[56:59]
  ds_read_b64_tr_b16 v[160:161], v2 offset:40960
  v_xor_b32_e64 v97, 64, v96
  v_mfma_f32_16x16x32_bf16 v[56:59], v[168:171], a[56:59], v[56:59]
  s_add_u32 m0, s28, 90112
  ds_read_b64_tr_b16 v[162:163], v2 offset:41472
  v_xor_b32_e64 v100, v10, v11
  v_mfma_f32_16x16x32_bf16 v[60:63], v[168:171], a[60:63], v[60:63]
  buffer_load_dwordx4 v1, s[8:11], s51 offen lds
  v_mfma_f32_16x16x32_bf16 v[60:63], v[152:155], a[44:47], v[60:63]
  s_waitcnt lgkmcnt(4)
  v_lshlrev_b32 v100, 4, v100
  v_lshl_add_u32 v100, v10, 7, v100
  v_mfma_f32_16x16x32_bf16 v[76:79], v[156:159], a[44:47], v[76:79]
  ds_read_b64_tr_b16 v[148:149], v2 offset:33792
  v_add_u32_e64 v100, s33, v100
  v_mfma_f32_16x16x32_bf16 v[76:79], v[172:175], a[60:63], v[76:79]
  ds_read_b64_tr_b16 v[150:151], v2 offset:34304
  v_add_u32_e64 v101, s34, v100
  v_mfma_f32_16x16x32_bf16 v[72:75], v[172:175], a[56:59], v[72:75]
  v_permlane16_swap_b32 v80, v82
  v_permlane16_swap_b32 v81, v83
  v_mfma_f32_16x16x32_bf16 v[72:75], v[156:159], a[40:43], v[72:75]
  ds_write_b128 v96, v[80:83] offset:0
  v_mfma_f32_16x16x32_bf16 v[68:71], v[156:159], a[36:39], v[68:71]
  ds_read_b64_tr_b16 v[164:165], v2 offset:41984
  v_permlane16_swap_b32 v84, v86
  v_mfma_f32_16x16x32_bf16 v[68:71], v[172:175], a[52:55], v[68:71]
  ds_read_b64_tr_b16 v[166:167], v2 offset:42496
  v_permlane16_swap_b32 v85, v87
  v_mfma_f32_16x16x32_bf16 v[64:67], v[172:175], a[48:51], v[64:67]
  buffer_load_dwordx4 v1, s[12:15], s51 offen offset:1024 lds
  v_mfma_f32_16x16x32_bf16 v[64:67], v[156:159], a[32:35], v[64:67]
  s_waitcnt lgkmcnt(4)
  ds_write_b128 v96, v[84:87] offset:2048
  v_mfma_f32_16x16x32_bf16 v[16:19], v[144:147], a[64:67], v[16:19]
  v_permlane16_swap_b32 v88, v90
  v_permlane16_swap_b32 v89, v91
  v_mfma_f32_16x16x32_bf16 v[16:19], v[160:163], a[80:83], v[16:19]
  ds_read_b64_tr_b16 v[152:153], v3 offset:32768
  v_mfma_f32_16x16x32_bf16 v[20:23], v[160:163], a[84:87], v[20:23]
  s_add_u32 m0, s28, 98304
  ds_read_b64_tr_b16 v[154:155], v3 offset:33280
  v_mfma_f32_16x16x32_bf16 v[20:23], v[144:147], a[68:71], v[20:23]
  buffer_load_dwordx4 v1, s[8:11], s52 offen lds
  v_mfma_f32_16x16x32_bf16 v[24:27], v[144:147], a[72:75], v[24:27]
  ds_read_b64_tr_b16 v[168:169], v3 offset:40960
  v_mfma_f32_16x16x32_bf16 v[24:27], v[160:163], a[88:91], v[24:27]
  ds_read_b64_tr_b16 v[170:171], v3 offset:41472
  v_mfma_f32_16x16x32_bf16 v[28:31], v[160:163], a[92:95], v[28:31]
  buffer_load_dwordx4 v1, s[12:15], s52 offen offset:1024 lds
  v_mfma_f32_16x16x32_bf16 v[28:31], v[144:147], a[76:79], v[28:31]
  s_waitcnt lgkmcnt(4)
  ds_write_b128 v97, v[88:91] offset:0
  v_mfma_f32_16x16x32_bf16 v[44:47], v[148:151], a[76:79], v[44:47]
  ds_read_b64_tr_b16 v[156:157], v3 offset:33792
  v_permlane16_swap_b32 v92, v94
  v_mfma_f32_16x16x32_bf16 v[44:47], v[164:167], a[92:95], v[44:47]
  s_add_u32 m0, s28, 106496
  ds_read_b64_tr_b16 v[158:159], v3 offset:34304
  v_permlane16_swap_b32 v93, v95
  v_mfma_f32_16x16x32_bf16 v[40:43], v[164:167], a[88:91], v[40:43]
  buffer_load_dwordx4 v1, s[8:11], s53 offen lds
  v_mfma_f32_16x16x32_bf16 v[40:43], v[148:151], a[72:75], v[40:43]
  ds_write_b128 v97, v[92:95] offset:2048
  v_mfma_f32_16x16x32_bf16 v[36:39], v[148:151], a[68:71], v[36:39]
  ds_read_b64_tr_b16 v[172:173], v3 offset:41984
  ds_read_b128 v[104:107], v100
  v_mfma_f32_16x16x32_bf16 v[36:39], v[164:167], a[84:87], v[36:39]
  ds_read_b64_tr_b16 v[174:175], v3 offset:42496
  ds_read_b128 v[108:111], v100 offset:1024
  v_mfma_f32_16x16x32_bf16 v[32:35], v[164:167], a[80:83], v[32:35]
  buffer_load_dwordx4 v1, s[12:15], s53 offen offset:1024 lds
  v_mfma_f32_16x16x32_bf16 v[32:35], v[148:151], a[64:67], v[32:35]
  s_waitcnt lgkmcnt(4)
  ds_read_b128 v[112:115], v101
  s_mul_i32 s33, s25, 147456
  v_mfma_f32_16x16x32_bf16 v[48:51], v[152:155], a[64:67], v[48:51]
  s_lshl_b32 s34, s39, 7
  s_add_u32 s33, s33, s34
  s_add_u32 s33, s33, 20971520
  v_mfma_f32_16x16x32_bf16 v[48:51], v[168:171], a[80:83], v[48:51]
  s_cmp_eq_u32 s82, 3
  ds_read_b64_tr_b16 v[144:145], v2 offset:49152
  s_cselect_b32 s33, 0x7f000000, s33
  v_mfma_f32_16x16x32_bf16 v[52:55], v[168:171], a[84:87], v[52:55]
  s_lshl_b32 s58, s58, 12
  ds_read_b64_tr_b16 v[146:147], v2 offset:49664
  s_lshl_b32 s59, s59, 12
  v_mfma_f32_16x16x32_bf16 v[52:55], v[152:155], a[68:71], v[52:55]
  buffer_load_dword v218, v220, s[4:7], 0 offen sc1
  v_mfma_f32_16x16x32_bf16 v[56:59], v[152:155], a[72:75], v[56:59]
  s_add_u32 s58, s58, s33
  ds_read_b64_tr_b16 v[160:161], v2 offset:57344
  s_add_u32 s59, s59, s33
  v_mfma_f32_16x16x32_bf16 v[56:59], v[168:171], a[88:91], v[56:59]
  s_add_u32 m0, s28, 114688
  ds_read_b64_tr_b16 v[162:163], v2 offset:57856
  s_lshl_b32 s34, s38, 11
  v_mfma_f32_16x16x32_bf16 v[60:63], v[168:171], a[92:95], v[60:63]
  buffer_load_dwordx4 v1, s[8:11], s54 offen lds
  v_mfma_f32_16x16x32_bf16 v[60:63], v[152:155], a[76:79], v[60:63]
  s_waitcnt lgkmcnt(5)
  s_add_u32 s59, s59, s34
  v_lshlrev_b32 v230, 8, v10
  v_mfma_f32_16x16x32_bf16 v[76:79], v[156:159], a[76:79], v[76:79]
  ds_read_b64_tr_b16 v[148:149], v2 offset:50176
  v_lshl_add_u32 v230, v11, 4, v230
  v_mfma_f32_16x16x32_bf16 v[76:79], v[172:175], a[92:95], v[76:79]
  s_waitcnt lgkmcnt(5)
  ds_read_b64_tr_b16 v[150:151], v2 offset:50688
  v_mfma_f32_16x16x32_bf16 v[72:75], v[172:175], a[88:91], v[72:75]
  buffer_store_dwordx4 v[104:107], v230, s[20:23], s58 offen sc1
L_pg2:
  s_cbranch_execz L_pg6
  v_mfma_f32_16x16x32_bf16 v[72:75], v[156:159], a[72:75], v[72:75]
  buffer_store_dwordx4 v[108:111], v230, s[20:23], s58 offen offset:2048 sc1
  v_mfma_f32_16x16x32_bf16 v[68:71], v[156:159], a[68:71], v[68:71]
  s_mov_b32 s89, s37
  ds_read_b64_tr_b16 v[164:165], v2 offset:58368
  v_mfma_f32_16x16x32_bf16 v[68:71], v[172:175], a[84:87], v[68:71]
  ds_read_b64_tr_b16 v[166:167], v2 offset:58880
  v_mfma_f32_16x16x32_bf16 v[64:67], v[172:175], a[80:83], v[64:67]
  buffer_load_dwordx4 v1, s[12:15], s54 offen offset:1024 lds
  v_mfma_f32_16x16x32_bf16 v[64:67], v[156:159], a[64:67], v[64:67]
  s_waitcnt lgkmcnt(4)
  v_mfma_f32_16x16x32_bf16 v[16:19], v[144:147], a[96:99], v[16:19]
  buffer_store_dwordx4 v[112:115], v230, s[20:23], s59 offen sc1
  v_mfma_f32_16x16x32_bf16 v[16:19], v[160:163], a[112:115], v[16:19]
  s_lshl_b32 s60, s25, 3
  ds_read_b64_tr_b16 v[152:153], v3 offset:49152
  v_mfma_f32_16x16x32_bf16 v[20:23], v[160:163], a[116:119], v[20:23]
  s_add_u32 m0, s28, 122880
  ds_read_b64_tr_b16 v[154:155], v3 offset:49664
  v_mfma_f32_16x16x32_bf16 v[20:23], v[144:147], a[100:103], v[20:23]
  buffer_load_dwordx4 v1, s[8:11], s55 offen lds
  v_mfma_f32_16x16x32_bf16 v[24:27], v[144:147], a[104:107], v[24:27]
  s_lshl_b32 s61, s24, 1
  ds_read_b64_tr_b16 v[168:169], v3 offset:57344
  v_mfma_f32_16x16x32_bf16 v[24:27], v[160:163], a[120:123], v[24:27]
  s_add_u32 s60, s60, s61
  ds_read_b64_tr_b16 v[170:171], v3 offset:57856
  v_mfma_f32_16x16x32_bf16 v[28:31], v[160:163], a[124:127], v[28:31]
  buffer_load_dwordx4 v1, s[12:15], s55 offen offset:1024 lds
  v_mfma_f32_16x16x32_bf16 v[28:31], v[144:147], a[108:111], v[28:31]
  s_waitcnt lgkmcnt(4)
  v_mfma_f32_16x16x32_bf16 v[44:47], v[148:151], a[108:111], v[44:47]
  s_mul_i32 s73, s60, 18432
  ds_read_b64_tr_b16 v[156:157], v3 offset:50176
  v_mfma_f32_16x16x32_bf16 v[44:47], v[164:167], a[124:127], v[44:47]
  s_add_u32 m0, s28, 131072
  ds_read_b64_tr_b16 v[158:159], v3 offset:50688
  v_mfma_f32_16x16x32_bf16 v[40:43], v[164:167], a[120:123], v[40:43]
  buffer_load_dwordx4 v1, s[8:11], s56 offen lds
  v_mfma_f32_16x16x32_bf16 v[40:43], v[148:151], a[104:107], v[40:43]
  s_min_u32 s60, s82, 2
  v_mfma_f32_16x16x32_bf16 v[36:39], v[148:151], a[100:103], v[36:39]
  s_mul_i32 s60, s60, 12
  ds_read_b64_tr_b16 v[172:173], v3 offset:58368
  v_mfma_f32_16x16x32_bf16 v[36:39], v[164:167], a[116:119], v[36:39]
  s_add_u32 s60, s60, s81
  ds_read_b64_tr_b16 v[174:175], v3 offset:58880
  v_mfma_f32_16x16x32_bf16 v[32:35], v[164:167], a[112:115], v[32:35]
  buffer_load_dwordx4 v1, s[12:15], s56 offen offset:1024 lds
  v_mfma_f32_16x16x32_bf16 v[32:35], v[148:151], a[96:99], v[32:35]
  s_waitcnt vmcnt(10) lgkmcnt(4)
  v_mfma_f32_16x16x32_bf16 v[48:51], v[152:155], a[96:99], v[48:51]
  s_barrier
  v_mfma_f32_16x16x32_bf16 v[48:51], v[168:171], a[112:115], v[48:51]
  s_lshl_b32 s60, s60, 5
  ds_read_b64_tr_b16 v[144:145], v4 offset:0
  v_mfma_f32_16x16x32_bf16 v[52:55], v[168:171], a[116:119], v[52:55]
  s_add_u32 s73, s73, s60
  ds_read_b64_tr_b16 v[146:147], v4 offset:512
  v_mfma_f32_16x16x32_bf16 v[52:55], v[152:155], a[100:103], v[52:55]
  s_add_u32 s60, s70, s73
  v_mfma_f32_16x16x32_bf16 v[56:59], v[152:155], a[104:107], v[56:59]
  s_addc_u32 s61, s71, 0
  ds_read_b64_tr_b16 v[160:161], v4 offset:8192
  v_and_b32 v12, 31, v0
  v_mfma_f32_16x16x32_bf16 v[56:59], v[168:171], a[120:123], v[56:59]
  s_add_u32 m0, s28, 139264
  ds_read_b64_tr_b16 v[162:163], v4 offset:8704
  v_mul_u32_u24 v12, 1152, v12
  v_mfma_f32_16x16x32_bf16 v[60:63], v[168:171], a[124:127], v[60:63]
  buffer_load_dwordx4 v1, s[8:11], s57 offen lds
  v_mfma_f32_16x16x32_bf16 v[60:63], v[152:155], a[108:111], v[60:63]
  s_waitcnt lgkmcnt(4)
  v_lshrrev_b32 v13, 5, v0
  v_lshl_add_u32 v12, v13, 4, v12
  v_mfma_f32_16x16x32_bf16 v[76:79], v[156:159], a[108:111], v[76:79]
  s_lshl_b32 s62, s24, 12
  ds_read_b64_tr_b16 v[148:149], v4 offset:1024
  v_mfma_f32_16x16x32_bf16 v[76:79], v[172:175], a[124:127], v[76:79]
  ds_read_b64_tr_b16 v[150:151], v4 offset:1536
  v_mfma_f32_16x16x32_bf16 v[72:75], v[172:175], a[120:123], v[72:75]
  v_mfma_f32_16x16x32_bf16 v[72:75], v[156:159], a[104:107], v[72:75]
  v_mfma_f32_16x16x32_bf16 v[68:71], v[156:159], a[100:103], v[68:71]
  ds_read_b64_tr_b16 v[164:165], v4 offset:9216
  v_mfma_f32_16x16x32_bf16 v[68:71], v[172:175], a[116:119], v[68:71]
  ds_read_b64_tr_b16 v[166:167], v4 offset:9728
  v_mfma_f32_16x16x32_bf16 v[64:67], v[172:175], a[112:115], v[64:67]
  buffer_load_dwordx4 v1, s[12:15], s57 offen offset:1024 lds
  v_mfma_f32_16x16x32_bf16 v[64:67], v[156:159], a[96:99], v[64:67]
  s_waitcnt lgkmcnt(4)
  v_mfma_f32_16x16x32_bf16 v[16:19], v[144:147], a[128:131], v[16:19]
  v_mfma_f32_16x16x32_bf16 v[16:19], v[160:163], a[144:147], v[16:19]
  ds_read_b64_tr_b16 v[152:153], v5 offset:0
  v_mfma_f32_16x16x32_bf16 v[20:23], v[160:163], a[148:151], v[20:23]
  s_add_u32 m0, s28, 0
  ds_read_b64_tr_b16 v[154:155], v5 offset:512
  v_add_u32 v1, s31, v1
  v_mfma_f32_16x16x32_bf16 v[20:23], v[144:147], a[132:135], v[20:23]
  buffer_load_dwordx4 v1, s[8:11], s40 offen lds
  v_mfma_f32_16x16x32_bf16 v[24:27], v[144:147], a[136:139], v[24:27]
  ds_read_b64_tr_b16 v[168:169], v5 offset:8192
  v_mfma_f32_16x16x32_bf16 v[24:27], v[160:163], a[152:155], v[24:27]
  ds_read_b64_tr_b16 v[170:171], v5 offset:8704
  v_mfma_f32_16x16x32_bf16 v[28:31], v[160:163], a[156:159], v[28:31]
  buffer_load_dwordx4 v1, s[12:15], s40 offen offset:1024 lds
  v_mfma_f32_16x16x32_bf16 v[28:31], v[144:147], a[140:143], v[28:31]
  s_waitcnt lgkmcnt(4)
  v_mfma_f32_16x16x32_bf16 v[44:47], v[148:151], a[140:143], v[44:47]
  ds_read_b64_tr_b16 v[156:157], v5 offset:1024
  v_mfma_f32_16x16x32_bf16 v[44:47], v[164:167], a[156:159], v[44:47]
  s_add_u32 m0, s28, 8192
  ds_read_b64_tr_b16 v[158:159], v5 offset:1536
  v_mfma_f32_16x16x32_bf16 v[40:43], v[164:167], a[152:155], v[40:43]
  buffer_load_dwordx4 v1, s[8:11], s41 offen lds
  v_mfma_f32_16x16x32_bf16 v[40:43], v[148:151], a[136:139], v[40:43]
  v_mfma_f32_16x16x32_bf16 v[36:39], v[148:151], a[132:135], v[36:39]
  ds_read_b64_tr_b16 v[172:173], v5 offset:9216
  v_mfma_f32_16x16x32_bf16 v[36:39], v[164:167], a[148:151], v[36:39]
  ds_read_b64_tr_b16 v[174:175], v5 offset:9728
  v_mfma_f32_16x16x32_bf16 v[32:35], v[164:167], a[144:147], v[32:35]
  buffer_load_dwordx4 v1, s[12:15], s41 offen offset:1024 lds
  v_mfma_f32_16x16x32_bf16 v[32:35], v[148:151], a[128:131], v[32:35]
  s_waitcnt lgkmcnt(4)
  v_mfma_f32_16x16x32_bf16 v[48:51], v[152:155], a[128:131], v[48:51]
  v_mfma_f32_16x16x32_bf16 v[48:51], v[168:171], a[144:147], v[48:51]
  ds_read_b64_tr_b16 v[144:145], v4 offset:16384
  v_mfma_f32_16x16x32_bf16 v[52:55], v[168:171], a[148:151], v[52:55]
  s_add_u32 m0, s62, 147456
  ds_read_b64_tr_b16 v[146:147], v4 offset:16896
  v_mfma_f32_16x16x32_bf16 v[52:55], v[152:155], a[132:135], v[52:55]
  global_load_lds_dwordx4 v12, s[60:61] offset:0
  v_mfma_f32_16x16x32_bf16 v[56:59], v[152:155], a[136:139], v[56:59]
  ds_read_b64_tr_b16 v[160:161], v4 offset:24576
  v_mfma_f32_16x16x32_bf16 v[56:59], v[168:171], a[152:155], v[56:59]
  s_add_u32 m0, s28, 16384
  ds_read_b64_tr_b16 v[162:163], v4 offset:25088
  v_mfma_f32_16x16x32_bf16 v[60:63], v[168:171], a[156:159], v[60:63]
  buffer_load_dwordx4 v1, s[8:11], s42 offen lds
  v_mfma_f32_16x16x32_bf16 v[60:63], v[152:155], a[140:143], v[60:63]
  s_waitcnt lgkmcnt(4)
  v_mfma_f32_16x16x32_bf16 v[76:79], v[156:159], a[140:143], v[76:79]
  ds_read_b64_tr_b16 v[148:149], v4 offset:17408
  v_mfma_f32_16x16x32_bf16 v[76:79], v[172:175], a[156:159], v[76:79]
  ds_read_b64_tr_b16 v[150:151], v4 offset:17920
  v_mfma_f32_16x16x32_bf16 v[72:75], v[172:175], a[152:155], v[72:75]
  v_mfma_f32_16x16x32_bf16 v[72:75], v[156:159], a[136:139], v[72:75]
  v_mfma_f32_16x16x32_bf16 v[68:71], v[156:159], a[132:135], v[68:71]
  ds_read_b64_tr_b16 v[164:165], v4 offset:25600
  v_mfma_f32_16x16x32_bf16 v[68:71], v[172:175], a[148:151], v[68:71]
  ds_read_b64_tr_b16 v[166:167], v4 offset:26112
  v_mfma_f32_16x16x32_bf16 v[64:67], v[172:175], a[144:147], v[64:67]
  buffer_load_dwordx4 v1, s[12:15], s42 offen offset:1024 lds
  v_mfma_f32_16x16x32_bf16 v[64:67], v[156:159], a[128:131], v[64:67]
  s_waitcnt lgkmcnt(4)
  v_mfma_f32_16x16x32_bf16 v[16:19], v[144:147], a[160:163], v[16:19]
  v_mfma_f32_16x16x32_bf16 v[16:19], v[160:163], a[176:179], v[16:19]
  ds_read_b64_tr_b16 v[152:153], v5 offset:16384
  v_mfma_f32_16x16x32_bf16 v[20:23], v[160:163], a[180:183], v[20:23]
  s_add_u32 m0, s28, 24576
  ds_read_b64_tr_b16 v[154:155], v5 offset:16896
  v_mfma_f32_16x16x32_bf16 v[20:23], v[144:147], a[164:167], v[20:23]
  buffer_load_dwordx4 v1, s[8:11], s43 offen lds
  v_mfma_f32_16x16x32_bf16 v[24:27], v[144:147], a[168:171], v[24:27]
  ds_read_b64_tr_b16 v[168:169], v5 offset:24576
  v_mfma_f32_16x16x32_bf16 v[24:27], v[160:163], a[184:187], v[24:27]
  ds_read_b64_tr_b16 v[170:171], v5 offset:25088
  v_mfma_f32_16x16x32_bf16 v[28:31], v[160:163], a[188:191], v[28:31]
  buffer_load_dwordx4 v1, s[12:15], s43 offen offset:1024 lds
  v_mfma_f32_16x16x32_bf16 v[28:31], v[144:147], a[172:175], v[28:31]
  s_waitcnt lgkmcnt(4)
  v_mfma_f32_16x16x32_bf16 v[44:47], v[148:151], a[172:175], v[44:47]
  ds_read_b64_tr_b16 v[156:157], v5 offset:17408
  v_mfma_f32_16x16x32_bf16 v[44:47], v[164:167], a[188:191], v[44:47]
  s_add_u32 m0, s28, 32768
  ds_read_b64_tr_b16 v[158:159], v5 offset:17920
  v_mfma_f32_16x16x32_bf16 v[40:43], v[164:167], a[184:187], v[40:43]
  buffer_load_dwordx4 v1, s[8:11], s44 offen lds
  v_mfma_f32_16x16x32_bf16 v[40:43], v[148:151], a[168:171], v[40:43]
  v_mfma_f32_16x16x32_bf16 v[36:39], v[148:151], a[164:167], v[36:39]
  ds_read_b64_tr_b16 v[172:173], v5 offset:25600
  v_mfma_f32_16x16x32_bf16 v[36:39], v[164:167], a[180:183], v[36:39]
  ds_read_b64_tr_b16 v[174:175], v5 offset:26112
  v_mfma_f32_16x16x32_bf16 v[32:35], v[164:167], a[176:179], v[32:35]
  buffer_load_dwordx4 v1, s[12:15], s44 offen offset:1024 lds
  v_mfma_f32_16x16x32_bf16 v[32:35], v[148:151], a[160:163], v[32:35]
  s_waitcnt vmcnt(10) lgkmcnt(4)
  v_mfma_f32_16x16x32_bf16 v[48:51], v[152:155], a[160:163], v[48:51]
  s_barrier
  v_mfma_f32_16x16x32_bf16 v[48:51], v[168:171], a[176:179], v[48:51]
  ds_read_b64_tr_b16 v[144:145], v4 offset:32768
  v_mfma_f32_16x16x32_bf16 v[52:55], v[168:171], a[180:183], v[52:55]
  ds_read_b64_tr_b16 v[146:147], v4 offset:33280
  v_cmp_gt_u32 vcc, v223, v218
  v_mfma_f32_16x16x32_bf16 v[52:55], v[152:155], a[164:167], v[52:55]
  s_cbranch_vccnz L_g_sp0
L_g_bk0:
  v_mfma_f32_16x16x32_bf16 v[56:59], v[152:155], a[168:171], v[56:59]
  ds_read_b64_tr_b16 v[160:161], v4 offset:40960
  v_add_u32 v6, 0x20000, v2
  v_mfma_f32_16x16x32_bf16 v[56:59], v[168:171], a[184:187], v[56:59]
  s_add_u32 m0, s28, 40960
  ds_read_b64_tr_b16 v[162:163], v4 offset:41472
  v_add_u32 v7, 0x20000, v3
  v_mfma_f32_16x16x32_bf16 v[60:63], v[168:171], a[188:191], v[60:63]
  buffer_load_dwordx4 v1, s[8:11], s45 offen lds
  v_mfma_f32_16x16x32_bf16 v[60:63], v[152:155], a[172:175], v[60:63]
  s_waitcnt lgkmcnt(4)
  s_add_u32 s4, s76, s90
  s_addc_u32 s5, s77, 0
  v_mfma_f32_16x16x32_bf16 v[76:79], v[156:159], a[172:175], v[76:79]
  s_lshl_b32 s91, s31, 4
  ds_read_b64_tr_b16 v[148:149], v4 offset:33792
  s_mov_b32 s6, 16
  v_mfma_f32_16x16x32_bf16 v[76:79], v[172:175], a[188:191], v[76:79]
  s_add_u32 s37, s37, s91
  ds_read_b64_tr_b16 v[150:151], v4 offset:34304
  v_lshrrev_b32 v220, 3, v220
  v_mfma_f32_16x16x32_bf16 v[72:75], v[172:175], a[184:187], v[72:75]
  v_mov_b32 v232, -1
  v_mov_b32 v233, -1
  v_mfma_f32_16x16x32_bf16 v[72:75], v[156:159], a[168:171], v[72:75]
  v_mov_b32 v234, -1
  v_mov_b32 v235, -1
  v_mfma_f32_16x16x32_bf16 v[68:71], v[156:159], a[164:167], v[68:71]
  s_sub_u32 s31, s88, s31
  ds_read_b64_tr_b16 v[164:165], v4 offset:41984
  s_lshl_b32 s33, s25, 4
  v_mfma_f32_16x16x32_bf16 v[68:71], v[172:175], a[180:183], v[68:71]
  s_add_u32 s33, s33, s82
  ds_read_b64_tr_b16 v[166:167], v4 offset:42496
  s_lshl_b32 s33, s33, 2
  v_mfma_f32_16x16x32_bf16 v[64:67], v[172:175], a[176:179], v[64:67]
  buffer_load_dwordx4 v1, s[12:15], s45 offen offset:1024 lds
  v_mfma_f32_16x16x32_bf16 v[64:67], v[156:159], a[160:163], v[64:67]
  s_waitcnt lgkmcnt(4)
  s_add_u32 s33, s33, s24
  s_mul_i32 s33, s33, 9216
  v_mfma_f32_16x16x32_bf16 v[16:19], v[144:147], a[192:195], v[16:19]
  s_add_u32 s33, s33, 33554432
  s_cmp_eq_u32 s82, 3
  s_cselect_b32 s33, 0x7f000000, s33
  v_mfma_f32_16x16x32_bf16 v[16:19], v[160:163], a[208:211], v[16:19]
  s_mul_i32 s34, s81, 147456
  ds_read_b64_tr_b16 v[152:153], v5 offset:32768
  s_add_u32 s67, s33, s34
  v_mfma_f32_16x16x32_bf16 v[20:23], v[160:163], a[212:215], v[20:23]
  s_xor_b32 s34, s81, 3
  ds_read_b64_tr_b16 v[154:155], v5 offset:33280
  s_mul_i32 s34, s34, 147456
  v_mfma_f32_16x16x32_bf16 v[20:23], v[144:147], a[196:199], v[20:23]
  s_add_u32 s64, s33, s34
  s_add_u32 s33, s33, 3072
  s_xor_b32 s34, s81, 2
  v_mfma_f32_16x16x32_bf16 v[24:27], v[144:147], a[200:203], v[24:27]
  s_mul_i32 s34, s34, 147456
  ds_read_b64_tr_b16 v[168:169], v5 offset:40960
  s_add_u32 s65, s33, s34
  v_mfma_f32_16x16x32_bf16 v[24:27], v[160:163], a[216:219], v[24:27]
  s_add_u32 m0, s28, 49152
  ds_read_b64_tr_b16 v[170:171], v5 offset:41472
  s_add_u32 s33, s33, 3072
  v_mfma_f32_16x16x32_bf16 v[28:31], v[160:163], a[220:223], v[28:31]
  buffer_load_dwordx4 v1, s[8:11], s46 offen lds
  v_mfma_f32_16x16x32_bf16 v[28:31], v[144:147], a[204:207], v[28:31]
  s_waitcnt lgkmcnt(4)
  s_xor_b32 s34, s81, 1
  s_mul_i32 s34, s34, 147456
  v_mfma_f32_16x16x32_bf16 v[44:47], v[148:151], a[204:207], v[44:47]
  s_add_u32 s66, s33, s34
  ds_read_b64_tr_b16 v[156:157], v5 offset:33792
  s_xor_b32 s33, s83, 0
  v_mfma_f32_16x16x32_bf16 v[44:47], v[164:167], a[220:223], v[44:47]
  s_mul_i32 s92, s33, 147456
  ds_read_b64_tr_b16 v[158:159], v5 offset:34304
  s_xor_b32 s33, s83, 1
  v_mfma_f32_16x16x32_bf16 v[40:43], v[164:167], a[216:219], v[40:43]
  s_mul_i32 s93, s33, 147456
  s_xor_b32 s33, s83, 2
  s_mul_i32 s94, s33, 147456
  v_mfma_f32_16x16x32_bf16 v[40:43], v[148:151], a[200:203], v[40:43]
  s_xor_b32 s33, s83, 3
  s_mul_i32 s95, s33, 147456
  v_mov_b32 v14, v214
  v_mfma_f32_16x16x32_bf16 v[36:39], v[148:151], a[196:199], v[36:39]
  s_mov_b32 s29, 0
  ds_read_b64_tr_b16 v[172:173], v5 offset:41984
  s_mov_b32 s16, s76
  v_mfma_f32_16x16x32_bf16 v[36:39], v[164:167], a[212:215], v[36:39]
  s_mov_b32 s17, s77
  ds_read_b64_tr_b16 v[174:175], v5 offset:42496
  s_mov_b32 s18, 18874368
  v_mfma_f32_16x16x32_bf16 v[32:35], v[164:167], a[208:211], v[32:35]
  buffer_load_dwordx4 v1, s[12:15], s46 offen offset:1024 lds
  v_mfma_f32_16x16x32_bf16 v[32:35], v[148:151], a[192:195], v[32:35]
  s_waitcnt lgkmcnt(4)
  s_mov_b32 s19, 0x20000
  s_mul_i32 s33, s39, 589824
  v_mfma_f32_16x16x32_bf16 v[48:51], v[152:155], a[192:195], v[48:51]
  s_lshl_b32 s34, s38, 10
  s_add_u32 s34, s33, s34
  v_add_u32_e64 v8, s34, v9
  v_mfma_f32_16x16x32_bf16 v[48:51], v[168:171], a[208:211], v[48:51]
  s_mov_b32 s32, 0x409d30fc
  ds_read_b64_tr_b16 v[144:145], v4 offset:49152
  s_mov_b32 s74, s86
  v_mfma_f32_16x16x32_bf16 v[52:55], v[168:171], a[212:215], v[52:55]
  s_add_u32 m0, s62, 148352
  ds_read_b64_tr_b16 v[146:147], v4 offset:49664
  s_mov_b32 s75, s87
  v_mfma_f32_16x16x32_bf16 v[52:55], v[152:155], a[196:199], v[52:55]
  global_load_lds_dwordx4 v12, s[60:61] offset:128
  v_mfma_f32_16x16x32_bf16 v[56:59], v[152:155], a[200:203], v[56:59]
  s_sub_u32 s84, s84, 2048
  ds_read_b64_tr_b16 v[160:161], v4 offset:57344
  s_subb_u32 s85, s85, 0
  v_mfma_f32_16x16x32_bf16 v[56:59], v[168:171], a[216:219], v[56:59]
  s_add_u32 m0, s28, 57344
  ds_read_b64_tr_b16 v[162:163], v4 offset:57856
  s_mov_b32 s86, 5310464
  v_mfma_f32_16x16x32_bf16 v[60:63], v[168:171], a[220:223], v[60:63]
  buffer_load_dwordx4 v1, s[8:11], s47 offen lds
  v_mfma_f32_16x16x32_bf16 v[60:63], v[152:155], a[204:207], v[60:63]
  s_waitcnt lgkmcnt(4)
  s_mov_b32 s87, 0x20000
  s_lshl_b32 s34, s82, 3
  v_mfma_f32_16x16x32_bf16 v[76:79], v[156:159], a[204:207], v[76:79]
  s_add_u32 s33, s27, s34
  ds_read_b64_tr_b16 v[148:149], v4 offset:50176
  s_lshl_b32 s33, s33, 6
  v_mfma_f32_16x16x32_bf16 v[76:79], v[172:175], a[220:223], v[76:79]
  s_add_u32 s33, s33, korder_tab-L_pc
  ds_read_b64_tr_b16 v[150:151], v4 offset:50688
  v_add_u32 v212, s33, v0
  v_mfma_f32_16x16x32_bf16 v[72:75], v[172:175], a[216:219], v[72:75]
  global_load_ubyte v222, v212, s[68:69]
  v_mfma_f32_16x16x32_bf16 v[72:75], v[156:159], a[200:203], v[72:75]
  s_lshl_b32 s33, s24, 3
  v_add_u32 v236, s33, v10
  v_mul_u32_u24 v236, 1152, v236
  v_mfma_f32_16x16x32_bf16 v[68:71], v[156:159], a[196:199], v[68:71]
  ds_read_b64_tr_b16 v[164:165], v4 offset:58368
  v_and_b32_e64 v212, 6, v10
  v_mfma_f32_16x16x32_bf16 v[68:71], v[172:175], a[212:215], v[68:71]
  ds_read_b64_tr_b16 v[166:167], v4 offset:58880
  v_xor_b32_e64 v212, v212, v11
  v_mfma_f32_16x16x32_bf16 v[64:67], v[172:175], a[208:211], v[64:67]
  buffer_load_dwordx4 v1, s[12:15], s47 offen offset:1024 lds
  v_mfma_f32_16x16x32_bf16 v[64:67], v[156:159], a[192:195], v[64:67]
  s_waitcnt lgkmcnt(4)
  v_lshl_add_u32 v236, v212, 4, v236
  s_mul_i32 s33, s82, 384
  v_mfma_f32_16x16x32_bf16 v[16:19], v[144:147], a[224:227], v[16:19]
  s_mul_i32 s34, s81, 1327104
  s_add_u32 s33, s33, s34
  s_add_u32 s33, s33, 2048
  v_mfma_f32_16x16x32_bf16 v[16:19], v[160:163], a[240:243], v[16:19]
  ds_read_b64_tr_b16 v[152:153], v5 offset:49152
  v_add_u32_e64 v236, s33, v236
  v_mfma_f32_16x16x32_bf16 v[20:23], v[160:163], a[244:247], v[20:23]
  ds_read_b64_tr_b16 v[154:155], v5 offset:49664
  v_add_u32 v237, 4294966400, v236
  v_mfma_f32_16x16x32_bf16 v[20:23], v[144:147], a[228:231], v[20:23]
  v_add_u32 v238, 4294965504, v236
  s_lshl_b32 s33, s25, 3
  v_mfma_f32_16x16x32_bf16 v[24:27], v[144:147], a[232:235], v[24:27]
  s_lshl_b32 s34, s24, 1
  ds_read_b64_tr_b16 v[168:169], v5 offset:57344
  s_add_u32 s83, s33, s34
  v_mfma_f32_16x16x32_bf16 v[24:27], v[160:163], a[248:251], v[24:27]
  s_add_u32 m0, s28, 65536
  ds_read_b64_tr_b16 v[170:171], v5 offset:57856
  s_mul_i32 s33, s83, 147456
  v_mfma_f32_16x16x32_bf16 v[28:31], v[160:163], a[252:255], v[28:31]
  buffer_load_dwordx4 v1, s[8:11], s48 offen lds
  v_mfma_f32_16x16x32_bf16 v[28:31], v[144:147], a[236:239], v[28:31]
  s_waitcnt lgkmcnt(4)
  s_mul_i32 s34, s81, 36864
  s_add_u32 s33, s33, s34
  v_mfma_f32_16x16x32_bf16 v[44:47], v[148:151], a[236:239], v[44:47]
  ds_read_b64_tr_b16 v[156:157], v5 offset:50176
  v_add_u32 v239, s33, v9
  v_mfma_f32_16x16x32_bf16 v[44:47], v[164:167], a[252:255], v[44:47]
  ds_read_b64_tr_b16 v[158:159], v5 offset:50688
  v_add_u32 v240, 147456, v239
  v_mfma_f32_16x16x32_bf16 v[40:43], v[164:167], a[248:251], v[40:43]
  s_xor_b32 s34, s81, 3
  v_lshrrev_b32 v212, 5, v0
  v_bfe_u32 v213, v0, 2, 3
  v_mfma_f32_16x16x32_bf16 v[40:43], v[148:151], a[232:235], v[40:43]
  v_and_b32_e64 v215, 3, v0
  v_mul_u32_u24 v241, 3072, v212
  v_mfma_f32_16x16x32_bf16 v[36:39], v[148:151], a[228:231], v[36:39]
  ds_read_b64_tr_b16 v[172:173], v5 offset:58368
  v_lshl_add_u32 v241, v213, 7, v241
  v_mfma_f32_16x16x32_bf16 v[36:39], v[164:167], a[244:247], v[36:39]
  ds_read_b64_tr_b16 v[174:175], v5 offset:58880
  v_lshl_add_u32 v241, v215, 3, v241
  v_mfma_f32_16x16x32_bf16 v[32:35], v[164:167], a[240:243], v[32:35]
  buffer_load_dwordx4 v1, s[12:15], s48 offen offset:1024 lds
  v_mfma_f32_16x16x32_bf16 v[32:35], v[148:151], a[224:227], v[32:35]
  s_waitcnt lgkmcnt(4)
  v_lshrrev_b32 v213, 1, v213
  v_xor_b32_e64 v213, s34, v213
  v_mfma_f32_16x16x32_bf16 v[48:51], v[152:155], a[224:227], v[48:51]
  v_lshl_add_u32 v241, v213, 5, v241
  v_xor_b32_e64 v242, 32, v241
  v_mfma_f32_16x16x32_bf16 v[48:51], v[168:171], a[240:243], v[48:51]
  ds_read_b64_tr_b16 v[144:145], v6 offset:0
  v_xor_b32_e64 v243, 64, v241
  v_mfma_f32_16x16x32_bf16 v[52:55], v[168:171], a[244:247], v[52:55]
  ds_read_b64_tr_b16 v[146:147], v6 offset:512
  v_xor_b32 v244, 96, v241
  v_mfma_f32_16x16x32_bf16 v[52:55], v[152:155], a[228:231], v[52:55]
  s_mul_i32 s63, s24, 3072
  v_min_u32 v212, 11, v0
  v_lshrrev_b32 v213, 2, v212
  v_mfma_f32_16x16x32_bf16 v[56:59], v[152:155], a[232:235], v[56:59]
  ds_read_b64_tr_b16 v[160:161], v6 offset:8192
  v_and_b32_e64 v212, 3, v212
  v_mfma_f32_16x16x32_bf16 v[56:59], v[168:171], a[248:251], v[56:59]
  s_add_u32 m0, s28, 73728
  ds_read_b64_tr_b16 v[162:163], v6 offset:8704
  v_mul_u32_u24 v15, 1152, v212
  v_mfma_f32_16x16x32_bf16 v[60:63], v[168:171], a[252:255], v[60:63]
  buffer_load_dwordx4 v1, s[8:11], s49 offen lds
  v_mfma_f32_16x16x32_bf16 v[60:63], v[152:155], a[236:239], v[60:63]
  s_waitcnt lgkmcnt(4)
  v_lshl_add_u32 v15, v213, 7, v15
  s_lshl_b32 s33, s27, 2
  v_mfma_f32_16x16x32_bf16 v[76:79], v[156:159], a[236:239], v[76:79]
  s_add_u32 s33, s33, s24
  ds_read_b64_tr_b16 v[148:149], v6 offset:1024
  s_mul_i32 s33, s33, 4608
  v_mfma_f32_16x16x32_bf16 v[76:79], v[172:175], a[252:255], v[76:79]
  s_mul_i32 s34, s81, 1327104
  ds_read_b64_tr_b16 v[150:151], v6 offset:1536
  s_add_u32 s33, s33, s34
  v_mfma_f32_16x16x32_bf16 v[72:75], v[172:175], a[248:251], v[72:75]
  s_mul_i32 s34, s82, 384
  s_add_u32 s33, s33, s34
  s_add_u32 s72, s33, 2048
  v_mfma_f32_16x16x32_bf16 v[72:75], v[156:159], a[232:235], v[72:75]
  s_cmp_eq_u32 s82, 3
  s_cselect_b32 s72, 0x7f000000, s72
  v_min_u32_e64 v212, 53, v0
  v_mfma_f32_16x16x32_bf16 v[68:71], v[156:159], a[228:231], v[68:71]
  ds_read_b64_tr_b16 v[164:165], v6 offset:9216
  v_mul_u32_u24 v213, 3641, v212
  v_mfma_f32_16x16x32_bf16 v[68:71], v[172:175], a[244:247], v[68:71]
  ds_read_b64_tr_b16 v[166:167], v6 offset:9728
  v_lshrrev_b32_e64 v213, 16, v213
  v_mfma_f32_16x16x32_bf16 v[64:67], v[172:175], a[240:243], v[64:67]
  buffer_load_dwordx4 v1, s[12:15], s49 offen offset:1024 lds
  v_mfma_f32_16x16x32_bf16 v[64:67], v[156:159], a[224:227], v[64:67]
  s_waitcnt lgkmcnt(4)
  v_mul_u32_u24 v213, 366336, v213
  v_lshl_add_u32 v13, v212, 7, v213
  v_mfma_f32_16x16x32_bf16 v[16:19], v[144:147], v[176:179], v[16:19]
  s_and_b32 s33, s25, 14
  s_lshl_b32 s33, s33, 1
  s_add_u32 s33, s33, s24
  v_mfma_f32_16x16x32_bf16 v[80:83], v[160:163], v[192:195], v[16:19]
  s_mul_i32 s33, s33, 2304
  ds_read_b64_tr_b16 v[152:153], v7 offset:0
  s_mul_i32 s34, s81, 1327104
  v_mfma_f32_16x16x32_bf16 v[20:23], v[160:163], v[196:199], v[20:23]
  s_add_u32 m0, s62, 149248
  ds_read_b64_tr_b16 v[154:155], v7 offset:512
  s_add_u32 s33, s33, s34
  v_mfma_f32_16x16x32_bf16 v[84:87], v[144:147], v[180:183], v[20:23]
  global_load_lds_dwordx4 v12, s[60:61] offset:256
  v_mfma_f32_16x16x32_bf16 v[24:27], v[144:147], v[184:187], v[24:27]
  s_add_u32 s59, s33, 223232
  ds_read_b64_tr_b16 v[168:169], v7 offset:8192
  v_mov_b32 v221, 0
  v_mfma_f32_16x16x32_bf16 v[88:91], v[160:163], v[200:203], v[24:27]
  s_add_u32 m0, s28, 81920
  ds_read_b64_tr_b16 v[170:171], v7 offset:8704
  s_mov_b32 s33, 26196
  v_mfma_f32_16x16x32_bf16 v[28:31], v[160:163], v[204:207], v[28:31]
  buffer_load_dwordx4 v1, s[8:11], s50 offen lds
  v_mfma_f32_16x16x32_bf16 v[92:95], v[144:147], v[188:191], v[28:31]
  s_waitcnt lgkmcnt(4)
  v_writelane_b32 v221, s33, 0
  v_writelane_b32 v221, s33, 1
  v_mfma_f32_16x16x32_bf16 v[44:47], v[148:151], v[188:191], v[44:47]
  ds_read_b64_tr_b16 v[156:157], v7 offset:1024
  v_writelane_b32 v221, s33, 2
  v_mfma_f32_16x16x32_bf16 v[108:111], v[164:167], v[204:207], v[44:47]
  s_mov_b32 s33, 29760
  ds_read_b64_tr_b16 v[158:159], v7 offset:1536
  v_writelane_b32 v221, s33, 3
  v_mfma_f32_16x16x32_bf16 v[40:43], v[164:167], v[200:203], v[40:43]
  v_add_u32 v245, 65536, v241
  v_add_u32 v246, 65536, v242
  v_mfma_f32_16x16x32_bf16 v[104:107], v[148:151], v[184:187], v[40:43]
  v_add_u32 v247, 65536, v243
  v_add_u32 v248, 65536, v244
  v_mfma_f32_16x16x32_bf16 v[36:39], v[148:151], v[180:183], v[36:39]
  ds_read_b64_tr_b16 v[172:173], v7 offset:9216
  v_add_u32 v249, 131072, v241
  v_mfma_f32_16x16x32_bf16 v[100:103], v[164:167], v[196:199], v[36:39]
  ds_read_b64_tr_b16 v[174:175], v7 offset:9728
  v_add_u32 v250, 131072, v242
  v_mfma_f32_16x16x32_bf16 v[32:35], v[164:167], v[192:195], v[32:35]
  buffer_load_dwordx4 v1, s[12:15], s50 offen offset:1024 lds
  v_mfma_f32_16x16x32_bf16 v[96:99], v[148:151], v[176:179], v[32:35]
  s_waitcnt vmcnt(10) lgkmcnt(4)
  v_add_u32 v251, 131072, v243
  v_add_u32 v252, 131072, v244
  v_mfma_f32_16x16x32_bf16 v[48:51], v[152:155], v[176:179], v[48:51]
  s_barrier
  v_mfma_f32_16x16x32_bf16 v[112:115], v[168:171], v[192:195], v[48:51]
  ds_read_b64_tr_b16 v[144:145], v2 offset:0
  v_mfma_f32_16x16x32_bf16 v[52:55], v[168:171], v[196:199], v[52:55]
  ds_read_b64_tr_b16 v[146:147], v2 offset:512
  v_add_u32 v219, 1, v219
  v_mfma_f32_16x16x32_bf16 v[116:119], v[152:155], v[180:183], v[52:55]
  buffer_store_dword v219, v216, s[20:23], s30 offen sc1
  v_mfma_f32_16x16x32_bf16 v[56:59], v[152:155], v[184:187], v[56:59]
  ds_read_b64_tr_b16 v[160:161], v2 offset:8192
  v_mfma_f32_16x16x32_bf16 v[120:123], v[168:171], v[200:203], v[56:59]
  s_add_u32 m0, s28, 90112
  ds_read_b64_tr_b16 v[162:163], v2 offset:8704
  v_mfma_f32_16x16x32_bf16 v[60:63], v[168:171], v[204:207], v[60:63]
  buffer_load_dwordx4 v1, s[8:11], s51 offen lds
  v_mfma_f32_16x16x32_bf16 v[124:127], v[152:155], v[188:191], v[60:63]
  s_waitcnt lgkmcnt(4)
  v_mfma_f32_16x16x32_bf16 v[76:79], v[156:159], v[188:191], v[76:79]
  ds_read_b64_tr_b16 v[148:149], v2 offset:1024
  v_mfma_f32_16x16x32_bf16 v[140:143], v[172:175], v[204:207], v[76:79]
  ds_read_b64_tr_b16 v[150:151], v2 offset:1536
  v_mfma_f32_16x16x32_bf16 v[72:75], v[172:175], v[200:203], v[72:75]
  v_mfma_f32_16x16x32_bf16 v[136:139], v[156:159], v[184:187], v[72:75]
  v_mfma_f32_16x16x32_bf16 v[68:71], v[156:159], v[180:183], v[68:71]
  ds_read_b64_tr_b16 v[164:165], v2 offset:9216
  v_mfma_f32_16x16x32_bf16 v[132:135], v[172:175], v[196:199], v[68:71]
  ds_read_b64_tr_b16 v[166:167], v2 offset:9728
  v_mfma_f32_16x16x32_bf16 v[64:67], v[172:175], v[192:195], v[64:67]
  buffer_load_dwordx4 v1, s[12:15], s51 offen offset:1024 lds
  v_mfma_f32_16x16x32_bf16 v[128:131], v[156:159], v[176:179], v[64:67]
  s_waitcnt lgkmcnt(4)
L_g1_loop:
  v_mfma_f32_16x16x32_bf16 v[16:19], v[144:147], a[0:3], 0
  s_add_u32 s30, s89, s92
  v_fma_f32 v208, v80, v80, s32
  v_fma_f32 v209, v81, v81, s32
  v_mfma_f32_16x16x32_bf16 v[16:19], v[160:163], a[16:19], v[16:19]
  ds_read_b64_tr_b16 v[152:153], v3 offset:0
  v_mul_f32 v96, v80, v96
  v_mfma_f32_16x16x32_bf16 v[20:23], v[160:163], a[20:23], 0
  ds_read_b64_tr_b16 v[154:155], v3 offset:512
  v_mul_f32_e64 v80, v80, v208
  v_mfma_f32_16x16x32_bf16 v[20:23], v[144:147], a[4:7], v[20:23]
  buffer_store_dwordx4 v[232:235], v9, s[20:23], s64 offen offset:0 sc1
  v_mfma_f32_16x16x32_bf16 v[24:27], v[144:147], a[8:11], 0
  ds_read_b64_tr_b16 v[168:169], v3 offset:8192
  v_mul_f32_e64 v97, v81, v97
  v_mfma_f32_16x16x32_bf16 v[24:27], v[160:163], a[24:27], v[24:27]
  s_add_u32 m0, s28, 98304
  ds_read_b64_tr_b16 v[170:171], v3 offset:8704
  v_mul_f32_e64 v81, v81, v209
  v_mfma_f32_16x16x32_bf16 v[28:31], v[160:163], a[28:31], 0
  buffer_load_dwordx4 v1, s[8:11], s52 offen lds
  v_mfma_f32_16x16x32_bf16 v[28:31], v[144:147], a[12:15], v[28:31]
  s_waitcnt lgkmcnt(4)
  v_exp_f32 v80, -v80
  v_mfma_f32_16x16x32_bf16 v[44:47], v[148:151], a[12:15], 0
  s_add_u32 s29, s29, 1
  ds_read_b64_tr_b16 v[156:157], v3 offset:1024
  v_add_f32 v80, 1.0, v80
L_pg3:
  s_cbranch_execz L_pg7
  v_mfma_f32_16x16x32_bf16 v[44:47], v[164:167], a[28:31], v[44:47]
  ds_read_b64_tr_b16 v[158:159], v3 offset:1536
  v_fma_f32 v210, v82, v82, s32
  v_mfma_f32_16x16x32_bf16 v[40:43], v[164:167], a[24:27], 0
  v_rcp_f32_e64 v80, v80
  v_mfma_f32_16x16x32_bf16 v[40:43], v[148:151], a[8:11], v[40:43]
  v_exp_f32 v81, -v81
  v_mfma_f32_16x16x32_bf16 v[36:39], v[148:151], a[4:7], 0
  ds_read_b64_tr_b16 v[172:173], v3 offset:9216
  v_mul_f32_e64 v96, v96, v80
  v_mfma_f32_16x16x32_bf16 v[36:39], v[164:167], a[20:23], v[36:39]
  ds_read_b64_tr_b16 v[174:175], v3 offset:9728
  v_add_f32_e64 v81, 1.0, v81
  v_mfma_f32_16x16x32_bf16 v[32:35], v[164:167], a[16:19], 0
  buffer_load_dwordx4 v1, s[12:15], s52 offen offset:1024 lds
  v_mfma_f32_16x16x32_bf16 v[32:35], v[148:151], a[0:3], v[32:35]
  s_waitcnt lgkmcnt(4)
  v_rcp_f32 v81, v81
  v_mfma_f32_16x16x32_bf16 v[48:51], v[152:155], a[0:3], 0
  v_mul_f32_e64 v97, v97, v81
  v_cvt_pk_bf16_f32 v224, v96, v97
  v_mfma_f32_16x16x32_bf16 v[48:51], v[168:171], a[16:19], v[48:51]
  s_add_u32 s78, s89, s93
  ds_read_b64_tr_b16 v[144:145], v2 offset:16384
  v_mul_f32 v98, v82, v98
  v_mfma_f32_16x16x32_bf16 v[52:55], v[168:171], a[20:23], 0
  s_add_u32 s79, s89, s94
  ds_read_b64_tr_b16 v[146:147], v2 offset:16896
  v_mul_f32 v82, v82, v210
  v_mfma_f32_16x16x32_bf16 v[52:55], v[152:155], a[4:7], v[52:55]
  v_exp_f32 v82, -v82
  v_mfma_f32_16x16x32_bf16 v[56:59], v[152:155], a[8:11], 0
  s_add_u32 s80, s89, s95
  ds_read_b64_tr_b16 v[160:161], v2 offset:24576
  v_add_f32 v82, 1.0, v82
  v_mfma_f32_16x16x32_bf16 v[56:59], v[168:171], a[24:27], v[56:59]
  s_add_u32 m0, s28, 106496
  ds_read_b64_tr_b16 v[162:163], v2 offset:25088
  v_fma_f32 v211, v83, v83, s32
  v_mfma_f32_16x16x32_bf16 v[60:63], v[168:171], a[28:31], 0
  buffer_load_dwordx4 v1, s[8:11], s53 offen lds
  v_mfma_f32_16x16x32_bf16 v[60:63], v[152:155], a[12:15], v[60:63]
  s_waitcnt lgkmcnt(4)
  v_rcp_f32 v82, v82
  v_mfma_f32_16x16x32_bf16 v[76:79], v[156:159], a[12:15], 0
  ds_read_b64_tr_b16 v[148:149], v2 offset:17408
  v_mul_f32_e64 v98, v98, v82
  v_mfma_f32_16x16x32_bf16 v[76:79], v[172:175], a[28:31], v[76:79]
  ds_read_b64_tr_b16 v[150:151], v2 offset:17920
  v_mul_f32_e64 v99, v83, v99
  v_mfma_f32_16x16x32_bf16 v[72:75], v[172:175], a[24:27], 0
  v_mul_f32_e64 v83, v83, v211
  v_fma_f32 v212, v112, v112, s32
  v_mfma_f32_16x16x32_bf16 v[72:75], v[156:159], a[8:11], v[72:75]
  v_exp_f32 v83, -v83
  v_mfma_f32_16x16x32_bf16 v[68:71], v[156:159], a[4:7], 0
  ds_read_b64_tr_b16 v[164:165], v2 offset:25600
  v_add_f32_e64 v83, 1.0, v83
  v_mfma_f32_16x16x32_bf16 v[68:71], v[172:175], a[20:23], v[68:71]
  ds_read_b64_tr_b16 v[166:167], v2 offset:26112
  v_mul_f32_e64 v128, v112, v128
  v_mfma_f32_16x16x32_bf16 v[64:67], v[172:175], a[16:19], 0
  buffer_load_dwordx4 v1, s[12:15], s53 offen offset:1024 lds
  v_mfma_f32_16x16x32_bf16 v[64:67], v[156:159], a[0:3], v[64:67]
  s_waitcnt lgkmcnt(4)
  v_rcp_f32 v83, v83
  v_mfma_f32_16x16x32_bf16 v[16:19], v[144:147], a[32:35], v[16:19]
  v_mul_f32_e64 v99, v99, v83
  v_cvt_pk_bf16_f32 v225, v98, v99
  v_mfma_f32_16x16x32_bf16 v[16:19], v[160:163], a[48:51], v[16:19]
  ds_read_b64_tr_b16 v[152:153], v3 offset:16384
  v_mul_f32_e64 v112, v112, v212
  v_mfma_f32_16x16x32_bf16 v[20:23], v[160:163], a[52:55], v[20:23]
  ds_read_b64_tr_b16 v[154:155], v3 offset:16896
  v_fma_f32 v213, v113, v113, s32
  v_mfma_f32_16x16x32_bf16 v[20:23], v[144:147], a[36:39], v[20:23]
  buffer_store_dwordx4 v[232:235], v9, s[20:23], s64 offen offset:1024 sc1
  v_mfma_f32_16x16x32_bf16 v[24:27], v[144:147], a[40:43], v[24:27]
  ds_read_b64_tr_b16 v[168:169], v3 offset:24576
  v_mul_f32_e64 v129, v113, v129
  v_mfma_f32_16x16x32_bf16 v[24:27], v[160:163], a[56:59], v[24:27]
  s_add_u32 m0, s28, 114688
  ds_read_b64_tr_b16 v[170:171], v3 offset:25088
  v_mul_f32_e64 v113, v113, v213
  v_mfma_f32_16x16x32_bf16 v[28:31], v[160:163], a[60:63], v[28:31]
  buffer_load_dwordx4 v1, s[8:11], s54 offen lds
  v_mfma_f32_16x16x32_bf16 v[28:31], v[144:147], a[44:47], v[28:31]
  s_waitcnt lgkmcnt(4)
  v_exp_f32 v112, -v112
  v_mfma_f32_16x16x32_bf16 v[44:47], v[148:151], a[44:47], v[44:47]
  ds_read_b64_tr_b16 v[156:157], v3 offset:17408
  v_add_f32 v112, 1.0, v112
  v_mfma_f32_16x16x32_bf16 v[44:47], v[164:167], a[60:63], v[44:47]
  ds_read_b64_tr_b16 v[158:159], v3 offset:17920
  v_fma_f32 v214, v114, v114, s32
  v_mfma_f32_16x16x32_bf16 v[40:43], v[164:167], a[56:59], v[40:43]
  v_rcp_f32_e64 v112, v112
  v_mfma_f32_16x16x32_bf16 v[40:43], v[148:151], a[40:43], v[40:43]
  v_exp_f32 v113, -v113
  v_mfma_f32_16x16x32_bf16 v[36:39], v[148:151], a[36:39], v[36:39]
  ds_read_b64_tr_b16 v[172:173], v3 offset:25600
  v_mul_f32_e64 v128, v128, v112
  v_mfma_f32_16x16x32_bf16 v[36:39], v[164:167], a[52:55], v[36:39]
  ds_read_b64_tr_b16 v[174:175], v3 offset:26112
  v_add_f32_e64 v113, 1.0, v113
  v_mfma_f32_16x16x32_bf16 v[32:35], v[164:167], a[48:51], v[32:35]
  buffer_load_dwordx4 v1, s[12:15], s54 offen offset:1024 lds
  v_mfma_f32_16x16x32_bf16 v[32:35], v[148:151], a[32:35], v[32:35]
  s_waitcnt lgkmcnt(4)
  v_rcp_f32 v113, v113
  v_mfma_f32_16x16x32_bf16 v[48:51], v[152:155], a[32:35], v[48:51]
  v_mul_f32_e64 v129, v129, v113
  v_cvt_pk_bf16_f32 v226, v128, v129
  v_mfma_f32_16x16x32_bf16 v[48:51], v[168:171], a[48:51], v[48:51]
  ds_read_b64_tr_b16 v[144:145], v2 offset:32768
  v_mul_f32_e64 v130, v114, v130
  v_mfma_f32_16x16x32_bf16 v[52:55], v[168:171], a[52:55], v[52:55]
  ds_read_b64_tr_b16 v[146:147], v2 offset:33280
  v_mul_f32_e64 v114, v114, v214
  v_mfma_f32_16x16x32_bf16 v[52:55], v[152:155], a[36:39], v[52:55]
  v_exp_f32 v114, -v114
  v_mfma_f32_16x16x32_bf16 v[56:59], v[152:155], a[40:43], v[56:59]
  ds_read_b64_tr_b16 v[160:161], v2 offset:40960
  v_add_f32_e64 v114, 1.0, v114
  v_mfma_f32_16x16x32_bf16 v[56:59], v[168:171], a[56:59], v[56:59]
  s_add_u32 m0, s28, 122880
  ds_read_b64_tr_b16 v[162:163], v2 offset:41472
  v_fma_f32 v215, v115, v115, s32
  v_mfma_f32_16x16x32_bf16 v[60:63], v[168:171], a[60:63], v[60:63]
  buffer_load_dwordx4 v1, s[8:11], s55 offen lds
  v_mfma_f32_16x16x32_bf16 v[60:63], v[152:155], a[44:47], v[60:63]
  s_waitcnt lgkmcnt(4)
  v_rcp_f32 v114, v114
  v_mfma_f32_16x16x32_bf16 v[76:79], v[156:159], a[44:47], v[76:79]
  ds_read_b64_tr_b16 v[148:149], v2 offset:33792
  v_mul_f32_e64 v130, v130, v114
  v_mfma_f32_16x16x32_bf16 v[76:79], v[172:175], a[60:63], v[76:79]
  ds_read_b64_tr_b16 v[150:151], v2 offset:34304
  v_mul_f32_e64 v131, v115, v131
  v_mfma_f32_16x16x32_bf16 v[72:75], v[172:175], a[56:59], v[72:75]
  v_mul_f32_e64 v115, v115, v215
  v_fma_f32 v208, v84, v84, s32
  v_mfma_f32_16x16x32_bf16 v[72:75], v[156:159], a[40:43], v[72:75]
  v_exp_f32 v115, -v115
  v_mfma_f32_16x16x32_bf16 v[68:71], v[156:159], a[36:39], v[68:71]
  ds_read_b64_tr_b16 v[164:165], v2 offset:41984
  v_add_f32_e64 v115, 1.0, v115
  v_mfma_f32_16x16x32_bf16 v[68:71], v[172:175], a[52:55], v[68:71]
  ds_read_b64_tr_b16 v[166:167], v2 offset:42496
  v_mul_f32_e64 v100, v84, v100
  v_mfma_f32_16x16x32_bf16 v[64:67], v[172:175], a[48:51], v[64:67]
  buffer_load_dwordx4 v1, s[12:15], s55 offen offset:1024 lds
  v_mfma_f32_16x16x32_bf16 v[64:67], v[156:159], a[32:35], v[64:67]
  s_waitcnt lgkmcnt(4)
  v_rcp_f32 v115, v115
  v_mfma_f32_16x16x32_bf16 v[16:19], v[144:147], a[64:67], v[16:19]
  v_mul_f32_e64 v131, v131, v115
  v_cvt_pk_bf16_f32 v227, v130, v131
  v_mfma_f32_16x16x32_bf16 v[16:19], v[160:163], a[80:83], v[16:19]
  ds_read_b64_tr_b16 v[152:153], v3 offset:32768
  v_mul_f32_e64 v84, v84, v208
  v_mfma_f32_16x16x32_bf16 v[20:23], v[160:163], a[84:87], v[20:23]
  ds_read_b64_tr_b16 v[154:155], v3 offset:33280
  v_fma_f32 v209, v85, v85, s32
  v_mfma_f32_16x16x32_bf16 v[20:23], v[144:147], a[68:71], v[20:23]
  buffer_store_dwordx4 v[224:227], v8, s[16:19], s30 offen sc1
  v_mfma_f32_16x16x32_bf16 v[24:27], v[144:147], a[72:75], v[24:27]
  ds_read_b64_tr_b16 v[168:169], v3 offset:40960
  v_mul_f32_e64 v101, v85, v101
  v_mfma_f32_16x16x32_bf16 v[24:27], v[160:163], a[88:91], v[24:27]
  s_add_u32 m0, s28, 131072
  ds_read_b64_tr_b16 v[170:171], v3 offset:41472
  v_mul_f32_e64 v85, v85, v209
  v_mfma_f32_16x16x32_bf16 v[28:31], v[160:163], a[92:95], v[28:31]
  buffer_load_dwordx4 v1, s[8:11], s56 offen lds
  v_mfma_f32_16x16x32_bf16 v[28:31], v[144:147], a[76:79], v[28:31]
  s_waitcnt lgkmcnt(4)
  v_exp_f32 v84, -v84
  v_mfma_f32_16x16x32_bf16 v[44:47], v[148:151], a[76:79], v[44:47]
  ds_read_b64_tr_b16 v[156:157], v3 offset:33792
  v_add_f32 v84, 1.0, v84
  v_mfma_f32_16x16x32_bf16 v[44:47], v[164:167], a[92:95], v[44:47]
  ds_read_b64_tr_b16 v[158:159], v3 offset:34304
  v_fma_f32 v210, v86, v86, s32
  v_mfma_f32_16x16x32_bf16 v[40:43], v[164:167], a[88:91], v[40:43]
  v_rcp_f32_e64 v84, v84
  v_mfma_f32_16x16x32_bf16 v[40:43], v[148:151], a[72:75], v[40:43]
  v_exp_f32 v85, -v85
  v_mfma_f32_16x16x32_bf16 v[36:39], v[148:151], a[68:71], v[36:39]
  ds_read_b64_tr_b16 v[172:173], v3 offset:41984
  v_mul_f32_e64 v100, v100, v84
  v_mfma_f32_16x16x32_bf16 v[36:39], v[164:167], a[84:87], v[36:39]
  ds_read_b64_tr_b16 v[174:175], v3 offset:42496
  v_add_f32_e64 v85, 1.0, v85
  v_mfma_f32_16x16x32_bf16 v[32:35], v[164:167], a[80:83], v[32:35]
  buffer_load_dwordx4 v1, s[12:15], s56 offen offset:1024 lds
  v_mfma_f32_16x16x32_bf16 v[32:35], v[148:151], a[64:67], v[32:35]
  s_waitcnt vmcnt(10) lgkmcnt(4)
  v_rcp_f32 v85, v85
  v_mfma_f32_16x16x32_bf16 v[48:51], v[152:155], a[64:67], v[48:51]
  s_barrier
  v_mfma_f32_16x16x32_bf16 v[48:51], v[168:171], a[80:83], v[48:51]
  ds_read_b64_tr_b16 v[144:145], v2 offset:49152
  v_mul_f32 v101, v101, v85
  v_mfma_f32_16x16x32_bf16 v[52:55], v[168:171], a[84:87], v[52:55]
  ds_read_b64_tr_b16 v[146:147], v2 offset:49664
  v_cvt_pk_bf16_f32 v228, v100, v101
  v_mfma_f32_16x16x32_bf16 v[52:55], v[152:155], a[68:71], v[52:55]
  v_mul_f32_e64 v102, v86, v102
  v_fma_f32 v211, v87, v87, s32
  v_mfma_f32_16x16x32_bf16 v[56:59], v[152:155], a[72:75], v[56:59]
  ds_read_b64_tr_b16 v[160:161], v2 offset:57344
  v_mul_f32_e64 v86, v86, v210
  v_mfma_f32_16x16x32_bf16 v[56:59], v[168:171], a[88:91], v[56:59]
  s_add_u32 m0, s28, 139264
  ds_read_b64_tr_b16 v[162:163], v2 offset:57856
  v_mul_f32_e64 v103, v87, v103
  v_mfma_f32_16x16x32_bf16 v[60:63], v[168:171], a[92:95], v[60:63]
  buffer_load_dwordx4 v1, s[8:11], s57 offen lds
  v_mfma_f32_16x16x32_bf16 v[60:63], v[152:155], a[76:79], v[60:63]
  s_waitcnt lgkmcnt(4)
  v_exp_f32 v86, -v86
  v_mfma_f32_16x16x32_bf16 v[76:79], v[156:159], a[76:79], v[76:79]
  ds_read_b64_tr_b16 v[148:149], v2 offset:50176
  v_add_f32 v86, 1.0, v86
  v_mfma_f32_16x16x32_bf16 v[76:79], v[172:175], a[92:95], v[76:79]
  ds_read_b64_tr_b16 v[150:151], v2 offset:50688
  v_mul_f32_e64 v87, v87, v211
  v_mfma_f32_16x16x32_bf16 v[72:75], v[172:175], a[88:91], v[72:75]
  v_rcp_f32_e64 v86, v86
  v_mfma_f32_16x16x32_bf16 v[72:75], v[156:159], a[72:75], v[72:75]
  v_exp_f32 v87, -v87
  v_mfma_f32_16x16x32_bf16 v[68:71], v[156:159], a[68:71], v[68:71]
  s_mov_b32 s89, s37
  ds_read_b64_tr_b16 v[164:165], v2 offset:58368
  v_mul_f32 v102, v102, v86
  v_mfma_f32_16x16x32_bf16 v[68:71], v[172:175], a[84:87], v[68:71]
  ds_read_b64_tr_b16 v[166:167], v2 offset:58880
  v_add_f32_e64 v87, 1.0, v87
  v_mfma_f32_16x16x32_bf16 v[64:67], v[172:175], a[80:83], v[64:67]
  buffer_load_dwordx4 v1, s[12:15], s57 offen offset:1024 lds
  v_mfma_f32_16x16x32_bf16 v[64:67], v[156:159], a[64:67], v[64:67]
  s_waitcnt lgkmcnt(4)
  v_rcp_f32 v87, v87
  v_mfma_f32_16x16x32_bf16 v[16:19], v[144:147], a[96:99], v[16:19]
  s_cmp_eq_u32 s29, 5
  v_mul_f32 v103, v103, v87
  v_cvt_pk_bf16_f32 v229, v102, v103
  v_mfma_f32_16x16x32_bf16 v[16:19], v[160:163], a[112:115], v[16:19]
  s_cselect_b32 s58, s59, 0x7f000000
  ds_read_b64_tr_b16 v[152:153], v3 offset:49152
  v_fma_f32 v212, v116, v116, s32
  v_mfma_f32_16x16x32_bf16 v[20:23], v[160:163], a[116:119], v[20:23]
  s_cmp_eq_u32 s29, 5
  ds_read_b64_tr_b16 v[154:155], v3 offset:49664
  v_add_u32 v1, s31, v1
  v_mfma_f32_16x16x32_bf16 v[20:23], v[144:147], a[100:103], v[20:23]
  s_cselect_b32 s10, 0, s10
  v_mul_f32 v132, v116, v132
  v_fma_f32 v213, v117, v117, s32
  v_mfma_f32_16x16x32_bf16 v[24:27], v[144:147], a[104:107], v[24:27]
  s_cselect_b32 s14, 0, s14
  ds_read_b64_tr_b16 v[168:169], v3 offset:57344
  v_mul_f32 v116, v116, v212
  v_mfma_f32_16x16x32_bf16 v[24:27], v[160:163], a[120:123], v[24:27]
  s_add_u32 m0, s28, 0
  ds_read_b64_tr_b16 v[170:171], v3 offset:57856
  v_mul_f32 v133, v117, v133
  v_mfma_f32_16x16x32_bf16 v[28:31], v[160:163], a[124:127], v[28:31]
  buffer_load_dwordx4 v1, s[8:11], s40 offen lds
  v_mfma_f32_16x16x32_bf16 v[28:31], v[144:147], a[108:111], v[28:31]
  s_waitcnt lgkmcnt(4)
  v_exp_f32 v116, -v116
  v_mfma_f32_16x16x32_bf16 v[44:47], v[148:151], a[108:111], v[44:47]
  ds_read_b64_tr_b16 v[156:157], v3 offset:50176
  v_add_f32 v116, 1.0, v116
  v_mfma_f32_16x16x32_bf16 v[44:47], v[164:167], a[124:127], v[44:47]
  ds_read_b64_tr_b16 v[158:159], v3 offset:50688
  v_mul_f32_e64 v117, v117, v213
  v_mfma_f32_16x16x32_bf16 v[40:43], v[164:167], a[120:123], v[40:43]
  buffer_load_dword v253, v13, s[84:87], s58 offen
  v_mfma_f32_16x16x32_bf16 v[40:43], v[148:151], a[104:107], v[40:43]
  v_rcp_f32_e64 v116, v116
  v_mfma_f32_16x16x32_bf16 v[36:39], v[148:151], a[100:103], v[36:39]
  ds_read_b64_tr_b16 v[172:173], v3 offset:58368
  v_mul_f32_e64 v132, v132, v116
  v_mfma_f32_16x16x32_bf16 v[36:39], v[164:167], a[116:119], v[36:39]
  ds_read_b64_tr_b16 v[174:175], v3 offset:58880
  v_fma_f32 v214, v118, v118, s32
  v_mfma_f32_16x16x32_bf16 v[32:35], v[164:167], a[112:115], v[32:35]
  buffer_load_dwordx4 v1, s[12:15], s40 offen offset:1024 lds
  v_mfma_f32_16x16x32_bf16 v[32:35], v[148:151], a[96:99], v[32:35]
  s_waitcnt lgkmcnt(4)
  v_exp_f32 v117, -v117
  v_mfma_f32_16x16x32_bf16 v[48:51], v[152:155], a[96:99], v[48:51]
  v_add_f32 v117, 1.0, v117
  v_mul_f32_e64 v134, v118, v134
  v_mfma_f32_16x16x32_bf16 v[48:51], v[168:171], a[112:115], v[48:51]
  ds_read_b64_tr_b16 v[144:145], v4 offset:0
  v_mul_f32_e64 v118, v118, v214
  v_mfma_f32_16x16x32_bf16 v[52:55], v[168:171], a[116:119], v[52:55]
  ds_read_b64_tr_b16 v[146:147], v4 offset:512
  v_fma_f32 v215, v119, v119, s32
  v_mfma_f32_16x16x32_bf16 v[52:55], v[152:155], a[100:103], v[52:55]
  v_rcp_f32_e64 v117, v117
  v_mfma_f32_16x16x32_bf16 v[56:59], v[152:155], a[104:107], v[56:59]
  ds_read_b64_tr_b16 v[160:161], v4 offset:8192
  v_mul_f32_e64 v133, v133, v117
  v_mfma_f32_16x16x32_bf16 v[56:59], v[168:171], a[120:123], v[56:59]
  s_add_u32 m0, s28, 8192
  ds_read_b64_tr_b16 v[162:163], v4 offset:8704
  v_cvt_pk_bf16_f32 v230, v132, v133
  v_mfma_f32_16x16x32_bf16 v[60:63], v[168:171], a[124:127], v[60:63]
  buffer_load_dwordx4 v1, s[8:11], s41 offen lds
  v_mfma_f32_16x16x32_bf16 v[60:63], v[152:155], a[108:111], v[60:63]
  s_waitcnt lgkmcnt(4)
  v_exp_f32 v118, -v118
  v_mfma_f32_16x16x32_bf16 v[76:79], v[156:159], a[108:111], v[76:79]
  s_lshl_b32 s91, s31, 4
  ds_read_b64_tr_b16 v[148:149], v4 offset:1024
  v_add_f32_e64 v118, 1.0, v118
  v_mfma_f32_16x16x32_bf16 v[76:79], v[172:175], a[124:127], v[76:79]
  s_add_u32 s37, s37, s91
  ds_read_b64_tr_b16 v[150:151], v4 offset:1536
  v_mul_f32 v135, v119, v135
  v_mfma_f32_16x16x32_bf16 v[72:75], v[172:175], a[120:123], v[72:75]
  v_rcp_f32_e64 v118, v118
  v_mfma_f32_16x16x32_bf16 v[72:75], v[156:159], a[104:107], v[72:75]
  v_mul_f32 v134, v134, v118
  v_mul_f32 v119, v119, v215
  v_mfma_f32_16x16x32_bf16 v[68:71], v[156:159], a[100:103], v[68:71]
  s_sub_u32 s31, s88, s31
  ds_read_b64_tr_b16 v[164:165], v4 offset:9216
  v_fma_f32 v208, v88, v88, s32
  v_mfma_f32_16x16x32_bf16 v[68:71], v[172:175], a[116:119], v[68:71]
  ds_read_b64_tr_b16 v[166:167], v4 offset:9728
  v_mul_f32 v104, v88, v104
  v_mfma_f32_16x16x32_bf16 v[64:67], v[172:175], a[112:115], v[64:67]
  buffer_load_dwordx4 v1, s[12:15], s41 offen offset:1024 lds
  v_mfma_f32_16x16x32_bf16 v[64:67], v[156:159], a[96:99], v[64:67]
  s_waitcnt lgkmcnt(4)
  v_exp_f32 v119, -v119
  v_mfma_f32_16x16x32_bf16 v[16:19], v[144:147], a[128:131], v[16:19]
  v_add_f32 v119, 1.0, v119
  v_mul_f32_e64 v88, v88, v208
  v_mfma_f32_16x16x32_bf16 v[16:19], v[160:163], a[144:147], v[16:19]
  s_add_u32 s58, s58, 73728
  ds_read_b64_tr_b16 v[152:153], v5 offset:0
  v_fma_f32 v209, v89, v89, s32
  v_mfma_f32_16x16x32_bf16 v[20:23], v[160:163], a[148:151], v[20:23]
  ds_read_b64_tr_b16 v[154:155], v5 offset:512
  v_mul_f32_e64 v105, v89, v105
  v_mfma_f32_16x16x32_bf16 v[20:23], v[144:147], a[132:135], v[20:23]
  v_rcp_f32_e64 v119, v119
  v_mfma_f32_16x16x32_bf16 v[24:27], v[144:147], a[136:139], v[24:27]
  ds_read_b64_tr_b16 v[168:169], v5 offset:8192
  v_mul_f32_e64 v135, v135, v119
  v_mfma_f32_16x16x32_bf16 v[24:27], v[160:163], a[152:155], v[24:27]
  s_add_u32 m0, s28, 16384
  ds_read_b64_tr_b16 v[170:171], v5 offset:8704
  v_cvt_pk_bf16_f32 v231, v134, v135
  v_mfma_f32_16x16x32_bf16 v[28:31], v[160:163], a[156:159], v[28:31]
  buffer_load_dwordx4 v1, s[8:11], s42 offen lds
  v_mfma_f32_16x16x32_bf16 v[28:31], v[144:147], a[140:143], v[28:31]
  s_waitcnt lgkmcnt(4)
  v_exp_f32 v88, -v88
  v_mfma_f32_16x16x32_bf16 v[44:47], v[148:151], a[140:143], v[44:47]
  ds_read_b64_tr_b16 v[156:157], v5 offset:1024
  v_add_f32 v88, 1.0, v88
  v_mfma_f32_16x16x32_bf16 v[44:47], v[164:167], a[156:159], v[44:47]
  ds_read_b64_tr_b16 v[158:159], v5 offset:1536
  v_mul_f32_e64 v89, v89, v209
  v_mfma_f32_16x16x32_bf16 v[40:43], v[164:167], a[152:155], v[40:43]
  buffer_store_dwordx4 v[228:231], v8, s[16:19], s78 offen sc1
  v_mfma_f32_16x16x32_bf16 v[40:43], v[148:151], a[136:139], v[40:43]
  v_rcp_f32_e64 v88, v88
  v_mfma_f32_16x16x32_bf16 v[36:39], v[148:151], a[132:135], v[36:39]
  ds_read_b64_tr_b16 v[172:173], v5 offset:9216
  v_mul_f32_e64 v104, v104, v88
  v_mfma_f32_16x16x32_bf16 v[36:39], v[164:167], a[148:151], v[36:39]
  ds_read_b64_tr_b16 v[174:175], v5 offset:9728
  v_fma_f32 v210, v90, v90, s32
  v_mfma_f32_16x16x32_bf16 v[32:35], v[164:167], a[144:147], v[32:35]
  buffer_load_dwordx4 v1, s[12:15], s42 offen offset:1024 lds
  v_mfma_f32_16x16x32_bf16 v[32:35], v[148:151], a[128:131], v[32:35]
  s_waitcnt lgkmcnt(4)
  v_exp_f32 v89, -v89
  v_mfma_f32_16x16x32_bf16 v[48:51], v[152:155], a[128:131], v[48:51]
  v_add_f32 v89, 1.0, v89
  v_mul_f32_e64 v106, v90, v106
  v_mfma_f32_16x16x32_bf16 v[48:51], v[168:171], a[144:147], v[48:51]
  ds_read_b64_tr_b16 v[144:145], v4 offset:16384
  v_mul_f32_e64 v90, v90, v210
  v_mfma_f32_16x16x32_bf16 v[52:55], v[168:171], a[148:151], v[52:55]
  ds_read_b64_tr_b16 v[146:147], v4 offset:16896
  v_fma_f32 v211, v91, v91, s32
  v_mfma_f32_16x16x32_bf16 v[52:55], v[152:155], a[132:135], v[52:55]
  v_rcp_f32_e64 v89, v89
  v_mfma_f32_16x16x32_bf16 v[56:59], v[152:155], a[136:139], v[56:59]
  ds_read_b64_tr_b16 v[160:161], v4 offset:24576
  v_mul_f32_e64 v105, v105, v89
  v_mfma_f32_16x16x32_bf16 v[56:59], v[168:171], a[152:155], v[56:59]
  s_add_u32 m0, s28, 24576
  ds_read_b64_tr_b16 v[162:163], v4 offset:25088
  v_cvt_pk_bf16_f32 v224, v104, v105
  v_mfma_f32_16x16x32_bf16 v[60:63], v[168:171], a[156:159], v[60:63]
  buffer_load_dwordx4 v1, s[8:11], s43 offen lds
  v_mfma_f32_16x16x32_bf16 v[60:63], v[152:155], a[140:143], v[60:63]
  s_waitcnt lgkmcnt(4)
  v_exp_f32 v90, -v90
  v_mfma_f32_16x16x32_bf16 v[76:79], v[156:159], a[140:143], v[76:79]
  ds_read_b64_tr_b16 v[148:149], v4 offset:17408
  v_add_f32 v90, 1.0, v90
  v_mfma_f32_16x16x32_bf16 v[76:79], v[172:175], a[156:159], v[76:79]
  ds_read_b64_tr_b16 v[150:151], v4 offset:17920
  v_mul_f32_e64 v107, v91, v107
  v_mfma_f32_16x16x32_bf16 v[72:75], v[172:175], a[152:155], v[72:75]
  v_rcp_f32_e64 v90, v90
  v_mfma_f32_16x16x32_bf16 v[72:75], v[156:159], a[136:139], v[72:75]
  v_mul_f32 v106, v106, v90
  v_mul_f32 v91, v91, v211
  v_mfma_f32_16x16x32_bf16 v[68:71], v[156:159], a[132:135], v[68:71]
  ds_read_b64_tr_b16 v[164:165], v4 offset:25600
  v_fma_f32 v212, v120, v120, s32
  v_mfma_f32_16x16x32_bf16 v[68:71], v[172:175], a[148:151], v[68:71]
  ds_read_b64_tr_b16 v[166:167], v4 offset:26112
  v_mul_f32_e64 v136, v120, v136
  v_mfma_f32_16x16x32_bf16 v[64:67], v[172:175], a[144:147], v[64:67]
  buffer_load_dwordx4 v1, s[12:15], s43 offen offset:1024 lds
  v_mfma_f32_16x16x32_bf16 v[64:67], v[156:159], a[128:131], v[64:67]
  s_waitcnt lgkmcnt(4)
  v_exp_f32 v91, -v91
  v_mfma_f32_16x16x32_bf16 v[16:19], v[144:147], a[160:163], v[16:19]
  v_add_f32 v91, 1.0, v91
  v_mul_f32_e64 v120, v120, v212
  v_mfma_f32_16x16x32_bf16 v[16:19], v[160:163], a[176:179], v[16:19]
  ds_read_b64_tr_b16 v[152:153], v5 offset:16384
  v_fma_f32 v213, v121, v121, s32
  v_mfma_f32_16x16x32_bf16 v[20:23], v[160:163], a[180:183], v[20:23]
  ds_read_b64_tr_b16 v[154:155], v5 offset:16896
  v_mul_f32_e64 v137, v121, v137
  v_mfma_f32_16x16x32_bf16 v[20:23], v[144:147], a[164:167], v[20:23]
  v_rcp_f32_e64 v91, v91
  v_mfma_f32_16x16x32_bf16 v[24:27], v[144:147], a[168:171], v[24:27]
  ds_read_b64_tr_b16 v[168:169], v5 offset:24576
  v_mul_f32_e64 v107, v107, v91
  v_mfma_f32_16x16x32_bf16 v[24:27], v[160:163], a[184:187], v[24:27]
  s_add_u32 m0, s28, 32768
  ds_read_b64_tr_b16 v[170:171], v5 offset:25088
  v_cvt_pk_bf16_f32 v225, v106, v107
  v_mfma_f32_16x16x32_bf16 v[28:31], v[160:163], a[188:191], v[28:31]
  buffer_load_dwordx4 v1, s[8:11], s44 offen lds
  v_mfma_f32_16x16x32_bf16 v[28:31], v[144:147], a[172:175], v[28:31]
  s_waitcnt lgkmcnt(4)
  v_exp_f32 v120, -v120
  v_mfma_f32_16x16x32_bf16 v[44:47], v[148:151], a[172:175], v[44:47]
  ds_read_b64_tr_b16 v[156:157], v5 offset:17408
  v_add_f32 v120, 1.0, v120
  v_mfma_f32_16x16x32_bf16 v[44:47], v[164:167], a[188:191], v[44:47]
  ds_read_b64_tr_b16 v[158:159], v5 offset:17920
  v_mul_f32_e64 v121, v121, v213
  v_mfma_f32_16x16x32_bf16 v[40:43], v[164:167], a[184:187], v[40:43]
  v_rcp_f32_e64 v120, v120
  v_mfma_f32_16x16x32_bf16 v[40:43], v[148:151], a[168:171], v[40:43]
  v_exp_f32 v121, -v121
  v_mfma_f32_16x16x32_bf16 v[36:39], v[148:151], a[164:167], v[36:39]
  ds_read_b64_tr_b16 v[172:173], v5 offset:25600
  v_mul_f32_e64 v136, v136, v120
  v_mfma_f32_16x16x32_bf16 v[36:39], v[164:167], a[180:183], v[36:39]
  ds_read_b64_tr_b16 v[174:175], v5 offset:26112
  v_add_f32_e64 v121, 1.0, v121
  v_mfma_f32_16x16x32_bf16 v[32:35], v[164:167], a[176:179], v[32:35]
  buffer_load_dwordx4 v1, s[12:15], s44 offen offset:1024 lds
  v_mfma_f32_16x16x32_bf16 v[32:35], v[148:151], a[160:163], v[32:35]
  s_waitcnt vmcnt(11) lgkmcnt(4)
  v_rcp_f32 v121, v121
  v_mfma_f32_16x16x32_bf16 v[48:51], v[152:155], a[160:163], v[48:51]
  s_barrier
  v_mfma_f32_16x16x32_bf16 v[48:51], v[168:171], a[176:179], v[48:51]
  ds_read_b64_tr_b16 v[144:145], v4 offset:32768
  v_mul_f32 v137, v137, v121
  v_mfma_f32_16x16x32_bf16 v[52:55], v[168:171], a[180:183], v[52:55]
  ds_read_b64_tr_b16 v[146:147], v4 offset:33280
  v_add_u32_e64 v219, 1, v219
  v_mfma_f32_16x16x32_bf16 v[52:55], v[152:155], a[164:167], v[52:55]
  buffer_store_dword v219, v216, s[20:23], s36 offen sc1
  v_mfma_f32_16x16x32_bf16 v[56:59], v[152:155], a[168:171], v[56:59]
  ds_read_b64_tr_b16 v[160:161], v4 offset:40960
  v_cvt_pk_bf16_f32 v226, v136, v137
  v_mfma_f32_16x16x32_bf16 v[56:59], v[168:171], a[184:187], v[56:59]
  s_add_u32 m0, s28, 40960
  ds_read_b64_tr_b16 v[162:163], v4 offset:41472
  v_fma_f32 v214, v122, v122, s32
  v_mfma_f32_16x16x32_bf16 v[60:63], v[168:171], a[188:191], v[60:63]
  buffer_load_dwordx4 v1, s[8:11], s45 offen lds
  v_mfma_f32_16x16x32_bf16 v[60:63], v[152:155], a[172:175], v[60:63]
  s_waitcnt lgkmcnt(4)
  v_mul_f32 v138, v122, v138
  v_fma_f32 v215, v123, v123, s32
  v_mfma_f32_16x16x32_bf16 v[76:79], v[156:159], a[172:175], v[76:79]
  ds_read_b64_tr_b16 v[148:149], v4 offset:33792
  v_mul_f32_e64 v122, v122, v214
  v_mfma_f32_16x16x32_bf16 v[76:79], v[172:175], a[188:191], v[76:79]
  ds_read_b64_tr_b16 v[150:151], v4 offset:34304
  v_mul_f32_e64 v139, v123, v139
  v_mfma_f32_16x16x32_bf16 v[72:75], v[172:175], a[184:187], v[72:75]
  v_exp_f32 v122, -v122
  v_mfma_f32_16x16x32_bf16 v[72:75], v[156:159], a[168:171], v[72:75]
  v_add_f32 v122, 1.0, v122
  v_mul_f32 v123, v123, v215
  v_mfma_f32_16x16x32_bf16 v[68:71], v[156:159], a[164:167], v[68:71]
  ds_read_b64_tr_b16 v[164:165], v4 offset:41984
  v_fma_f32 v208, v92, v92, s32
  v_mfma_f32_16x16x32_bf16 v[68:71], v[172:175], a[180:183], v[68:71]
  ds_read_b64_tr_b16 v[166:167], v4 offset:42496
  v_mul_f32_e64 v108, v92, v108
  v_mfma_f32_16x16x32_bf16 v[64:67], v[172:175], a[176:179], v[64:67]
  buffer_load_dwordx4 v1, s[12:15], s45 offen offset:1024 lds
  v_mfma_f32_16x16x32_bf16 v[64:67], v[156:159], a[160:163], v[64:67]
  s_waitcnt lgkmcnt(4)
  v_rcp_f32 v122, v122
  v_mfma_f32_16x16x32_bf16 v[16:19], v[144:147], a[192:195], v[16:19]
  v_exp_f32 v123, -v123
  v_mfma_f32_16x16x32_bf16 v[16:19], v[160:163], a[208:211], v[16:19]
  ds_read_b64_tr_b16 v[152:153], v5 offset:32768
  v_mul_f32_e64 v138, v138, v122
  v_mfma_f32_16x16x32_bf16 v[20:23], v[160:163], a[212:215], v[20:23]
  ds_read_b64_tr_b16 v[154:155], v5 offset:33280
  v_add_f32_e64 v123, 1.0, v123
  v_mfma_f32_16x16x32_bf16 v[20:23], v[144:147], a[196:199], v[20:23]
  buffer_load_dword v253, v13, s[84:87], s58 offen
  v_mfma_f32_16x16x32_bf16 v[24:27], v[144:147], a[200:203], v[24:27]
  ds_read_b64_tr_b16 v[168:169], v5 offset:40960
  v_mul_f32_e64 v92, v92, v208
  v_mfma_f32_16x16x32_bf16 v[24:27], v[160:163], a[216:219], v[24:27]
  s_add_u32 m0, s28, 49152
  ds_read_b64_tr_b16 v[170:171], v5 offset:41472
  v_fma_f32 v209, v93, v93, s32
  v_mfma_f32_16x16x32_bf16 v[28:31], v[160:163], a[220:223], v[28:31]
  buffer_load_dwordx4 v1, s[8:11], s46 offen lds
  v_mfma_f32_16x16x32_bf16 v[28:31], v[144:147], a[204:207], v[28:31]
  s_waitcnt lgkmcnt(4)
  v_rcp_f32 v123, v123
  v_mfma_f32_16x16x32_bf16 v[44:47], v[148:151], a[204:207], v[44:47]
  ds_read_b64_tr_b16 v[156:157], v5 offset:33792
  v_mul_f32_e64 v139, v139, v123
  v_mfma_f32_16x16x32_bf16 v[44:47], v[164:167], a[220:223], v[44:47]
L_pg4:
  s_cbranch_execz L_pg8
  ds_read_b64_tr_b16 v[158:159], v5 offset:34304
  v_cvt_pk_bf16_f32 v227, v138, v139
  v_mfma_f32_16x16x32_bf16 v[40:43], v[164:167], a[216:219], v[40:43]
  buffer_store_dwordx4 v[224:227], v8, s[16:19], s79 offen sc1
  v_mfma_f32_16x16x32_bf16 v[40:43], v[148:151], a[200:203], v[40:43]
  v_exp_f32 v92, -v92
  v_mfma_f32_16x16x32_bf16 v[36:39], v[148:151], a[196:199], v[36:39]
  ds_read_b64_tr_b16 v[172:173], v5 offset:41984
  v_add_f32 v92, 1.0, v92
  v_mfma_f32_16x16x32_bf16 v[36:39], v[164:167], a[212:215], v[36:39]
  ds_read_b64_tr_b16 v[174:175], v5 offset:42496
  v_mul_f32_e64 v109, v93, v109
  v_mfma_f32_16x16x32_bf16 v[32:35], v[164:167], a[208:211], v[32:35]
  buffer_load_dwordx4 v1, s[12:15], s46 offen offset:1024 lds
  v_mfma_f32_16x16x32_bf16 v[32:35], v[148:151], a[192:195], v[32:35]
  s_waitcnt lgkmcnt(4)
  v_rcp_f32 v92, v92
  v_mfma_f32_16x16x32_bf16 v[48:51], v[152:155], a[192:195], v[48:51]
  v_mul_f32 v108, v108, v92
  v_mul_f32 v93, v93, v209
  v_mfma_f32_16x16x32_bf16 v[48:51], v[168:171], a[208:211], v[48:51]
  ds_read_b64_tr_b16 v[144:145], v4 offset:49152
  v_fma_f32 v210, v94, v94, s32
  v_mfma_f32_16x16x32_bf16 v[52:55], v[168:171], a[212:215], v[52:55]
  ds_read_b64_tr_b16 v[146:147], v4 offset:49664
  v_mul_f32_e64 v110, v94, v110
  v_mfma_f32_16x16x32_bf16 v[52:55], v[152:155], a[196:199], v[52:55]
  v_exp_f32 v93, -v93
  v_mfma_f32_16x16x32_bf16 v[56:59], v[152:155], a[200:203], v[56:59]
  ds_read_b64_tr_b16 v[160:161], v4 offset:57344
  v_add_f32_e64 v93, 1.0, v93
  v_mfma_f32_16x16x32_bf16 v[56:59], v[168:171], a[216:219], v[56:59]
  s_add_u32 m0, s28, 57344
  ds_read_b64_tr_b16 v[162:163], v4 offset:57856
  v_mul_f32_e64 v94, v94, v210
  v_mfma_f32_16x16x32_bf16 v[60:63], v[168:171], a[220:223], v[60:63]
  buffer_load_dwordx4 v1, s[8:11], s47 offen lds
  v_mfma_f32_16x16x32_bf16 v[60:63], v[152:155], a[204:207], v[60:63]
  s_waitcnt lgkmcnt(4)
  v_rcp_f32 v93, v93
  v_mfma_f32_16x16x32_bf16 v[76:79], v[156:159], a[204:207], v[76:79]
  ds_read_b64_tr_b16 v[148:149], v4 offset:50176
  v_mul_f32_e64 v109, v109, v93
  v_mfma_f32_16x16x32_bf16 v[76:79], v[172:175], a[220:223], v[76:79]
  ds_read_b64_tr_b16 v[150:151], v4 offset:50688
  v_cvt_pk_bf16_f32 v228, v108, v109
  v_mfma_f32_16x16x32_bf16 v[72:75], v[172:175], a[216:219], v[72:75]
  global_load_dword v253, v14, s[68:69]
  v_mfma_f32_16x16x32_bf16 v[72:75], v[156:159], a[200:203], v[72:75]
  v_exp_f32 v94, -v94
  v_mfma_f32_16x16x32_bf16 v[68:71], v[156:159], a[196:199], v[68:71]
  ds_read_b64_tr_b16 v[164:165], v4 offset:58368
  v_add_f32_e64 v94, 1.0, v94
  v_mfma_f32_16x16x32_bf16 v[68:71], v[172:175], a[212:215], v[68:71]
  ds_read_b64_tr_b16 v[166:167], v4 offset:58880
  v_fma_f32 v211, v95, v95, s32
  v_mfma_f32_16x16x32_bf16 v[64:67], v[172:175], a[208:211], v[64:67]
  buffer_load_dwordx4 v1, s[12:15], s47 offen offset:1024 lds
  v_mfma_f32_16x16x32_bf16 v[64:67], v[156:159], a[192:195], v[64:67]
  s_waitcnt lgkmcnt(4)
  v_rcp_f32 v94, v94
  v_mfma_f32_16x16x32_bf16 v[16:19], v[144:147], a[224:227], v[16:19]
  v_mul_f32 v110, v110, v94
  v_mul_f32 v111, v95, v111
  v_mfma_f32_16x16x32_bf16 v[16:19], v[160:163], a[240:243], v[16:19]
  ds_read_b64_tr_b16 v[152:153], v5 offset:49152
  v_mul_f32_e64 v95, v95, v211
  v_mfma_f32_16x16x32_bf16 v[20:23], v[160:163], a[244:247], v[20:23]
  ds_read_b64_tr_b16 v[154:155], v5 offset:49664
  v_fma_f32 v212, v124, v124, s32
  v_mfma_f32_16x16x32_bf16 v[20:23], v[144:147], a[228:231], v[20:23]
  v_exp_f32 v95, -v95
  v_mfma_f32_16x16x32_bf16 v[24:27], v[144:147], a[232:235], v[24:27]
  ds_read_b64_tr_b16 v[168:169], v5 offset:57344
  v_add_f32_e64 v95, 1.0, v95
  v_mfma_f32_16x16x32_bf16 v[24:27], v[160:163], a[248:251], v[24:27]
  s_add_u32 m0, s28, 65536
  ds_read_b64_tr_b16 v[170:171], v5 offset:57856
  v_mul_f32_e64 v140, v124, v140
  v_mfma_f32_16x16x32_bf16 v[28:31], v[160:163], a[252:255], v[28:31]
  buffer_load_dwordx4 v1, s[8:11], s48 offen lds
  v_mfma_f32_16x16x32_bf16 v[28:31], v[144:147], a[236:239], v[28:31]
  s_waitcnt lgkmcnt(4)
  v_rcp_f32 v95, v95
  v_mfma_f32_16x16x32_bf16 v[44:47], v[148:151], a[236:239], v[44:47]
  ds_read_b64_tr_b16 v[156:157], v5 offset:50176
  v_mul_f32_e64 v111, v111, v95
  v_mfma_f32_16x16x32_bf16 v[44:47], v[164:167], a[252:255], v[44:47]
  ds_read_b64_tr_b16 v[158:159], v5 offset:50688
  v_cvt_pk_bf16_f32 v229, v110, v111
  v_mfma_f32_16x16x32_bf16 v[40:43], v[164:167], a[248:251], v[40:43]
  v_mul_f32_e64 v124, v124, v212
  v_fma_f32 v213, v125, v125, s32
  v_mfma_f32_16x16x32_bf16 v[40:43], v[148:151], a[232:235], v[40:43]
  v_exp_f32 v124, -v124
  v_mfma_f32_16x16x32_bf16 v[36:39], v[148:151], a[228:231], v[36:39]
  ds_read_b64_tr_b16 v[172:173], v5 offset:58368
  v_add_f32_e64 v124, 1.0, v124
  v_mfma_f32_16x16x32_bf16 v[36:39], v[164:167], a[244:247], v[36:39]
  ds_read_b64_tr_b16 v[174:175], v5 offset:58880
  v_mul_f32_e64 v141, v125, v141
  v_mfma_f32_16x16x32_bf16 v[32:35], v[164:167], a[240:243], v[32:35]
  buffer_load_dwordx4 v1, s[12:15], s48 offen offset:1024 lds
  v_mfma_f32_16x16x32_bf16 v[32:35], v[148:151], a[224:227], v[32:35]
  s_waitcnt lgkmcnt(4)
  v_rcp_f32 v124, v124
  v_mfma_f32_16x16x32_bf16 v[48:51], v[152:155], a[224:227], v[48:51]
  v_mul_f32 v140, v140, v124
  v_mul_f32 v125, v125, v213
  v_mfma_f32_16x16x32_bf16 v[48:51], v[168:171], a[240:243], v[48:51]
  ds_read_b64_tr_b16 v[144:145], v6 offset:0
  v_fma_f32 v214, v126, v126, s32
  v_mfma_f32_16x16x32_bf16 v[52:55], v[168:171], a[244:247], v[52:55]
  ds_read_b64_tr_b16 v[146:147], v6 offset:512
  v_mul_f32_e64 v142, v126, v142
  v_mfma_f32_16x16x32_bf16 v[52:55], v[152:155], a[228:231], v[52:55]
  buffer_store_dwordx4 v[232:235], v9, s[20:23], s64 offen offset:2048 sc1
  v_mfma_f32_16x16x32_bf16 v[56:59], v[152:155], a[232:235], v[56:59]
  s_mov_b32 s33, s64
  ds_read_b64_tr_b16 v[160:161], v6 offset:8192
  v_mul_f32 v126, v126, v214
  v_mfma_f32_16x16x32_bf16 v[56:59], v[168:171], a[248:251], v[56:59]
  s_add_u32 m0, s28, 73728
  ds_read_b64_tr_b16 v[162:163], v6 offset:8704
  v_fma_f32 v215, v127, v127, s32
  v_mfma_f32_16x16x32_bf16 v[60:63], v[168:171], a[252:255], v[60:63]
  buffer_load_dwordx4 v1, s[8:11], s49 offen lds
  v_mfma_f32_16x16x32_bf16 v[60:63], v[152:155], a[236:239], v[60:63]
  s_waitcnt lgkmcnt(4)
  v_exp_f32 v125, -v125
  v_mfma_f32_16x16x32_bf16 v[76:79], v[156:159], a[236:239], v[76:79]
  s_mov_b32 s64, s65
  ds_read_b64_tr_b16 v[148:149], v6 offset:1024
  v_add_f32_e64 v125, 1.0, v125
  v_mfma_f32_16x16x32_bf16 v[76:79], v[172:175], a[252:255], v[76:79]
  s_mov_b32 s65, s66
  ds_read_b64_tr_b16 v[150:151], v6 offset:1536
  v_mul_f32 v143, v127, v143
  v_mfma_f32_16x16x32_bf16 v[72:75], v[172:175], a[248:251], v[72:75]
  v_rcp_f32_e64 v125, v125
  v_mfma_f32_16x16x32_bf16 v[72:75], v[156:159], a[232:235], v[72:75]
  v_exp_f32 v126, -v126
  v_mfma_f32_16x16x32_bf16 v[68:71], v[156:159], a[228:231], v[68:71]
  s_mov_b32 s66, s33
  ds_read_b64_tr_b16 v[164:165], v6 offset:9216
  v_mul_f32 v141, v141, v125
  v_mfma_f32_16x16x32_bf16 v[68:71], v[172:175], a[244:247], v[68:71]
  ds_read_b64_tr_b16 v[166:167], v6 offset:9728
  v_cvt_pk_bf16_f32 v230, v140, v141
  v_mfma_f32_16x16x32_bf16 v[64:67], v[172:175], a[240:243], v[64:67]
  buffer_load_dwordx4 v1, s[12:15], s49 offen offset:1024 lds
  v_mfma_f32_16x16x32_bf16 v[64:67], v[156:159], a[224:227], v[64:67]
  s_waitcnt lgkmcnt(4)
  v_add_f32 v126, 1.0, v126
  v_mul_f32_e64 v127, v127, v215
  v_mfma_f32_16x16x32_bf16 v[16:19], v[144:147], v[176:179], v[16:19]
  v_rcp_f32_e64 v126, v126
  v_mfma_f32_16x16x32_bf16 v[80:83], v[160:163], v[192:195], v[16:19]
  ds_read_b64_tr_b16 v[152:153], v7 offset:0
  v_mul_f32_e64 v142, v142, v126
  v_mfma_f32_16x16x32_bf16 v[20:23], v[160:163], v[196:199], v[20:23]
  ds_read_b64_tr_b16 v[154:155], v7 offset:512
  v_mfma_f32_16x16x32_bf16 v[84:87], v[144:147], v[180:183], v[20:23]
  buffer_load_dword v253, v15, s[84:87], s72 offen
  v_mfma_f32_16x16x32_bf16 v[24:27], v[144:147], v[184:187], v[24:27]
  ds_read_b64_tr_b16 v[168:169], v7 offset:8192
  v_mfma_f32_16x16x32_bf16 v[88:91], v[160:163], v[200:203], v[24:27]
  s_add_u32 m0, s28, 81920
  ds_read_b64_tr_b16 v[170:171], v7 offset:8704
  v_mfma_f32_16x16x32_bf16 v[28:31], v[160:163], v[204:207], v[28:31]
  buffer_load_dwordx4 v1, s[8:11], s50 offen lds
  v_mfma_f32_16x16x32_bf16 v[92:95], v[144:147], v[188:191], v[28:31]
  s_waitcnt lgkmcnt(4)
  v_exp_f32 v127, -v127
  v_mfma_f32_16x16x32_bf16 v[44:47], v[148:151], v[188:191], v[44:47]
  s_add_u32 s72, s72, 368640
  ds_read_b64_tr_b16 v[156:157], v7 offset:1024
  v_add_f32 v127, 1.0, v127
  v_mfma_f32_16x16x32_bf16 v[108:111], v[164:167], v[204:207], v[44:47]
  ds_read_b64_tr_b16 v[158:159], v7 offset:1536
  v_mfma_f32_16x16x32_bf16 v[40:43], v[164:167], v[200:203], v[40:43]
  v_rcp_f32_e64 v127, v127
  v_mfma_f32_16x16x32_bf16 v[104:107], v[148:151], v[184:187], v[40:43]
  v_mul_f32_e64 v143, v143, v127
  v_cvt_pk_bf16_f32 v231, v142, v143
  v_mfma_f32_16x16x32_bf16 v[36:39], v[148:151], v[180:183], v[36:39]
  ds_read_b64_tr_b16 v[172:173], v7 offset:9216
  v_mfma_f32_16x16x32_bf16 v[100:103], v[164:167], v[196:199], v[36:39]
  ds_read_b64_tr_b16 v[174:175], v7 offset:9728
  v_mfma_f32_16x16x32_bf16 v[32:35], v[164:167], v[192:195], v[32:35]
  buffer_load_dwordx4 v1, s[12:15], s50 offen offset:1024 lds
  v_mfma_f32_16x16x32_bf16 v[96:99], v[148:151], v[176:179], v[32:35]
  s_waitcnt vmcnt(11) lgkmcnt(4)
  v_mfma_f32_16x16x32_bf16 v[48:51], v[152:155], v[176:179], v[48:51]
  s_barrier
  v_mfma_f32_16x16x32_bf16 v[112:115], v[168:171], v[192:195], v[48:51]
  ds_read_b64_tr_b16 v[144:145], v2 offset:0
  v_mfma_f32_16x16x32_bf16 v[52:55], v[168:171], v[196:199], v[52:55]
  ds_read_b64_tr_b16 v[146:147], v2 offset:512
  v_mfma_f32_16x16x32_bf16 v[116:119], v[152:155], v[180:183], v[52:55]
  buffer_store_dwordx4 v[228:231], v8, s[16:19], s80 offen sc1
  v_mfma_f32_16x16x32_bf16 v[56:59], v[152:155], v[184:187], v[56:59]
  ds_read_b64_tr_b16 v[160:161], v2 offset:8192
  v_mfma_f32_16x16x32_bf16 v[120:123], v[168:171], v[200:203], v[56:59]
  s_add_u32 m0, s28, 90112
  ds_read_b64_tr_b16 v[162:163], v2 offset:8704
  v_mfma_f32_16x16x32_bf16 v[60:63], v[168:171], v[204:207], v[60:63]
  buffer_load_dwordx4 v1, s[8:11], s51 offen lds
  v_mfma_f32_16x16x32_bf16 v[124:127], v[152:155], v[188:191], v[60:63]
  s_waitcnt lgkmcnt(4)
  v_mfma_f32_16x16x32_bf16 v[76:79], v[156:159], v[188:191], v[76:79]
  ds_read_b64_tr_b16 v[148:149], v2 offset:1024
  v_mfma_f32_16x16x32_bf16 v[140:143], v[172:175], v[204:207], v[76:79]
  ds_read_b64_tr_b16 v[150:151], v2 offset:1536
  v_mfma_f32_16x16x32_bf16 v[72:75], v[172:175], v[200:203], v[72:75]
  v_mfma_f32_16x16x32_bf16 v[136:139], v[156:159], v[184:187], v[72:75]
  v_mfma_f32_16x16x32_bf16 v[68:71], v[156:159], v[180:183], v[68:71]
  ds_read_b64_tr_b16 v[164:165], v2 offset:9216
  v_mfma_f32_16x16x32_bf16 v[132:135], v[172:175], v[196:199], v[68:71]
  s_cmp_lt_u32 s29, s35
  ds_read_b64_tr_b16 v[166:167], v2 offset:9728
  v_mfma_f32_16x16x32_bf16 v[64:67], v[172:175], v[192:195], v[64:67]
  buffer_load_dwordx4 v1, s[12:15], s51 offen offset:1024 lds
  v_mfma_f32_16x16x32_bf16 v[128:131], v[156:159], v[176:179], v[64:67]
  s_waitcnt lgkmcnt(4)
  s_cbranch_scc1 L_g1_loop
  s_cmp_eq_u32 s82, 3
  s_cbranch_scc1 L_prole
  v_mfma_f32_16x16x32_bf16 v[16:19], v[144:147], a[0:3], 0
  s_add_u32 s30, s89, s92
  v_fma_f32 v208, v80, v80, s32
  v_fma_f32 v209, v81, v81, s32
  v_mfma_f32_16x16x32_bf16 v[16:19], v[160:163], a[16:19], v[16:19]
  ds_read_b64_tr_b16 v[152:153], v3 offset:0
  v_mul_f32 v96, v80, v96
  v_mul_f32_e64 v97, v81, v97
  v_mfma_f32_16x16x32_bf16 v[20:23], v[160:163], a[20:23], 0
  ds_read_b64_tr_b16 v[154:155], v3 offset:512
  v_mul_f32_e64 v80, v80, v208
  v_mfma_f32_16x16x32_bf16 v[20:23], v[144:147], a[4:7], v[20:23]
  buffer_load_dword v218, v220, s[4:7], 0 offen sc1
  v_mfma_f32_16x16x32_bf16 v[24:27], v[144:147], a[8:11], 0
  ds_read_b64_tr_b16 v[168:169], v3 offset:8192
  v_mul_f32_e64 v81, v81, v209
  v_mfma_f32_16x16x32_bf16 v[24:27], v[160:163], a[24:27], v[24:27]
  s_add_u32 m0, s28, 98304
  ds_read_b64_tr_b16 v[170:171], v3 offset:8704
  v_fma_f32 v210, v82, v82, s32
  v_mfma_f32_16x16x32_bf16 v[28:31], v[160:163], a[28:31], 0
  buffer_load_dwordx4 v1, s[8:11], s52 offen lds
  v_mfma_f32_16x16x32_bf16 v[28:31], v[144:147], a[12:15], v[28:31]
  s_waitcnt lgkmcnt(4)
  v_exp_f32 v80, -v80
  v_mfma_f32_16x16x32_bf16 v[44:47], v[148:151], a[12:15], 0
  ds_read_b64_tr_b16 v[156:157], v3 offset:1024
  v_add_f32 v80, 1.0, v80
  v_mfma_f32_16x16x32_bf16 v[44:47], v[164:167], a[28:31], v[44:47]
  ds_read_b64_tr_b16 v[158:159], v3 offset:1536
  v_mul_f32_e64 v98, v82, v98
  v_mfma_f32_16x16x32_bf16 v[40:43], v[164:167], a[24:27], 0
  v_rcp_f32_e64 v80, v80
  v_mfma_f32_16x16x32_bf16 v[40:43], v[148:151], a[8:11], v[40:43]
  v_exp_f32 v81, -v81
  v_mfma_f32_16x16x32_bf16 v[36:39], v[148:151], a[4:7], 0
  ds_read_b64_tr_b16 v[172:173], v3 offset:9216
  v_mul_f32_e64 v96, v96, v80
  v_mfma_f32_16x16x32_bf16 v[36:39], v[164:167], a[20:23], v[36:39]
  ds_read_b64_tr_b16 v[174:175], v3 offset:9728
  v_add_f32 v81, 1.0, v81
  v_mul_f32 v82, v82, v210
  v_mfma_f32_16x16x32_bf16 v[32:35], v[164:167], a[16:19], 0
  buffer_load_dwordx4 v1, s[12:15], s52 offen offset:1024 lds
  v_mfma_f32_16x16x32_bf16 v[32:35], v[148:151], a[0:3], v[32:35]
  s_waitcnt lgkmcnt(4)
  v_rcp_f32 v81, v81
  v_mfma_f32_16x16x32_bf16 v[48:51], v[152:155], a[0:3], 0
  v_exp_f32 v82, -v82
  v_mfma_f32_16x16x32_bf16 v[48:51], v[168:171], a[16:19], v[48:51]
  s_add_u32 s78, s89, s93
  ds_read_b64_tr_b16 v[144:145], v2 offset:16384
  v_mul_f32 v97, v97, v81
  v_mfma_f32_16x16x32_bf16 v[52:55], v[168:171], a[20:23], 0
  s_add_u32 s79, s89, s94
  ds_read_b64_tr_b16 v[146:147], v2 offset:16896
  v_cvt_pk_bf16_f32 v224, v96, v97
  v_mfma_f32_16x16x32_bf16 v[52:55], v[152:155], a[4:7], v[52:55]
  v_add_f32 v82, 1.0, v82
  v_fma_f32 v211, v83, v83, s32
  v_mfma_f32_16x16x32_bf16 v[56:59], v[152:155], a[8:11], 0
  s_add_u32 s80, s89, s95
  ds_read_b64_tr_b16 v[160:161], v2 offset:24576
  v_mul_f32 v99, v83, v99
  v_mfma_f32_16x16x32_bf16 v[56:59], v[168:171], a[24:27], v[56:59]
  s_add_u32 m0, s28, 106496
  ds_read_b64_tr_b16 v[162:163], v2 offset:25088
  v_mul_f32_e64 v83, v83, v211
  v_mfma_f32_16x16x32_bf16 v[60:63], v[168:171], a[28:31], 0
  buffer_load_dwordx4 v1, s[8:11], s53 offen lds
  v_mfma_f32_16x16x32_bf16 v[60:63], v[152:155], a[12:15], v[60:63]
  s_waitcnt lgkmcnt(4)
  v_rcp_f32 v82, v82
  v_mfma_f32_16x16x32_bf16 v[76:79], v[156:159], a[12:15], 0
  ds_read_b64_tr_b16 v[148:149], v2 offset:17408
  v_mul_f32_e64 v98, v98, v82
  v_mfma_f32_16x16x32_bf16 v[76:79], v[172:175], a[28:31], v[76:79]
  ds_read_b64_tr_b16 v[150:151], v2 offset:17920
  v_fma_f32 v212, v112, v112, s32
  v_mfma_f32_16x16x32_bf16 v[72:75], v[172:175], a[24:27], 0
  v_exp_f32 v83, -v83
  v_mfma_f32_16x16x32_bf16 v[72:75], v[156:159], a[8:11], v[72:75]
  v_add_f32 v83, 1.0, v83
  v_mul_f32 v128, v112, v128
  v_mfma_f32_16x16x32_bf16 v[68:71], v[156:159], a[4:7], 0
  ds_read_b64_tr_b16 v[164:165], v2 offset:25600
  v_rcp_f32_e64 v83, v83
  v_mfma_f32_16x16x32_bf16 v[68:71], v[172:175], a[20:23], v[68:71]
  ds_read_b64_tr_b16 v[166:167], v2 offset:26112
  v_mul_f32_e64 v99, v99, v83
  v_mfma_f32_16x16x32_bf16 v[64:67], v[172:175], a[16:19], 0
  buffer_load_dwordx4 v1, s[12:15], s53 offen offset:1024 lds
  v_mfma_f32_16x16x32_bf16 v[64:67], v[156:159], a[0:3], v[64:67]
  s_waitcnt lgkmcnt(4)
  v_cvt_pk_bf16_f32 v225, v98, v99
  v_mul_f32 v112, v112, v212
  v_mfma_f32_16x16x32_bf16 v[16:19], v[144:147], a[32:35], v[16:19]
  v_exp_f32 v112, -v112
  v_mfma_f32_16x16x32_bf16 v[16:19], v[160:163], a[48:51], v[16:19]
  ds_read_b64_tr_b16 v[152:153], v3 offset:16384
  v_add_f32_e64 v112, 1.0, v112
  v_mfma_f32_16x16x32_bf16 v[20:23], v[160:163], a[52:55], v[20:23]
  ds_read_b64_tr_b16 v[154:155], v3 offset:16896
  v_fma_f32 v213, v113, v113, s32
  v_mfma_f32_16x16x32_bf16 v[20:23], v[144:147], a[36:39], v[20:23]
  v_rcp_f32_e64 v112, v112
  v_mfma_f32_16x16x32_bf16 v[24:27], v[144:147], a[40:43], v[24:27]
  ds_read_b64_tr_b16 v[168:169], v3 offset:24576
  v_mul_f32_e64 v128, v128, v112
  v_mfma_f32_16x16x32_bf16 v[24:27], v[160:163], a[56:59], v[24:27]
  s_add_u32 m0, s28, 114688
  ds_read_b64_tr_b16 v[170:171], v3 offset:25088
  v_mul_f32_e64 v129, v113, v129
  v_mfma_f32_16x16x32_bf16 v[28:31], v[160:163], a[60:63], v[28:31]
  buffer_load_dwordx4 v1, s[8:11], s54 offen lds
  v_mfma_f32_16x16x32_bf16 v[28:31], v[144:147], a[44:47], v[28:31]
  s_waitcnt lgkmcnt(4)
  v_mul_f32 v113, v113, v213
  v_fma_f32 v214, v114, v114, s32
  v_mfma_f32_16x16x32_bf16 v[44:47], v[148:151], a[44:47], v[44:47]
  ds_read_b64_tr_b16 v[156:157], v3 offset:17408
  v_mul_f32_e64 v130, v114, v130
  v_mfma_f32_16x16x32_bf16 v[44:47], v[164:167], a[60:63], v[44:47]
  ds_read_b64_tr_b16 v[158:159], v3 offset:17920
  v_exp_f32 v113, -v113
  v_mfma_f32_16x16x32_bf16 v[40:43], v[164:167], a[56:59], v[40:43]
  v_add_f32 v113, 1.0, v113
  v_mul_f32 v114, v114, v214
  v_mfma_f32_16x16x32_bf16 v[40:43], v[148:151], a[40:43], v[40:43]
  v_rcp_f32_e64 v113, v113
  v_mfma_f32_16x16x32_bf16 v[36:39], v[148:151], a[36:39], v[36:39]
  ds_read_b64_tr_b16 v[172:173], v3 offset:25600
  v_mul_f32_e64 v129, v129, v113
  v_mfma_f32_16x16x32_bf16 v[36:39], v[164:167], a[52:55], v[36:39]
  ds_read_b64_tr_b16 v[174:175], v3 offset:26112
  v_cvt_pk_bf16_f32 v226, v128, v129
  v_mfma_f32_16x16x32_bf16 v[32:35], v[164:167], a[48:51], v[32:35]
  buffer_load_dwordx4 v1, s[12:15], s54 offen offset:1024 lds
  v_mfma_f32_16x16x32_bf16 v[32:35], v[148:151], a[32:35], v[32:35]
  s_waitcnt lgkmcnt(4)
  v_exp_f32 v114, -v114
  v_mfma_f32_16x16x32_bf16 v[48:51], v[152:155], a[32:35], v[48:51]
  v_add_f32 v114, 1.0, v114
  v_fma_f32 v215, v115, v115, s32
  v_mfma_f32_16x16x32_bf16 v[48:51], v[168:171], a[48:51], v[48:51]
  ds_read_b64_tr_b16 v[144:145], v2 offset:32768
  v_mul_f32_e64 v131, v115, v131
  v_mfma_f32_16x16x32_bf16 v[52:55], v[168:171], a[52:55], v[52:55]
  ds_read_b64_tr_b16 v[146:147], v2 offset:33280
  v_mul_f32_e64 v115, v115, v215
  v_mfma_f32_16x16x32_bf16 v[52:55], v[152:155], a[36:39], v[52:55]
  v_rcp_f32_e64 v114, v114
  v_mfma_f32_16x16x32_bf16 v[56:59], v[152:155], a[40:43], v[56:59]
  ds_read_b64_tr_b16 v[160:161], v2 offset:40960
  v_mul_f32_e64 v130, v130, v114
  v_mfma_f32_16x16x32_bf16 v[56:59], v[168:171], a[56:59], v[56:59]
  s_add_u32 m0, s28, 122880
  ds_read_b64_tr_b16 v[162:163], v2 offset:41472
  v_fma_f32 v208, v84, v84, s32
  v_mfma_f32_16x16x32_bf16 v[60:63], v[168:171], a[60:63], v[60:63]
  buffer_load_dwordx4 v1, s[8:11], s55 offen lds
  v_mfma_f32_16x16x32_bf16 v[60:63], v[152:155], a[44:47], v[60:63]
  s_waitcnt lgkmcnt(4)
  v_exp_f32 v115, -v115
  v_mfma_f32_16x16x32_bf16 v[76:79], v[156:159], a[44:47], v[76:79]
  ds_read_b64_tr_b16 v[148:149], v2 offset:33792
  v_add_f32 v115, 1.0, v115
  v_mul_f32_e64 v100, v84, v100
  v_mfma_f32_16x16x32_bf16 v[76:79], v[172:175], a[60:63], v[76:79]
  ds_read_b64_tr_b16 v[150:151], v2 offset:34304
  v_mul_f32_e64 v84, v84, v208
  v_mfma_f32_16x16x32_bf16 v[72:75], v[172:175], a[56:59], v[72:75]
  v_and_b32 v223, 15, v221
  v_lshrrev_b32 v221, 4, v221
  v_mfma_f32_16x16x32_bf16 v[72:75], v[156:159], a[40:43], v[72:75]
  v_rcp_f32_e64 v115, v115
  v_mfma_f32_16x16x32_bf16 v[68:71], v[156:159], a[36:39], v[68:71]
  ds_read_b64_tr_b16 v[164:165], v2 offset:41984
  v_mul_f32_e64 v131, v131, v115
  v_mfma_f32_16x16x32_bf16 v[68:71], v[172:175], a[52:55], v[68:71]
  ds_read_b64_tr_b16 v[166:167], v2 offset:42496
  v_cvt_pk_bf16_f32 v227, v130, v131
  v_mfma_f32_16x16x32_bf16 v[64:67], v[172:175], a[48:51], v[64:67]
  buffer_load_dwordx4 v1, s[12:15], s55 offen offset:1024 lds
  v_mfma_f32_16x16x32_bf16 v[64:67], v[156:159], a[32:35], v[64:67]
  s_waitcnt lgkmcnt(4)
  v_exp_f32 v84, -v84
  v_mfma_f32_16x16x32_bf16 v[16:19], v[144:147], a[64:67], v[16:19]
  v_readlane_b32 s62, v222, 0
  v_add_f32 v84, 1.0, v84
  v_mfma_f32_16x16x32_bf16 v[16:19], v[160:163], a[80:83], v[16:19]
  s_lshl_b32 s60, s62, 10
  ds_read_b64_tr_b16 v[152:153], v3 offset:32768
  v_fma_f32 v209, v85, v85, s32
  v_mfma_f32_16x16x32_bf16 v[20:23], v[160:163], a[84:87], v[20:23]
  ds_read_b64_tr_b16 v[154:155], v3 offset:33280
  v_mul_f32 v101, v85, v101
  v_mfma_f32_16x16x32_bf16 v[20:23], v[144:147], a[68:71], v[20:23]
  buffer_store_dwordx4 v[224:227], v8, s[16:19], s30 offen sc1
  v_mfma_f32_16x16x32_bf16 v[24:27], v[144:147], a[72:75], v[24:27]
  ds_read_b64_tr_b16 v[168:169], v3 offset:40960
  v_rcp_f32_e64 v84, v84
  v_mfma_f32_16x16x32_bf16 v[24:27], v[160:163], a[88:91], v[24:27]
  s_add_u32 m0, s28, 131072
  ds_read_b64_tr_b16 v[170:171], v3 offset:41472
  v_mul_f32_e64 v100, v100, v84
  v_mfma_f32_16x16x32_bf16 v[28:31], v[160:163], a[92:95], v[28:31]
  buffer_load_dwordx4 v1, s[8:11], s56 offen lds
  v_mfma_f32_16x16x32_bf16 v[28:31], v[144:147], a[76:79], v[28:31]
  s_waitcnt lgkmcnt(4)
  v_mul_f32 v85, v85, v209
  v_fma_f32 v210, v86, v86, s32
  v_mfma_f32_16x16x32_bf16 v[44:47], v[148:151], a[76:79], v[44:47]
  ds_read_b64_tr_b16 v[156:157], v3 offset:33792
  v_mul_f32_e64 v102, v86, v102
  v_mfma_f32_16x16x32_bf16 v[44:47], v[164:167], a[92:95], v[44:47]
  ds_read_b64_tr_b16 v[158:159], v3 offset:34304
  v_mul_f32_e64 v86, v86, v210
  v_mfma_f32_16x16x32_bf16 v[40:43], v[164:167], a[88:91], v[40:43]
  v_exp_f32 v85, -v85
  v_mfma_f32_16x16x32_bf16 v[40:43], v[148:151], a[72:75], v[40:43]
  v_exp_f32 v86, -v86
  v_mfma_f32_16x16x32_bf16 v[36:39], v[148:151], a[68:71], v[36:39]
  ds_read_b64_tr_b16 v[172:173], v3 offset:41984
  v_add_f32_e64 v85, 1.0, v85
  v_mfma_f32_16x16x32_bf16 v[36:39], v[164:167], a[84:87], v[36:39]
  ds_read_b64_tr_b16 v[174:175], v3 offset:42496
  v_add_f32_e64 v86, 1.0, v86
  v_mfma_f32_16x16x32_bf16 v[32:35], v[164:167], a[80:83], v[32:35]
  buffer_load_dwordx4 v1, s[12:15], s56 offen offset:1024 lds
  v_mfma_f32_16x16x32_bf16 v[32:35], v[148:151], a[64:67], v[32:35]
  s_waitcnt vmcnt(10) lgkmcnt(4)
  v_rcp_f32 v85, v85
  v_mfma_f32_16x16x32_bf16 v[48:51], v[152:155], a[64:67], v[48:51]
  s_barrier
  v_mfma_f32_16x16x32_bf16 v[48:51], v[168:171], a[80:83], v[48:51]
  ds_read_b64_tr_b16 v[144:145], v2 offset:49152
  v_mul_f32 v101, v101, v85
  v_mfma_f32_16x16x32_bf16 v[52:55], v[168:171], a[84:87], v[52:55]
  ds_read_b64_tr_b16 v[146:147], v2 offset:49664
  v_rcp_f32_e64 v86, v86
  v_mfma_f32_16x16x32_bf16 v[52:55], v[152:155], a[68:71], v[52:55]
  v_cvt_pk_bf16_f32 v228, v100, v101
  v_mul_f32_e64 v102, v102, v86
  v_mfma_f32_16x16x32_bf16 v[56:59], v[152:155], a[72:75], v[56:59]
  ds_read_b64_tr_b16 v[160:161], v2 offset:57344
  v_fma_f32 v211, v87, v87, s32
  v_mfma_f32_16x16x32_bf16 v[56:59], v[168:171], a[88:91], v[56:59]
  s_add_u32 m0, s28, 139264
  ds_read_b64_tr_b16 v[162:163], v2 offset:57856
  v_mul_f32_e64 v103, v87, v103
  v_mfma_f32_16x16x32_bf16 v[60:63], v[168:171], a[92:95], v[60:63]
  buffer_load_dwordx4 v1, s[8:11], s57 offen lds
  v_mfma_f32_16x16x32_bf16 v[60:63], v[152:155], a[76:79], v[60:63]
  s_waitcnt lgkmcnt(4)
  v_mul_f32 v87, v87, v211
  v_fma_f32 v212, v116, v116, s32
  v_mfma_f32_16x16x32_bf16 v[76:79], v[156:159], a[76:79], v[76:79]
  s_waitcnt vmcnt(11)
  ds_read_b64_tr_b16 v[148:149], v2 offset:50176
  v_cmp_gt_u32 vcc, v223, v218
  v_mfma_f32_16x16x32_bf16 v[76:79], v[172:175], a[92:95], v[76:79]
  s_cbranch_vccnz L_g_sp1
L_g_bk1:
  ds_read_b64_tr_b16 v[150:151], v2 offset:50688
  v_mul_f32 v132, v116, v132
  v_mfma_f32_16x16x32_bf16 v[72:75], v[172:175], a[88:91], v[72:75]
  v_exp_f32 v87, -v87
  v_mfma_f32_16x16x32_bf16 v[72:75], v[156:159], a[72:75], v[72:75]
  v_add_f32 v87, 1.0, v87
  v_mul_f32 v116, v116, v212
  v_mfma_f32_16x16x32_bf16 v[68:71], v[156:159], a[68:71], v[68:71]
  s_mov_b32 s89, s37
  ds_read_b64_tr_b16 v[164:165], v2 offset:58368
  v_fma_f32 v213, v117, v117, s32
  v_mfma_f32_16x16x32_bf16 v[68:71], v[172:175], a[84:87], v[68:71]
  ds_read_b64_tr_b16 v[166:167], v2 offset:58880
  v_mul_f32 v133, v117, v133
  v_mfma_f32_16x16x32_bf16 v[64:67], v[172:175], a[80:83], v[64:67]
  buffer_load_dwordx4 v1, s[12:15], s57 offen offset:1024 lds
  v_mfma_f32_16x16x32_bf16 v[64:67], v[156:159], a[64:67], v[64:67]
  s_waitcnt lgkmcnt(4)
  v_rcp_f32 v87, v87
  v_mfma_f32_16x16x32_bf16 v[16:19], v[144:147], a[96:99], v[16:19]
  buffer_load_dwordx4 a[0:3], v239, s[16:19], s60 offen sc1
  v_mfma_f32_16x16x32_bf16 v[16:19], v[160:163], a[112:115], v[16:19]
  s_mul_i32 s61, s62, 36864
  ds_read_b64_tr_b16 v[152:153], v3 offset:49152
  v_mul_f32_e64 v103, v103, v87
  v_mfma_f32_16x16x32_bf16 v[20:23], v[160:163], a[116:119], v[20:23]
  ds_read_b64_tr_b16 v[154:155], v3 offset:49664
  v_exp_f32 v116, -v116
  v_mfma_f32_16x16x32_bf16 v[20:23], v[144:147], a[100:103], v[20:23]
  v_cvt_pk_bf16_f32 v229, v102, v103
  v_add_f32_e64 v116, 1.0, v116
  v_mfma_f32_16x16x32_bf16 v[24:27], v[144:147], a[104:107], v[24:27]
  ds_read_b64_tr_b16 v[168:169], v3 offset:57344
  v_mul_f32_e64 v117, v117, v213
  v_mfma_f32_16x16x32_bf16 v[24:27], v[160:163], a[120:123], v[24:27]
  ds_read_b64_tr_b16 v[170:171], v3 offset:57856
  v_fma_f32 v214, v118, v118, s32
  v_mfma_f32_16x16x32_bf16 v[28:31], v[160:163], a[124:127], v[28:31]
  buffer_load_dwordx4 a[4:7], v240, s[16:19], s60 offen sc1
  v_mfma_f32_16x16x32_bf16 v[28:31], v[144:147], a[108:111], v[28:31]
  s_waitcnt lgkmcnt(4)
  v_rcp_f32 v116, v116
  v_mfma_f32_16x16x32_bf16 v[44:47], v[148:151], a[108:111], v[44:47]
  s_add_u32 m0, s63, 0
  ds_read_b64_tr_b16 v[156:157], v3 offset:50176
  v_readlane_b32 s62, v222, 1
  v_mfma_f32_16x16x32_bf16 v[44:47], v[164:167], a[124:127], v[44:47]
  ds_read_b64_tr_b16 v[158:159], v3 offset:50688
  v_mul_f32 v132, v132, v116
  v_mfma_f32_16x16x32_bf16 v[40:43], v[164:167], a[120:123], v[40:43]
  buffer_load_dwordx4 v236, s[84:87], s61 offen lds
  v_mfma_f32_16x16x32_bf16 v[40:43], v[148:151], a[104:107], v[40:43]
  s_lshl_b32 s60, s62, 10
  v_exp_f32 v117, -v117
  v_mfma_f32_16x16x32_bf16 v[36:39], v[148:151], a[100:103], v[36:39]
  ds_read_b64_tr_b16 v[172:173], v3 offset:58368
  v_add_f32 v117, 1.0, v117
  v_mfma_f32_16x16x32_bf16 v[36:39], v[164:167], a[116:119], v[36:39]
  ds_read_b64_tr_b16 v[174:175], v3 offset:58880
  v_mul_f32_e64 v134, v118, v134
  v_mfma_f32_16x16x32_bf16 v[32:35], v[164:167], a[112:115], v[32:35]
  buffer_load_dwordx4 v237, s[84:87], s61 offen offset:1024 lds
  v_mfma_f32_16x16x32_bf16 v[32:35], v[148:151], a[96:99], v[32:35]
  s_waitcnt lgkmcnt(4)
  v_rcp_f32 v117, v117
  v_mfma_f32_16x16x32_bf16 v[48:51], v[152:155], a[96:99], v[48:51]
  v_mul_f32_e64 v133, v133, v117
  v_cvt_pk_bf16_f32 v230, v132, v133
  v_mfma_f32_16x16x32_bf16 v[48:51], v[168:171], a[112:115], v[48:51]
L_pg5:
  s_cbranch_execz L_pg9
  ds_read_b64_tr_b16 v[144:145], v4 offset:0
  v_mul_f32 v118, v118, v214
  v_mfma_f32_16x16x32_bf16 v[52:55], v[168:171], a[116:119], v[52:55]
  ds_read_b64_tr_b16 v[146:147], v4 offset:512
  v_exp_f32 v118, -v118
  v_mfma_f32_16x16x32_bf16 v[52:55], v[152:155], a[100:103], v[52:55]
  buffer_load_dwordx4 v238, s[84:87], s61 offen offset:2048 lds
  v_mfma_f32_16x16x32_bf16 v[56:59], v[152:155], a[104:107], v[56:59]
  ds_read_b64_tr_b16 v[160:161], v4 offset:8192
  v_add_f32_e64 v118, 1.0, v118
  v_mfma_f32_16x16x32_bf16 v[56:59], v[168:171], a[120:123], v[56:59]
  ds_read_b64_tr_b16 v[162:163], v4 offset:8704
  v_fma_f32 v215, v119, v119, s32
  v_mfma_f32_16x16x32_bf16 v[60:63], v[168:171], a[124:127], v[60:63]
  v_rcp_f32_e64 v118, v118
  v_mfma_f32_16x16x32_bf16 v[60:63], v[152:155], a[108:111], v[60:63]
  s_waitcnt lgkmcnt(4)
  v_mul_f32 v134, v134, v118
  v_mul_f32_e64 v135, v119, v135
  v_mfma_f32_16x16x32_bf16 v[76:79], v[156:159], a[108:111], v[76:79]
  ds_read_b64_tr_b16 v[148:149], v4 offset:1024
  v_mul_f32_e64 v119, v119, v215
  v_mfma_f32_16x16x32_bf16 v[76:79], v[172:175], a[124:127], v[76:79]
  ds_read_b64_tr_b16 v[150:151], v4 offset:1536
  v_fma_f32 v208, v88, v88, s32
  v_mfma_f32_16x16x32_bf16 v[72:75], v[172:175], a[120:123], v[72:75]
  buffer_load_dwordx4 a[8:11], v239, s[16:19], s60 offen sc1
  v_mfma_f32_16x16x32_bf16 v[72:75], v[156:159], a[104:107], v[72:75]
  s_mul_i32 s61, s62, 36864
  v_exp_f32 v119, -v119
  v_mfma_f32_16x16x32_bf16 v[68:71], v[156:159], a[100:103], v[68:71]
  ds_read_b64_tr_b16 v[164:165], v4 offset:9216
  v_add_f32_e64 v119, 1.0, v119
  v_mfma_f32_16x16x32_bf16 v[68:71], v[172:175], a[116:119], v[68:71]
  ds_read_b64_tr_b16 v[166:167], v4 offset:9728
  v_mul_f32_e64 v104, v88, v104
  v_mfma_f32_16x16x32_bf16 v[64:67], v[172:175], a[112:115], v[64:67]
  buffer_load_dwordx4 a[12:15], v240, s[16:19], s60 offen sc1
  v_mfma_f32_16x16x32_bf16 v[64:67], v[156:159], a[96:99], v[64:67]
  s_waitcnt lgkmcnt(4)
  v_rcp_f32 v119, v119
  v_mfma_f32_16x16x32_bf16 v[16:19], v[144:147], a[128:131], v[16:19]
  s_add_u32 m0, s63, 12288
  v_readlane_b32 s62, v222, 2
  v_mul_f32_e64 v135, v135, v119
  v_cvt_pk_bf16_f32 v231, v134, v135
  v_mfma_f32_16x16x32_bf16 v[16:19], v[160:163], a[144:147], v[16:19]
  ds_read_b64_tr_b16 v[152:153], v5 offset:0
  v_mul_f32_e64 v88, v88, v208
  v_mfma_f32_16x16x32_bf16 v[20:23], v[160:163], a[148:151], v[20:23]
  ds_read_b64_tr_b16 v[154:155], v5 offset:512
  v_fma_f32 v209, v89, v89, s32
  v_mfma_f32_16x16x32_bf16 v[20:23], v[144:147], a[132:135], v[20:23]
  buffer_load_dwordx4 v236, s[84:87], s61 offen lds
  v_mfma_f32_16x16x32_bf16 v[24:27], v[144:147], a[136:139], v[24:27]
  s_lshl_b32 s60, s62, 10
  ds_read_b64_tr_b16 v[168:169], v5 offset:8192
  v_mul_f32 v105, v89, v105
  v_mfma_f32_16x16x32_bf16 v[24:27], v[160:163], a[152:155], v[24:27]
  ds_read_b64_tr_b16 v[170:171], v5 offset:8704
  v_mul_f32_e64 v89, v89, v209
  v_mfma_f32_16x16x32_bf16 v[28:31], v[160:163], a[156:159], v[28:31]
  buffer_load_dwordx4 v237, s[84:87], s61 offen offset:1024 lds
  v_mfma_f32_16x16x32_bf16 v[28:31], v[144:147], a[140:143], v[28:31]
  s_waitcnt lgkmcnt(4)
  v_exp_f32 v88, -v88
  v_mfma_f32_16x16x32_bf16 v[44:47], v[148:151], a[140:143], v[44:47]
  ds_read_b64_tr_b16 v[156:157], v5 offset:1024
  v_add_f32 v88, 1.0, v88
  v_mfma_f32_16x16x32_bf16 v[44:47], v[164:167], a[156:159], v[44:47]
  ds_read_b64_tr_b16 v[158:159], v5 offset:1536
  v_fma_f32 v210, v90, v90, s32
  v_mfma_f32_16x16x32_bf16 v[40:43], v[164:167], a[152:155], v[40:43]
  buffer_load_dwordx4 v238, s[84:87], s61 offen offset:2048 lds
  v_mfma_f32_16x16x32_bf16 v[40:43], v[148:151], a[136:139], v[40:43]
  buffer_store_dwordx4 v[228:231], v8, s[16:19], s78 offen sc1
  v_mfma_f32_16x16x32_bf16 v[36:39], v[148:151], a[132:135], v[36:39]
  ds_read_b64_tr_b16 v[172:173], v5 offset:9216
  v_rcp_f32_e64 v88, v88
  v_mfma_f32_16x16x32_bf16 v[36:39], v[164:167], a[148:151], v[36:39]
  ds_read_b64_tr_b16 v[174:175], v5 offset:9728
  v_mul_f32_e64 v104, v104, v88
  v_mfma_f32_16x16x32_bf16 v[32:35], v[164:167], a[144:147], v[32:35]
  v_exp_f32 v89, -v89
  v_mfma_f32_16x16x32_bf16 v[32:35], v[148:151], a[128:131], v[32:35]
  s_waitcnt lgkmcnt(4)
  v_add_f32 v89, 1.0, v89
  v_mul_f32_e64 v106, v90, v106
  v_mfma_f32_16x16x32_bf16 v[48:51], v[152:155], a[128:131], v[48:51]
  buffer_load_dwordx4 a[16:19], v239, s[16:19], s60 offen sc1
  v_mfma_f32_16x16x32_bf16 v[48:51], v[168:171], a[144:147], v[48:51]
  s_mul_i32 s61, s62, 36864
  ds_read_b64_tr_b16 v[144:145], v4 offset:16384
  v_mul_f32_e64 v90, v90, v210
  v_mfma_f32_16x16x32_bf16 v[52:55], v[168:171], a[148:151], v[52:55]
  ds_read_b64_tr_b16 v[146:147], v4 offset:16896
  v_fma_f32 v211, v91, v91, s32
  v_mfma_f32_16x16x32_bf16 v[52:55], v[152:155], a[132:135], v[52:55]
  buffer_load_dwordx4 a[20:23], v240, s[16:19], s60 offen sc1
  v_mfma_f32_16x16x32_bf16 v[56:59], v[152:155], a[136:139], v[56:59]
  s_add_u32 m0, s63, 24576
  ds_read_b64_tr_b16 v[160:161], v4 offset:24576
  v_readlane_b32 s62, v222, 3
  v_mfma_f32_16x16x32_bf16 v[56:59], v[168:171], a[152:155], v[56:59]
  ds_read_b64_tr_b16 v[162:163], v4 offset:25088
  v_mul_f32_e64 v107, v91, v107
  v_mfma_f32_16x16x32_bf16 v[60:63], v[168:171], a[156:159], v[60:63]
  v_rcp_f32_e64 v89, v89
  v_mfma_f32_16x16x32_bf16 v[60:63], v[152:155], a[140:143], v[60:63]
  s_waitcnt lgkmcnt(4)
  v_exp_f32 v90, -v90
  v_mfma_f32_16x16x32_bf16 v[76:79], v[156:159], a[140:143], v[76:79]
  ds_read_b64_tr_b16 v[148:149], v4 offset:17408
  v_mul_f32 v105, v105, v89
  v_mfma_f32_16x16x32_bf16 v[76:79], v[172:175], a[156:159], v[76:79]
  ds_read_b64_tr_b16 v[150:151], v4 offset:17920
  v_cvt_pk_bf16_f32 v224, v104, v105
  v_mfma_f32_16x16x32_bf16 v[72:75], v[172:175], a[152:155], v[72:75]
  buffer_load_dwordx4 v236, s[84:87], s61 offen lds
  v_mfma_f32_16x16x32_bf16 v[72:75], v[156:159], a[136:139], v[72:75]
  s_lshl_b32 s60, s62, 10
  v_add_f32 v90, 1.0, v90
  v_mul_f32_e64 v91, v91, v211
  v_mfma_f32_16x16x32_bf16 v[68:71], v[156:159], a[132:135], v[68:71]
  ds_read_b64_tr_b16 v[164:165], v4 offset:25600
  v_rcp_f32_e64 v90, v90
  v_mfma_f32_16x16x32_bf16 v[68:71], v[172:175], a[148:151], v[68:71]
  ds_read_b64_tr_b16 v[166:167], v4 offset:26112
  v_mul_f32_e64 v106, v106, v90
  v_mfma_f32_16x16x32_bf16 v[64:67], v[172:175], a[144:147], v[64:67]
  buffer_load_dwordx4 v237, s[84:87], s61 offen offset:1024 lds
  v_mfma_f32_16x16x32_bf16 v[64:67], v[156:159], a[128:131], v[64:67]
  s_waitcnt lgkmcnt(4)
  v_exp_f32 v91, -v91
  v_mfma_f32_16x16x32_bf16 v[16:19], v[144:147], a[160:163], v[16:19]
  v_add_f32 v91, 1.0, v91
  v_fma_f32 v212, v120, v120, s32
  v_mfma_f32_16x16x32_bf16 v[16:19], v[160:163], a[176:179], v[16:19]
  ds_read_b64_tr_b16 v[152:153], v5 offset:16384
  v_mul_f32_e64 v136, v120, v136
  v_mfma_f32_16x16x32_bf16 v[20:23], v[160:163], a[180:183], v[20:23]
  ds_read_b64_tr_b16 v[154:155], v5 offset:16896
  v_mul_f32_e64 v120, v120, v212
  v_mfma_f32_16x16x32_bf16 v[20:23], v[144:147], a[164:167], v[20:23]
  buffer_load_dwordx4 v238, s[84:87], s61 offen offset:2048 lds
  v_mfma_f32_16x16x32_bf16 v[24:27], v[144:147], a[168:171], v[24:27]
  ds_read_b64_tr_b16 v[168:169], v5 offset:24576
  v_fma_f32 v213, v121, v121, s32
  v_mfma_f32_16x16x32_bf16 v[24:27], v[160:163], a[184:187], v[24:27]
  ds_read_b64_tr_b16 v[170:171], v5 offset:25088
  v_mul_f32_e64 v137, v121, v137
  v_mfma_f32_16x16x32_bf16 v[28:31], v[160:163], a[188:191], v[28:31]
  buffer_load_dwordx4 a[24:27], v239, s[16:19], s60 offen sc1
  v_mfma_f32_16x16x32_bf16 v[28:31], v[144:147], a[172:175], v[28:31]
  s_waitcnt lgkmcnt(4)
  v_rcp_f32 v91, v91
  v_mfma_f32_16x16x32_bf16 v[44:47], v[148:151], a[172:175], v[44:47]
  s_mul_i32 s61, s62, 36864
  ds_read_b64_tr_b16 v[156:157], v5 offset:17408
  v_mul_f32_e64 v107, v107, v91
  v_mfma_f32_16x16x32_bf16 v[44:47], v[164:167], a[188:191], v[44:47]
  ds_read_b64_tr_b16 v[158:159], v5 offset:17920
  v_exp_f32 v120, -v120
  v_mfma_f32_16x16x32_bf16 v[40:43], v[164:167], a[184:187], v[40:43]
  v_cvt_pk_bf16_f32 v225, v106, v107
  v_add_f32_e64 v120, 1.0, v120
  v_mfma_f32_16x16x32_bf16 v[40:43], v[148:151], a[168:171], v[40:43]
  buffer_load_dwordx4 a[28:31], v240, s[16:19], s60 offen sc1
  v_mfma_f32_16x16x32_bf16 v[36:39], v[148:151], a[164:167], v[36:39]
  s_add_u32 m0, s63, 36864
  ds_read_b64_tr_b16 v[172:173], v5 offset:25600
  v_readlane_b32 s62, v222, 4
  v_mfma_f32_16x16x32_bf16 v[36:39], v[164:167], a[180:183], v[36:39]
  ds_read_b64_tr_b16 v[174:175], v5 offset:26112
  v_mul_f32_e64 v121, v121, v213
  v_mfma_f32_16x16x32_bf16 v[32:35], v[164:167], a[176:179], v[32:35]
  v_rcp_f32_e64 v120, v120
  v_mfma_f32_16x16x32_bf16 v[32:35], v[148:151], a[160:163], v[32:35]
  s_waitcnt vmcnt(17) lgkmcnt(4)
  v_exp_f32 v121, -v121
  v_mfma_f32_16x16x32_bf16 v[48:51], v[152:155], a[160:163], v[48:51]
  s_barrier
  v_mfma_f32_16x16x32_bf16 v[48:51], v[168:171], a[176:179], v[48:51]
  ds_read_b64_tr_b16 v[144:145], v4 offset:32768
  v_mul_f32_e64 v136, v136, v120
  v_mfma_f32_16x16x32_bf16 v[52:55], v[168:171], a[180:183], v[52:55]
  ds_read_b64_tr_b16 v[146:147], v4 offset:33280
  v_add_u32_e64 v219, 1, v219
  v_mfma_f32_16x16x32_bf16 v[52:55], v[152:155], a[164:167], v[52:55]
  buffer_store_dword v219, v216, s[20:23], s36 offen sc1
  v_mfma_f32_16x16x32_bf16 v[56:59], v[152:155], a[168:171], v[56:59]
  ds_read_b64_tr_b16 v[160:161], v4 offset:40960
  v_add_f32_e64 v121, 1.0, v121
  v_mfma_f32_16x16x32_bf16 v[56:59], v[168:171], a[184:187], v[56:59]
  ds_read_b64_tr_b16 v[162:163], v4 offset:41472
  v_fma_f32 v214, v122, v122, s32
  v_mfma_f32_16x16x32_bf16 v[60:63], v[168:171], a[188:191], v[60:63]
  buffer_load_dwordx4 v236, s[84:87], s61 offen lds
  v_mfma_f32_16x16x32_bf16 v[60:63], v[152:155], a[172:175], v[60:63]
  s_waitcnt lgkmcnt(4)
  v_rcp_f32 v121, v121
  v_mfma_f32_16x16x32_bf16 v[76:79], v[156:159], a[172:175], v[76:79]
  s_lshl_b32 s60, s62, 10
  ds_read_b64_tr_b16 v[148:149], v4 offset:33792
  v_mul_f32 v137, v137, v121
  v_mfma_f32_16x16x32_bf16 v[76:79], v[172:175], a[188:191], v[76:79]
  ds_read_b64_tr_b16 v[150:151], v4 offset:34304
  v_cvt_pk_bf16_f32 v226, v136, v137
  v_mfma_f32_16x16x32_bf16 v[72:75], v[172:175], a[184:187], v[72:75]
  buffer_load_dwordx4 v237, s[84:87], s61 offen offset:1024 lds
  v_mfma_f32_16x16x32_bf16 v[72:75], v[156:159], a[168:171], v[72:75]
  buffer_load_dwordx4 v238, s[84:87], s61 offen offset:2048 lds
  v_mfma_f32_16x16x32_bf16 v[68:71], v[156:159], a[164:167], v[68:71]
  ds_read_b64_tr_b16 v[164:165], v4 offset:41984
  v_mul_f32_e64 v138, v122, v138
  v_fma_f32 v215, v123, v123, s32
  v_mfma_f32_16x16x32_bf16 v[68:71], v[172:175], a[180:183], v[68:71]
  ds_read_b64_tr_b16 v[166:167], v4 offset:42496
  v_mul_f32_e64 v122, v122, v214
  v_mfma_f32_16x16x32_bf16 v[64:67], v[172:175], a[176:179], v[64:67]
  buffer_load_dwordx4 a[32:35], v239, s[16:19], s60 offen sc1
  v_mfma_f32_16x16x32_bf16 v[64:67], v[156:159], a[160:163], v[64:67]
  s_waitcnt lgkmcnt(4)
  v_exp_f32 v122, -v122
  v_mfma_f32_16x16x32_bf16 v[16:19], v[144:147], a[192:195], v[16:19]
  s_mul_i32 s61, s62, 36864
  v_add_f32 v122, 1.0, v122
  v_mul_f32_e64 v139, v123, v139
  v_mfma_f32_16x16x32_bf16 v[16:19], v[160:163], a[208:211], v[16:19]
  ds_read_b64_tr_b16 v[152:153], v5 offset:32768
  v_mul_f32_e64 v123, v123, v215
  v_mfma_f32_16x16x32_bf16 v[20:23], v[160:163], a[212:215], v[20:23]
  ds_read_b64_tr_b16 v[154:155], v5 offset:33280
  v_fma_f32 v208, v92, v92, s32
  v_mfma_f32_16x16x32_bf16 v[20:23], v[144:147], a[196:199], v[20:23]
  buffer_load_dwordx4 a[36:39], v240, s[16:19], s60 offen sc1
  v_mfma_f32_16x16x32_bf16 v[24:27], v[144:147], a[200:203], v[24:27]
  s_add_u32 m0, s63, 49152
  ds_read_b64_tr_b16 v[168:169], v5 offset:40960
  v_readlane_b32 s62, v222, 5
  v_mfma_f32_16x16x32_bf16 v[24:27], v[160:163], a[216:219], v[24:27]
  ds_read_b64_tr_b16 v[170:171], v5 offset:41472
  v_mul_f32_e64 v108, v92, v108
  v_mfma_f32_16x16x32_bf16 v[28:31], v[160:163], a[220:223], v[28:31]
  v_rcp_f32_e64 v122, v122
  v_mfma_f32_16x16x32_bf16 v[28:31], v[144:147], a[204:207], v[28:31]
  s_waitcnt lgkmcnt(4)
  v_exp_f32 v123, -v123
  v_mfma_f32_16x16x32_bf16 v[44:47], v[148:151], a[204:207], v[44:47]
  ds_read_b64_tr_b16 v[156:157], v5 offset:33792
  v_mul_f32 v138, v138, v122
  v_mfma_f32_16x16x32_bf16 v[44:47], v[164:167], a[220:223], v[44:47]
  ds_read_b64_tr_b16 v[158:159], v5 offset:34304
  v_add_f32_e64 v123, 1.0, v123
  v_mfma_f32_16x16x32_bf16 v[40:43], v[164:167], a[216:219], v[40:43]
  buffer_load_dwordx4 v236, s[84:87], s61 offen lds
  v_mfma_f32_16x16x32_bf16 v[40:43], v[148:151], a[200:203], v[40:43]
  s_lshl_b32 s60, s62, 10
  v_rcp_f32 v123, v123
  v_mfma_f32_16x16x32_bf16 v[36:39], v[148:151], a[196:199], v[36:39]
  ds_read_b64_tr_b16 v[172:173], v5 offset:41984
  v_mul_f32_e64 v139, v139, v123
  v_cvt_pk_bf16_f32 v227, v138, v139
  v_mfma_f32_16x16x32_bf16 v[36:39], v[164:167], a[212:215], v[36:39]
  ds_read_b64_tr_b16 v[174:175], v5 offset:42496
  v_mul_f32_e64 v92, v92, v208
  v_mfma_f32_16x16x32_bf16 v[32:35], v[164:167], a[208:211], v[32:35]
  buffer_load_dwordx4 v237, s[84:87], s61 offen offset:1024 lds
  v_mfma_f32_16x16x32_bf16 v[32:35], v[148:151], a[192:195], v[32:35]
  s_waitcnt lgkmcnt(4)
  v_exp_f32 v92, -v92
  v_mfma_f32_16x16x32_bf16 v[48:51], v[152:155], a[192:195], v[48:51]
  buffer_load_dwordx4 v238, s[84:87], s61 offen offset:2048 lds
  v_mfma_f32_16x16x32_bf16 v[48:51], v[168:171], a[208:211], v[48:51]
  ds_read_b64_tr_b16 v[144:145], v4 offset:49152
  v_add_f32 v92, 1.0, v92
  v_mfma_f32_16x16x32_bf16 v[52:55], v[168:171], a[212:215], v[52:55]
  ds_read_b64_tr_b16 v[146:147], v4 offset:49664
  v_fma_f32 v209, v93, v93, s32
  v_mfma_f32_16x16x32_bf16 v[52:55], v[152:155], a[196:199], v[52:55]
  buffer_store_dwordx4 v[224:227], v8, s[16:19], s79 offen sc1
  v_mfma_f32_16x16x32_bf16 v[56:59], v[152:155], a[200:203], v[56:59]
  ds_read_b64_tr_b16 v[160:161], v4 offset:57344
  v_mul_f32_e64 v109, v93, v109
  v_mfma_f32_16x16x32_bf16 v[56:59], v[168:171], a[216:219], v[56:59]
  ds_read_b64_tr_b16 v[162:163], v4 offset:57856
  v_mul_f32_e64 v93, v93, v209
  v_mfma_f32_16x16x32_bf16 v[60:63], v[168:171], a[220:223], v[60:63]
  buffer_load_dwordx4 a[40:43], v239, s[16:19], s60 offen sc1
  v_mfma_f32_16x16x32_bf16 v[60:63], v[152:155], a[204:207], v[60:63]
  s_waitcnt lgkmcnt(4)
  v_rcp_f32 v92, v92
  v_mfma_f32_16x16x32_bf16 v[76:79], v[156:159], a[204:207], v[76:79]
  s_mul_i32 s61, s62, 36864
  ds_read_b64_tr_b16 v[148:149], v4 offset:50176
  v_mul_f32_e64 v108, v108, v92
  v_mfma_f32_16x16x32_bf16 v[76:79], v[172:175], a[220:223], v[76:79]
  ds_read_b64_tr_b16 v[150:151], v4 offset:50688
  v_exp_f32 v93, -v93
  v_mfma_f32_16x16x32_bf16 v[72:75], v[172:175], a[216:219], v[72:75]
  buffer_load_dwordx4 a[44:47], v240, s[16:19], s60 offen sc1
  v_mfma_f32_16x16x32_bf16 v[72:75], v[156:159], a[200:203], v[72:75]
  s_add_u32 m0, s63, 61440
  v_readlane_b32 s62, v222, 6
  v_add_f32_e64 v93, 1.0, v93
  v_mfma_f32_16x16x32_bf16 v[68:71], v[156:159], a[196:199], v[68:71]
  ds_read_b64_tr_b16 v[164:165], v4 offset:58368
  v_fma_f32 v210, v94, v94, s32
  v_mfma_f32_16x16x32_bf16 v[68:71], v[172:175], a[212:215], v[68:71]
  ds_read_b64_tr_b16 v[166:167], v4 offset:58880
  v_mul_f32_e64 v110, v94, v110
  v_mfma_f32_16x16x32_bf16 v[64:67], v[172:175], a[208:211], v[64:67]
  buffer_load_dwordx4 v236, s[84:87], s61 offen lds
  v_mfma_f32_16x16x32_bf16 v[64:67], v[156:159], a[192:195], v[64:67]
  s_waitcnt lgkmcnt(4)
  v_rcp_f32 v93, v93
  v_mfma_f32_16x16x32_bf16 v[16:19], v[144:147], a[224:227], v[16:19]
  s_lshl_b32 s60, s62, 10
  v_mul_f32 v109, v109, v93
  v_cvt_pk_bf16_f32 v228, v108, v109
  v_mfma_f32_16x16x32_bf16 v[16:19], v[160:163], a[240:243], v[16:19]
  ds_read_b64_tr_b16 v[152:153], v5 offset:49152
  v_mul_f32_e64 v94, v94, v210
  v_mfma_f32_16x16x32_bf16 v[20:23], v[160:163], a[244:247], v[20:23]
  ds_read_b64_tr_b16 v[154:155], v5 offset:49664
  v_fma_f32 v211, v95, v95, s32
  v_mfma_f32_16x16x32_bf16 v[20:23], v[144:147], a[228:231], v[20:23]
  buffer_load_dwordx4 v237, s[84:87], s61 offen offset:1024 lds
  v_mfma_f32_16x16x32_bf16 v[24:27], v[144:147], a[232:235], v[24:27]
  ds_read_b64_tr_b16 v[168:169], v5 offset:57344
  v_mul_f32_e64 v111, v95, v111
  v_mfma_f32_16x16x32_bf16 v[24:27], v[160:163], a[248:251], v[24:27]
  ds_read_b64_tr_b16 v[170:171], v5 offset:57856
  v_exp_f32 v94, -v94
  v_mfma_f32_16x16x32_bf16 v[28:31], v[160:163], a[252:255], v[28:31]
  v_add_f32 v94, 1.0, v94
  v_mul_f32 v95, v95, v211
  v_mfma_f32_16x16x32_bf16 v[28:31], v[144:147], a[236:239], v[28:31]
  s_waitcnt lgkmcnt(4)
  v_rcp_f32 v94, v94
  v_mfma_f32_16x16x32_bf16 v[44:47], v[148:151], a[236:239], v[44:47]
  ds_read_b64_tr_b16 v[156:157], v5 offset:50176
  v_mul_f32_e64 v110, v110, v94
  v_mfma_f32_16x16x32_bf16 v[44:47], v[164:167], a[252:255], v[44:47]
  ds_read_b64_tr_b16 v[158:159], v5 offset:50688
  v_fma_f32 v212, v124, v124, s32
  v_mfma_f32_16x16x32_bf16 v[40:43], v[164:167], a[248:251], v[40:43]
  buffer_load_dwordx4 v238, s[84:87], s61 offen offset:2048 lds
  v_mfma_f32_16x16x32_bf16 v[40:43], v[148:151], a[232:235], v[40:43]
  v_exp_f32 v95, -v95
  v_mfma_f32_16x16x32_bf16 v[36:39], v[148:151], a[228:231], v[36:39]
  ds_read_b64_tr_b16 v[172:173], v5 offset:58368
  v_add_f32_e64 v95, 1.0, v95
  v_mfma_f32_16x16x32_bf16 v[36:39], v[164:167], a[244:247], v[36:39]
  ds_read_b64_tr_b16 v[174:175], v5 offset:58880
  v_mul_f32_e64 v140, v124, v140
  v_mfma_f32_16x16x32_bf16 v[32:35], v[164:167], a[240:243], v[32:35]
  buffer_load_dwordx4 a[48:51], v239, s[16:19], s60 offen sc1
  v_mfma_f32_16x16x32_bf16 v[32:35], v[148:151], a[224:227], v[32:35]
  s_waitcnt lgkmcnt(4)
  v_rcp_f32 v95, v95
  v_mfma_f32_16x16x32_bf16 v[48:51], v[152:155], a[224:227], v[48:51]
  s_mul_i32 s61, s62, 36864
  v_mul_f32_e64 v111, v111, v95
  v_cvt_pk_bf16_f32 v229, v110, v111
  v_mfma_f32_16x16x32_bf16 v[48:51], v[168:171], a[240:243], v[48:51]
  ds_read_b64_tr_b16 v[144:145], v6 offset:0
  v_mul_f32_e64 v124, v124, v212
  v_mfma_f32_16x16x32_bf16 v[52:55], v[168:171], a[244:247], v[52:55]
  ds_read_b64_tr_b16 v[146:147], v6 offset:512
  v_fma_f32 v213, v125, v125, s32
  v_mfma_f32_16x16x32_bf16 v[52:55], v[152:155], a[228:231], v[52:55]
  buffer_load_dwordx4 a[52:55], v240, s[16:19], s60 offen sc1
  v_mfma_f32_16x16x32_bf16 v[56:59], v[152:155], a[232:235], v[56:59]
  s_add_u32 m0, s63, 73728
  ds_read_b64_tr_b16 v[160:161], v6 offset:8192
  v_readlane_b32 s62, v222, 7
  v_mfma_f32_16x16x32_bf16 v[56:59], v[168:171], a[248:251], v[56:59]
  ds_read_b64_tr_b16 v[162:163], v6 offset:8704
  v_exp_f32 v124, -v124
  v_mfma_f32_16x16x32_bf16 v[60:63], v[168:171], a[252:255], v[60:63]
  buffer_load_dwordx4 v236, s[84:87], s61 offen lds
  v_mfma_f32_16x16x32_bf16 v[60:63], v[152:155], a[236:239], v[60:63]
  s_waitcnt lgkmcnt(4)
  v_add_f32 v124, 1.0, v124
  v_mul_f32_e64 v141, v125, v141
  v_mfma_f32_16x16x32_bf16 v[76:79], v[156:159], a[236:239], v[76:79]
  s_lshl_b32 s60, s62, 10
  ds_read_b64_tr_b16 v[148:149], v6 offset:1024
  v_mul_f32 v125, v125, v213
  v_mfma_f32_16x16x32_bf16 v[76:79], v[172:175], a[252:255], v[76:79]
  ds_read_b64_tr_b16 v[150:151], v6 offset:1536
  v_fma_f32 v214, v126, v126, s32
  v_mfma_f32_16x16x32_bf16 v[72:75], v[172:175], a[248:251], v[72:75]
  v_rcp_f32_e64 v124, v124
  v_mfma_f32_16x16x32_bf16 v[72:75], v[156:159], a[232:235], v[72:75]
  buffer_load_dwordx4 v237, s[84:87], s61 offen offset:1024 lds
  v_mfma_f32_16x16x32_bf16 v[68:71], v[156:159], a[228:231], v[68:71]
  ds_read_b64_tr_b16 v[164:165], v6 offset:9216
  v_mul_f32_e64 v140, v140, v124
  v_mfma_f32_16x16x32_bf16 v[68:71], v[172:175], a[244:247], v[68:71]
  ds_read_b64_tr_b16 v[166:167], v6 offset:9728
  v_mul_f32_e64 v142, v126, v142
  v_mfma_f32_16x16x32_bf16 v[64:67], v[172:175], a[240:243], v[64:67]
  v_exp_f32 v125, -v125
  v_mfma_f32_16x16x32_bf16 v[64:67], v[156:159], a[224:227], v[64:67]
  s_waitcnt lgkmcnt(4)
  v_add_f32 v125, 1.0, v125
  v_mul_f32_e64 v126, v126, v214
  v_mfma_f32_16x16x32_bf16 v[16:19], v[144:147], v[176:179], v[16:19]
  buffer_load_dwordx4 v238, s[84:87], s61 offen offset:2048 lds
  v_mfma_f32_16x16x32_bf16 v[80:83], v[160:163], v[192:195], v[16:19]
  ds_read_b64_tr_b16 v[152:153], v7 offset:0
  v_fma_f32 v215, v127, v127, s32
  v_mfma_f32_16x16x32_bf16 v[20:23], v[160:163], v[196:199], v[20:23]
  ds_read_b64_tr_b16 v[154:155], v7 offset:512
  v_mul_f32_e64 v143, v127, v143
  v_mfma_f32_16x16x32_bf16 v[84:87], v[144:147], v[180:183], v[20:23]
  buffer_load_dword v218, v220, s[4:7], 0 offen sc1
  v_mfma_f32_16x16x32_bf16 v[24:27], v[144:147], v[184:187], v[24:27]
  ds_read_b64_tr_b16 v[168:169], v7 offset:8192
  v_mul_f32_e64 v127, v127, v215
  v_mfma_f32_16x16x32_bf16 v[88:91], v[160:163], v[200:203], v[24:27]
  ds_read_b64_tr_b16 v[170:171], v7 offset:8704
  v_mfma_f32_16x16x32_bf16 v[28:31], v[160:163], v[204:207], v[28:31]
  buffer_load_dwordx4 a[56:59], v239, s[16:19], s60 offen sc1
  v_mfma_f32_16x16x32_bf16 v[92:95], v[144:147], v[188:191], v[28:31]
  s_waitcnt lgkmcnt(4)
  v_rcp_f32 v125, v125
  v_mfma_f32_16x16x32_bf16 v[44:47], v[148:151], v[188:191], v[44:47]
  s_mul_i32 s61, s62, 36864
  ds_read_b64_tr_b16 v[156:157], v7 offset:1024
  v_mul_f32_e64 v141, v141, v125
  v_mfma_f32_16x16x32_bf16 v[108:111], v[164:167], v[204:207], v[44:47]
  ds_read_b64_tr_b16 v[158:159], v7 offset:1536
  v_cvt_pk_bf16_f32 v230, v140, v141
  v_mfma_f32_16x16x32_bf16 v[40:43], v[164:167], v[200:203], v[40:43]
  buffer_load_dwordx4 a[60:63], v240, s[16:19], s60 offen sc1
  v_mfma_f32_16x16x32_bf16 v[104:107], v[148:151], v[184:187], v[40:43]
  s_add_u32 m0, s63, 86016
  v_readlane_b32 s62, v222, 8
  v_mfma_f32_16x16x32_bf16 v[36:39], v[148:151], v[180:183], v[36:39]
  ds_read_b64_tr_b16 v[172:173], v7 offset:9216
  v_mfma_f32_16x16x32_bf16 v[100:103], v[164:167], v[196:199], v[36:39]
  ds_read_b64_tr_b16 v[174:175], v7 offset:9728
  v_mfma_f32_16x16x32_bf16 v[32:35], v[164:167], v[192:195], v[32:35]
  v_exp_f32 v126, -v126
  v_mfma_f32_16x16x32_bf16 v[96:99], v[148:151], v[176:179], v[32:35]
  s_waitcnt vmcnt(17) lgkmcnt(4)
  v_exp_f32 v127, -v127
  v_mfma_f32_16x16x32_bf16 v[48:51], v[152:155], v[176:179], v[48:51]
  s_barrier
  v_mfma_f32_16x16x32_bf16 v[112:115], v[168:171], v[192:195], v[48:51]
  buffer_load_dwordx4 v236, s[84:87], s61 offen lds
  v_mfma_f32_16x16x32_bf16 v[52:55], v[168:171], v[196:199], v[52:55]
  s_lshl_b32 s60, s62, 10
  v_add_f32 v126, 1.0, v126
  v_add_f32_e64 v127, 1.0, v127
  v_mfma_f32_16x16x32_bf16 v[116:119], v[152:155], v[180:183], v[52:55]
  buffer_load_dwordx4 v237, s[84:87], s61 offen offset:1024 lds
  v_mfma_f32_16x16x32_bf16 v[56:59], v[152:155], v[184:187], v[56:59]
  v_rcp_f32_e64 v126, v126
  v_mfma_f32_16x16x32_bf16 v[120:123], v[168:171], v[200:203], v[56:59]
  v_rcp_f32_e64 v127, v127
  v_mfma_f32_16x16x32_bf16 v[60:63], v[168:171], v[204:207], v[60:63]
  v_mul_f32 v142, v142, v126
  v_mul_f32 v143, v143, v127
  v_mfma_f32_16x16x32_bf16 v[124:127], v[152:155], v[188:191], v[60:63]
  s_waitcnt lgkmcnt(0)
  v_cvt_pk_bf16_f32 v231, v142, v143
  v_mfma_f32_16x16x32_bf16 v[76:79], v[156:159], v[188:191], v[76:79]
  buffer_load_dwordx4 v238, s[84:87], s61 offen offset:2048 lds
  v_mfma_f32_16x16x32_bf16 v[140:143], v[172:175], v[204:207], v[76:79]
  buffer_store_dwordx4 v[228:231], v8, s[16:19], s80 offen sc1
  v_mfma_f32_16x16x32_bf16 v[72:75], v[172:175], v[200:203], v[72:75]
  v_mfma_f32_16x16x32_bf16 v[136:139], v[156:159], v[184:187], v[72:75]
  v_mfma_f32_16x16x32_bf16 v[68:71], v[156:159], v[180:183], v[68:71]
  v_mfma_f32_16x16x32_bf16 v[132:135], v[172:175], v[196:199], v[68:71]
  v_mfma_f32_16x16x32_bf16 v[64:67], v[172:175], v[192:195], v[64:67]
  v_mfma_f32_16x16x32_bf16 v[128:131], v[156:159], v[176:179], v[64:67]
  s_mul_i32 s61, s62, 36864
  s_add_u32 m0, s63, 98304
  ds_read_b64_tr_b16 v[144:145], v241 offset:0
  ds_read_b64_tr_b16 v[146:147], v241 offset:6144
  s_nop 0
  ds_read_b64_tr_b16 v[148:149], v241 offset:12288
  ds_read_b64_tr_b16 v[150:151], v241 offset:18432
  ds_read_b64_tr_b16 v[152:153], v242 offset:0
  ds_read_b64_tr_b16 v[154:155], v242 offset:6144
  ds_read_b64_tr_b16 v[156:157], v242 offset:12288
  ds_read_b64_tr_b16 v[158:159], v242 offset:18432
  ds_read_b64_tr_b16 v[160:161], v243 offset:0
  ds_read_b64_tr_b16 v[162:163], v243 offset:6144
  ds_read_b64_tr_b16 v[164:165], v243 offset:12288
  ds_read_b64_tr_b16 v[166:167], v243 offset:18432
  buffer_load_dwordx4 v236, s[84:87], s61 offen lds
  buffer_load_dwordx4 v237, s[84:87], s61 offen offset:1024 lds
  buffer_load_dwordx4 v238, s[84:87], s61 offen offset:2048 lds
  s_mov_b32 s33, s32
  s_add_u32 s30, s89, s92
  s_add_u32 s78, s89, s93
  s_add_u32 s79, s89, s94
  s_add_u32 s80, s89, s95
  s_nop 0
  v_pk_fma_f32 v[208:209], v[80:81], v[80:81], s[32:33]
  v_pk_fma_f32 v[210:211], v[82:83], v[82:83], s[32:33]
  v_pk_fma_f32 v[212:213], v[112:113], v[112:113], s[32:33]
  v_pk_fma_f32 v[214:215], v[114:115], v[114:115], s[32:33]
  v_pk_mul_f32 v[96:97], v[80:81], v[96:97]
  v_pk_mul_f32 v[98:99], v[82:83], v[98:99]
  v_pk_mul_f32 v[128:129], v[112:113], v[128:129]
  v_pk_mul_f32 v[130:131], v[114:115], v[130:131]
  v_pk_mul_f32 v[80:81], v[80:81], v[208:209] neg_lo:[1,0] neg_hi:[1,0]
  v_pk_mul_f32 v[82:83], v[82:83], v[210:211] neg_lo:[1,0] neg_hi:[1,0]
  v_pk_mul_f32 v[112:113], v[112:113], v[212:213] neg_lo:[1,0] neg_hi:[1,0]
  v_pk_mul_f32 v[114:115], v[114:115], v[214:215] neg_lo:[1,0] neg_hi:[1,0]
  v_exp_f32 v80, v80
  v_exp_f32 v81, v81
  v_exp_f32 v82, v82
  v_exp_f32 v83, v83
  v_exp_f32 v112, v112
  v_exp_f32 v113, v113
  v_exp_f32 v114, v114
  v_exp_f32 v115, v115
  v_pk_add_f32 v[80:81], v[80:81], 1.0 op_sel_hi:[1,0]
  v_pk_add_f32 v[82:83], v[82:83], 1.0 op_sel_hi:[1,0]
  v_pk_add_f32 v[112:113], v[112:113], 1.0 op_sel_hi:[1,0]
  v_pk_add_f32 v[114:115], v[114:115], 1.0 op_sel_hi:[1,0]
  v_rcp_f32 v80, v80
  v_rcp_f32 v81, v81
  v_rcp_f32 v82, v82
  v_rcp_f32 v83, v83
  v_rcp_f32 v112, v112
  v_rcp_f32 v113, v113
  v_rcp_f32 v114, v114
  v_rcp_f32 v115, v115
  v_pk_mul_f32 v[96:97], v[96:97], v[80:81]
  v_pk_mul_f32 v[98:99], v[98:99], v[82:83]
  v_pk_mul_f32 v[128:129], v[128:129], v[112:113]
  v_pk_mul_f32 v[130:131], v[130:131], v[114:115]
  v_cvt_pk_bf16_f32 v224, v96, v97
  v_cvt_pk_bf16_f32 v225, v98, v99
  v_cvt_pk_bf16_f32 v226, v128, v129
  v_cvt_pk_bf16_f32 v227, v130, v131
  buffer_store_dwordx4 v[224:227], v8, s[16:19], s30 offen sc1
  v_pk_fma_f32 v[208:209], v[84:85], v[84:85], s[32:33]
  v_pk_fma_f32 v[210:211], v[86:87], v[86:87], s[32:33]
  v_pk_fma_f32 v[212:213], v[116:117], v[116:117], s[32:33]
  v_pk_fma_f32 v[214:215], v[118:119], v[118:119], s[32:33]
  v_pk_mul_f32 v[100:101], v[84:85], v[100:101]
  v_pk_mul_f32 v[102:103], v[86:87], v[102:103]
  v_pk_mul_f32 v[132:133], v[116:117], v[132:133]
  v_pk_mul_f32 v[134:135], v[118:119], v[134:135]
  v_pk_mul_f32 v[84:85], v[84:85], v[208:209] neg_lo:[1,0] neg_hi:[1,0]
  v_pk_mul_f32 v[86:87], v[86:87], v[210:211] neg_lo:[1,0] neg_hi:[1,0]
  v_pk_mul_f32 v[116:117], v[116:117], v[212:213] neg_lo:[1,0] neg_hi:[1,0]
  v_pk_mul_f32 v[118:119], v[118:119], v[214:215] neg_lo:[1,0] neg_hi:[1,0]
  v_exp_f32 v84, v84
L_pg6:
  s_cbranch_execz L_pg10
  v_exp_f32 v85, v85
  v_exp_f32 v86, v86
  v_exp_f32 v87, v87
  v_exp_f32 v116, v116
  v_exp_f32 v117, v117
  v_exp_f32 v118, v118
  v_exp_f32_e64 v119, v119
  v_pk_add_f32 v[84:85], v[84:85], 1.0 op_sel_hi:[1,0]
  v_pk_add_f32 v[86:87], v[86:87], 1.0 op_sel_hi:[1,0]
  v_pk_add_f32 v[116:117], v[116:117], 1.0 op_sel_hi:[1,0]
  v_pk_add_f32 v[118:119], v[118:119], 1.0 op_sel_hi:[1,0]
  v_rcp_f32 v84, v84
  v_rcp_f32 v85, v85
  v_rcp_f32 v86, v86
  v_rcp_f32 v87, v87
  v_rcp_f32 v116, v116
  v_rcp_f32 v117, v117
  v_rcp_f32 v118, v118
  v_rcp_f32 v119, v119
  v_pk_mul_f32 v[100:101], v[100:101], v[84:85]
  v_pk_mul_f32 v[102:103], v[102:103], v[86:87]
  v_pk_mul_f32 v[132:133], v[132:133], v[116:117]
  v_pk_mul_f32 v[134:135], v[134:135], v[118:119]
  v_cvt_pk_bf16_f32 v228, v100, v101
  v_cvt_pk_bf16_f32 v229, v102, v103
  v_cvt_pk_bf16_f32 v230, v132, v133
  v_cvt_pk_bf16_f32 v231, v134, v135
  buffer_store_dwordx4 v[228:231], v8, s[16:19], s78 offen sc1
  v_pk_fma_f32 v[208:209], v[88:89], v[88:89], s[32:33]
  v_pk_fma_f32 v[210:211], v[90:91], v[90:91], s[32:33]
  v_pk_fma_f32 v[212:213], v[120:121], v[120:121], s[32:33]
  v_pk_fma_f32 v[214:215], v[122:123], v[122:123], s[32:33]
  v_pk_mul_f32 v[104:105], v[88:89], v[104:105]
  v_pk_mul_f32 v[106:107], v[90:91], v[106:107]
  v_pk_mul_f32 v[136:137], v[120:121], v[136:137]
  v_pk_mul_f32 v[138:139], v[122:123], v[138:139]
  v_pk_mul_f32 v[88:89], v[88:89], v[208:209] neg_lo:[1,0] neg_hi:[1,0]
  v_pk_mul_f32 v[90:91], v[90:91], v[210:211] neg_lo:[1,0] neg_hi:[1,0]
  v_pk_mul_f32 v[120:121], v[120:121], v[212:213] neg_lo:[1,0] neg_hi:[1,0]
  v_pk_mul_f32 v[122:123], v[122:123], v[214:215] neg_lo:[1,0] neg_hi:[1,0]
  v_exp_f32 v88, v88
  v_exp_f32 v89, v89
  v_exp_f32 v90, v90
  v_exp_f32 v91, v91
  v_exp_f32 v120, v120
  v_exp_f32 v121, v121
  v_exp_f32 v122, v122
  v_exp_f32 v123, v123
  v_pk_add_f32 v[88:89], v[88:89], 1.0 op_sel_hi:[1,0]
  v_pk_add_f32 v[90:91], v[90:91], 1.0 op_sel_hi:[1,0]
  v_pk_add_f32 v[120:121], v[120:121], 1.0 op_sel_hi:[1,0]
  v_pk_add_f32 v[122:123], v[122:123], 1.0 op_sel_hi:[1,0]
  v_rcp_f32 v88, v88
  v_rcp_f32 v89, v89
  v_rcp_f32 v90, v90
  v_rcp_f32 v91, v91
  v_rcp_f32 v120, v120
  v_rcp_f32 v121, v121
  v_rcp_f32 v122, v122
  v_rcp_f32 v123, v123
  v_pk_mul_f32 v[104:105], v[104:105], v[88:89]
  v_pk_mul_f32 v[106:107], v[106:107], v[90:91]
  v_pk_mul_f32 v[136:137], v[136:137], v[120:121]
  v_pk_mul_f32 v[138:139], v[138:139], v[122:123]
  v_cvt_pk_bf16_f32 v224, v104, v105
  v_cvt_pk_bf16_f32 v225, v106, v107
  v_cvt_pk_bf16_f32 v226, v136, v137
  v_cvt_pk_bf16_f32 v227, v138, v139
  buffer_store_dwordx4 v[224:227], v8, s[16:19], s79 offen sc1
  v_pk_fma_f32 v[208:209], v[92:93], v[92:93], s[32:33]
  v_pk_fma_f32 v[210:211], v[94:95], v[94:95], s[32:33]
  v_pk_fma_f32 v[212:213], v[124:125], v[124:125], s[32:33]
  v_pk_fma_f32 v[214:215], v[126:127], v[126:127], s[32:33]
  v_pk_mul_f32 v[108:109], v[92:93], v[108:109]
  v_pk_mul_f32 v[110:111], v[94:95], v[110:111]
  v_pk_mul_f32 v[140:141], v[124:125], v[140:141]
  v_pk_mul_f32 v[142:143], v[126:127], v[142:143]
  v_pk_mul_f32 v[92:93], v[92:93], v[208:209] neg_lo:[1,0] neg_hi:[1,0]
  v_pk_mul_f32 v[94:95], v[94:95], v[210:211] neg_lo:[1,0] neg_hi:[1,0]
  v_pk_mul_f32 v[124:125], v[124:125], v[212:213] neg_lo:[1,0] neg_hi:[1,0]
  v_pk_mul_f32 v[126:127], v[126:127], v[214:215] neg_lo:[1,0] neg_hi:[1,0]
  v_exp_f32 v92, v92
  v_exp_f32 v93, v93
  v_exp_f32 v94, v94
  v_exp_f32 v95, v95
  v_exp_f32 v124, v124
  v_exp_f32 v125, v125
  v_exp_f32 v126, v126
  v_exp_f32 v127, v127
  v_pk_add_f32 v[92:93], v[92:93], 1.0 op_sel_hi:[1,0]
  v_pk_add_f32 v[94:95], v[94:95], 1.0 op_sel_hi:[1,0]
  v_pk_add_f32 v[124:125], v[124:125], 1.0 op_sel_hi:[1,0]
  v_pk_add_f32 v[126:127], v[126:127], 1.0 op_sel_hi:[1,0]
  v_rcp_f32 v92, v92
  v_rcp_f32 v93, v93
  v_rcp_f32 v94, v94
  v_rcp_f32 v95, v95
  v_rcp_f32 v124, v124
  v_rcp_f32 v125, v125
  v_rcp_f32 v126, v126
  v_rcp_f32 v127, v127
  v_pk_mul_f32 v[108:109], v[108:109], v[92:93]
  v_pk_mul_f32 v[110:111], v[110:111], v[94:95]
  v_pk_mul_f32 v[140:141], v[140:141], v[124:125]
  v_pk_mul_f32 v[142:143], v[142:143], v[126:127]
  v_cvt_pk_bf16_f32 v228, v108, v109
  v_cvt_pk_bf16_f32 v229, v110, v111
  v_cvt_pk_bf16_f32 v230, v140, v141
  v_cvt_pk_bf16_f32 v231, v142, v143
  buffer_store_dwordx4 v[228:231], v8, s[16:19], s80 offen sc1
  s_waitcnt lgkmcnt(0)
  v_mfma_f32_16x16x32_bf16 v[16:19], v[144:147], a[0:3], 0
  ds_read_b64_tr_b16 v[168:169], v244 offset:0
  v_mfma_f32_16x16x32_bf16 v[16:19], v[148:151], a[8:11], v[16:19]
  ds_read_b64_tr_b16 v[170:171], v244 offset:6144
  v_mfma_f32_16x16x32_bf16 v[20:23], v[148:151], a[12:15], 0
  ds_read_b64_tr_b16 v[172:173], v244 offset:12288
  v_mfma_f32_16x16x32_bf16 v[20:23], v[144:147], a[4:7], v[20:23]
  s_waitcnt lgkmcnt(7)
  ds_read_b64_tr_b16 v[174:175], v244 offset:18432
  v_mfma_f32_16x16x32_bf16 v[44:47], v[152:155], a[4:7], 0
  buffer_load_dwordx4 a[64:67], v239, s[16:19], s60 offen sc1
  v_mfma_f32_16x16x32_bf16 v[44:47], v[156:159], a[12:15], v[44:47]
  ds_read_b64_tr_b16 v[144:145], v241 offset:1024
  ds_read_b64_tr_b16 v[146:147], v241 offset:7168
  v_mfma_f32_16x16x32_bf16 v[40:43], v[156:159], a[8:11], 0
  ds_read_b64_tr_b16 v[148:149], v241 offset:13312
  v_readlane_b32 s62, v222, 9
  v_mfma_f32_16x16x32_bf16 v[40:43], v[152:155], a[0:3], v[40:43]
  s_waitcnt lgkmcnt(7)
  ds_read_b64_tr_b16 v[150:151], v241 offset:19456
  v_mfma_f32_16x16x32_bf16 v[64:67], v[160:163], a[0:3], 0
  buffer_load_dwordx4 a[68:71], v240, s[16:19], s60 offen sc1
  v_mfma_f32_16x16x32_bf16 v[64:67], v[164:167], a[8:11], v[64:67]
  s_add_u32 m0, s63, 110592
  ds_read_b64_tr_b16 v[152:153], v242 offset:1024
  ds_read_b64_tr_b16 v[154:155], v242 offset:7168
  v_mfma_f32_16x16x32_bf16 v[68:71], v[164:167], a[12:15], 0
  s_mul_i32 s61, s62, 36864
  ds_read_b64_tr_b16 v[156:157], v242 offset:13312
  v_mfma_f32_16x16x32_bf16 v[68:71], v[160:163], a[4:7], v[68:71]
  s_waitcnt lgkmcnt(7)
  ds_read_b64_tr_b16 v[158:159], v242 offset:19456
  v_mfma_f32_16x16x32_bf16 v[188:191], v[168:171], a[4:7], 0
  ds_read_b64_tr_b16 v[160:161], v243 offset:1024
  v_mfma_f32_16x16x32_bf16 v[188:191], v[172:175], a[12:15], v[188:191]
  ds_read_b64_tr_b16 v[162:163], v243 offset:7168
  v_mfma_f32_16x16x32_bf16 v[184:187], v[172:175], a[8:11], 0
  buffer_load_dwordx4 v236, s[84:87], s61 offen lds
  v_mfma_f32_16x16x32_bf16 v[184:187], v[168:171], a[0:3], v[184:187]
  s_waitcnt lgkmcnt(6)
  ds_read_b64_tr_b16 v[164:165], v243 offset:13312
  ds_read_b64_tr_b16 v[166:167], v243 offset:19456
  v_mfma_f32_16x16x32_bf16 v[24:27], v[144:147], a[0:3], 0
  s_lshl_b32 s60, s62, 10
  ds_read_b64_tr_b16 v[168:169], v244 offset:1024
  v_mfma_f32_16x16x32_bf16 v[24:27], v[148:151], a[8:11], v[24:27]
  ds_read_b64_tr_b16 v[170:171], v244 offset:7168
  v_mfma_f32_16x16x32_bf16 v[28:31], v[148:151], a[12:15], 0
  buffer_load_dwordx4 v237, s[84:87], s61 offen offset:1024 lds
  v_mfma_f32_16x16x32_bf16 v[28:31], v[144:147], a[4:7], v[28:31]
  s_waitcnt lgkmcnt(6)
  ds_read_b64_tr_b16 v[172:173], v244 offset:13312
  ds_read_b64_tr_b16 v[174:175], v244 offset:19456
  v_mfma_f32_16x16x32_bf16 v[52:55], v[152:155], a[4:7], 0
  ds_read_b64_tr_b16 v[144:145], v241 offset:2048
  v_mfma_f32_16x16x32_bf16 v[52:55], v[156:159], a[12:15], v[52:55]
  ds_read_b64_tr_b16 v[146:147], v241 offset:8192
  v_mfma_f32_16x16x32_bf16 v[48:51], v[156:159], a[8:11], 0
  buffer_load_dwordx4 v238, s[84:87], s61 offen offset:2048 lds
  v_mfma_f32_16x16x32_bf16 v[48:51], v[152:155], a[0:3], v[48:51]
  s_waitcnt lgkmcnt(6)
  ds_read_b64_tr_b16 v[148:149], v241 offset:14336
  ds_read_b64_tr_b16 v[150:151], v241 offset:20480
  v_mfma_f32_16x16x32_bf16 v[72:75], v[160:163], a[0:3], 0
  ds_read_b64_tr_b16 v[152:153], v242 offset:2048
  v_mfma_f32_16x16x32_bf16 v[72:75], v[164:167], a[8:11], v[72:75]
  ds_read_b64_tr_b16 v[154:155], v242 offset:8192
  v_mfma_f32_16x16x32_bf16 v[76:79], v[164:167], a[12:15], 0
  ds_read_b64_tr_b16 v[156:157], v242 offset:14336
  v_mfma_f32_16x16x32_bf16 v[76:79], v[160:163], a[4:7], v[76:79]
  s_waitcnt lgkmcnt(7)
  ds_read_b64_tr_b16 v[158:159], v242 offset:20480
  v_mfma_f32_16x16x32_bf16 v[196:199], v[168:171], a[4:7], 0
  buffer_load_dwordx4 a[72:75], v239, s[16:19], s60 offen sc1
  v_mfma_f32_16x16x32_bf16 v[196:199], v[172:175], a[12:15], v[196:199]
  ds_read_b64_tr_b16 v[160:161], v243 offset:2048
  ds_read_b64_tr_b16 v[162:163], v243 offset:8192
  v_mfma_f32_16x16x32_bf16 v[192:195], v[172:175], a[8:11], 0
  ds_read_b64_tr_b16 v[164:165], v243 offset:14336
  v_readlane_b32 s62, v222, 10
  v_mfma_f32_16x16x32_bf16 v[192:195], v[168:171], a[0:3], v[192:195]
  s_waitcnt lgkmcnt(7)
  ds_read_b64_tr_b16 v[166:167], v243 offset:20480
  v_mfma_f32_16x16x32_bf16 v[32:35], v[144:147], a[0:3], 0
  buffer_load_dwordx4 a[76:79], v240, s[16:19], s60 offen sc1
  v_mfma_f32_16x16x32_bf16 v[32:35], v[148:151], a[8:11], v[32:35]
  s_add_u32 m0, s63, 122880
  ds_read_b64_tr_b16 v[168:169], v244 offset:2048
  ds_read_b64_tr_b16 v[170:171], v244 offset:8192
  v_mfma_f32_16x16x32_bf16 v[36:39], v[148:151], a[12:15], 0
  s_mul_i32 s61, s62, 36864
  ds_read_b64_tr_b16 v[172:173], v244 offset:14336
  v_mfma_f32_16x16x32_bf16 v[36:39], v[144:147], a[4:7], v[36:39]
  s_waitcnt lgkmcnt(7)
  ds_read_b64_tr_b16 v[174:175], v244 offset:20480
  v_mfma_f32_16x16x32_bf16 v[60:63], v[152:155], a[4:7], 0
  ds_read_b64_tr_b16 v[144:145], v241 offset:24576
  v_mfma_f32_16x16x32_bf16 v[60:63], v[156:159], a[12:15], v[60:63]
  ds_read_b64_tr_b16 v[146:147], v241 offset:30720
  v_mfma_f32_16x16x32_bf16 v[56:59], v[156:159], a[8:11], 0
  buffer_load_dwordx4 v236, s[84:87], s61 offen lds
  v_mfma_f32_16x16x32_bf16 v[56:59], v[152:155], a[0:3], v[56:59]
  s_waitcnt lgkmcnt(6)
  ds_read_b64_tr_b16 v[148:149], v241 offset:36864
  ds_read_b64_tr_b16 v[150:151], v241 offset:43008
  v_mfma_f32_16x16x32_bf16 v[176:179], v[160:163], a[0:3], 0
  s_lshl_b32 s60, s62, 10
  ds_read_b64_tr_b16 v[152:153], v242 offset:24576
  v_mfma_f32_16x16x32_bf16 v[176:179], v[164:167], a[8:11], v[176:179]
  ds_read_b64_tr_b16 v[154:155], v242 offset:30720
  v_mfma_f32_16x16x32_bf16 v[180:183], v[164:167], a[12:15], 0
  buffer_load_dwordx4 v237, s[84:87], s61 offen offset:1024 lds
  v_mfma_f32_16x16x32_bf16 v[180:183], v[160:163], a[4:7], v[180:183]
  s_waitcnt lgkmcnt(6)
  ds_read_b64_tr_b16 v[156:157], v242 offset:36864
  ds_read_b64_tr_b16 v[158:159], v242 offset:43008
  v_mfma_f32_16x16x32_bf16 v[204:207], v[168:171], a[4:7], 0
  ds_read_b64_tr_b16 v[160:161], v243 offset:24576
  v_mfma_f32_16x16x32_bf16 v[204:207], v[172:175], a[12:15], v[204:207]
  ds_read_b64_tr_b16 v[162:163], v243 offset:30720
  v_mfma_f32_16x16x32_bf16 v[200:203], v[172:175], a[8:11], 0
  buffer_load_dwordx4 v238, s[84:87], s61 offen offset:2048 lds
  v_mfma_f32_16x16x32_bf16 v[200:203], v[168:171], a[0:3], v[200:203]
  s_waitcnt lgkmcnt(6)
  ds_read_b64_tr_b16 v[164:165], v243 offset:36864
  ds_read_b64_tr_b16 v[166:167], v243 offset:43008
  v_mfma_f32_16x16x32_bf16 v[16:19], v[144:147], a[16:19], v[16:19]
  ds_read_b64_tr_b16 v[168:169], v244 offset:24576
  v_mfma_f32_16x16x32_bf16 v[16:19], v[148:151], a[24:27], v[16:19]
  ds_read_b64_tr_b16 v[170:171], v244 offset:30720
  v_mfma_f32_16x16x32_bf16 v[20:23], v[148:151], a[28:31], v[20:23]
  ds_read_b64_tr_b16 v[172:173], v244 offset:36864
  v_mfma_f32_16x16x32_bf16 v[20:23], v[144:147], a[20:23], v[20:23]
  s_waitcnt lgkmcnt(7)
  ds_read_b64_tr_b16 v[174:175], v244 offset:43008
  v_mfma_f32_16x16x32_bf16 v[44:47], v[152:155], a[20:23], v[44:47]
  buffer_load_dwordx4 a[80:83], v239, s[16:19], s60 offen sc1
  v_mfma_f32_16x16x32_bf16 v[44:47], v[156:159], a[28:31], v[44:47]
  ds_read_b64_tr_b16 v[144:145], v241 offset:25600
  ds_read_b64_tr_b16 v[146:147], v241 offset:31744
  v_mfma_f32_16x16x32_bf16 v[40:43], v[156:159], a[24:27], v[40:43]
  ds_read_b64_tr_b16 v[148:149], v241 offset:37888
  v_readlane_b32 s62, v222, 11
  v_mfma_f32_16x16x32_bf16 v[40:43], v[152:155], a[16:19], v[40:43]
  s_waitcnt lgkmcnt(7)
  ds_read_b64_tr_b16 v[150:151], v241 offset:44032
  v_mfma_f32_16x16x32_bf16 v[64:67], v[160:163], a[16:19], v[64:67]
  buffer_load_dwordx4 a[84:87], v240, s[16:19], s60 offen sc1
  v_mfma_f32_16x16x32_bf16 v[64:67], v[164:167], a[24:27], v[64:67]
  s_add_u32 m0, s63, 135168
  ds_read_b64_tr_b16 v[152:153], v242 offset:25600
  ds_read_b64_tr_b16 v[154:155], v242 offset:31744
  v_mfma_f32_16x16x32_bf16 v[68:71], v[164:167], a[28:31], v[68:71]
  s_mul_i32 s61, s62, 36864
  ds_read_b64_tr_b16 v[156:157], v242 offset:37888
  v_mfma_f32_16x16x32_bf16 v[68:71], v[160:163], a[20:23], v[68:71]
  s_waitcnt lgkmcnt(7)
  ds_read_b64_tr_b16 v[158:159], v242 offset:44032
  v_mfma_f32_16x16x32_bf16 v[188:191], v[168:171], a[20:23], v[188:191]
  ds_read_b64_tr_b16 v[160:161], v243 offset:25600
  v_mfma_f32_16x16x32_bf16 v[188:191], v[172:175], a[28:31], v[188:191]
  ds_read_b64_tr_b16 v[162:163], v243 offset:31744
  v_mfma_f32_16x16x32_bf16 v[184:187], v[172:175], a[24:27], v[184:187]
  buffer_load_dwordx4 v236, s[84:87], s61 offen lds
  v_mfma_f32_16x16x32_bf16 v[184:187], v[168:171], a[16:19], v[184:187]
  s_waitcnt lgkmcnt(6)
  ds_read_b64_tr_b16 v[164:165], v243 offset:37888
  ds_read_b64_tr_b16 v[166:167], v243 offset:44032
  v_mfma_f32_16x16x32_bf16 v[24:27], v[144:147], a[16:19], v[24:27]
  s_lshl_b32 s60, s62, 10
  ds_read_b64_tr_b16 v[168:169], v244 offset:25600
  v_mfma_f32_16x16x32_bf16 v[24:27], v[148:151], a[24:27], v[24:27]
  ds_read_b64_tr_b16 v[170:171], v244 offset:31744
  v_mfma_f32_16x16x32_bf16 v[28:31], v[148:151], a[28:31], v[28:31]
  buffer_load_dwordx4 v237, s[84:87], s61 offen offset:1024 lds
  v_mfma_f32_16x16x32_bf16 v[28:31], v[144:147], a[20:23], v[28:31]
  s_waitcnt lgkmcnt(6)
  ds_read_b64_tr_b16 v[172:173], v244 offset:37888
  ds_read_b64_tr_b16 v[174:175], v244 offset:44032
  v_mfma_f32_16x16x32_bf16 v[52:55], v[152:155], a[20:23], v[52:55]
  ds_read_b64_tr_b16 v[144:145], v241 offset:26624
  v_and_b32 v223, 15, v221
  v_mfma_f32_16x16x32_bf16 v[52:55], v[156:159], a[28:31], v[52:55]
  ds_read_b64_tr_b16 v[146:147], v241 offset:32768
  v_lshrrev_b32_e64 v221, 4, v221
  v_mfma_f32_16x16x32_bf16 v[48:51], v[156:159], a[24:27], v[48:51]
  buffer_load_dwordx4 v238, s[84:87], s61 offen offset:2048 lds
  v_mfma_f32_16x16x32_bf16 v[48:51], v[152:155], a[16:19], v[48:51]
  s_waitcnt lgkmcnt(6)
  ds_read_b64_tr_b16 v[148:149], v241 offset:38912
  ds_read_b64_tr_b16 v[150:151], v241 offset:45056
  v_mfma_f32_16x16x32_bf16 v[72:75], v[160:163], a[16:19], v[72:75]
  ds_read_b64_tr_b16 v[152:153], v242 offset:26624
  v_mfma_f32_16x16x32_bf16 v[72:75], v[164:167], a[24:27], v[72:75]
  ds_read_b64_tr_b16 v[154:155], v242 offset:32768
  v_mfma_f32_16x16x32_bf16 v[76:79], v[164:167], a[28:31], v[76:79]
  ds_read_b64_tr_b16 v[156:157], v242 offset:38912
  v_mfma_f32_16x16x32_bf16 v[76:79], v[160:163], a[20:23], v[76:79]
  s_waitcnt lgkmcnt(7)
  ds_read_b64_tr_b16 v[158:159], v242 offset:45056
  v_mfma_f32_16x16x32_bf16 v[196:199], v[168:171], a[20:23], v[196:199]
  buffer_load_dwordx4 a[88:91], v239, s[16:19], s60 offen sc1
  v_mfma_f32_16x16x32_bf16 v[196:199], v[172:175], a[28:31], v[196:199]
  ds_read_b64_tr_b16 v[160:161], v243 offset:26624
  ds_read_b64_tr_b16 v[162:163], v243 offset:32768
  v_mfma_f32_16x16x32_bf16 v[192:195], v[172:175], a[24:27], v[192:195]
  ds_read_b64_tr_b16 v[164:165], v243 offset:38912
  v_readlane_b32 s62, v222, 12
  v_mfma_f32_16x16x32_bf16 v[192:195], v[168:171], a[16:19], v[192:195]
  s_waitcnt lgkmcnt(7)
  ds_read_b64_tr_b16 v[166:167], v243 offset:45056
  v_mfma_f32_16x16x32_bf16 v[32:35], v[144:147], a[16:19], v[32:35]
  buffer_load_dwordx4 a[92:95], v240, s[16:19], s60 offen sc1
  v_mfma_f32_16x16x32_bf16 v[32:35], v[148:151], a[24:27], v[32:35]
  s_add_u32 m0, s63, 0
  ds_read_b64_tr_b16 v[168:169], v244 offset:26624
  ds_read_b64_tr_b16 v[170:171], v244 offset:32768
  v_mfma_f32_16x16x32_bf16 v[36:39], v[148:151], a[28:31], v[36:39]
  s_waitcnt vmcnt(20)
  ds_read_b64_tr_b16 v[172:173], v244 offset:38912
  v_mfma_f32_16x16x32_bf16 v[36:39], v[144:147], a[20:23], v[36:39]
  s_waitcnt lgkmcnt(7)
  ds_read_b64_tr_b16 v[174:175], v244 offset:45056
  v_mfma_f32_16x16x32_bf16 v[60:63], v[152:155], a[20:23], v[60:63]
  s_barrier
  ds_read_b64_tr_b16 v[144:145], v241 offset:49152
  v_mfma_f32_16x16x32_bf16 v[60:63], v[156:159], a[28:31], v[60:63]
  s_mul_i32 s61, s62, 36864
  ds_read_b64_tr_b16 v[146:147], v241 offset:55296
  v_mfma_f32_16x16x32_bf16 v[56:59], v[156:159], a[24:27], v[56:59]
  buffer_load_dwordx4 v236, s[84:87], s61 offen lds
  v_mfma_f32_16x16x32_bf16 v[56:59], v[152:155], a[16:19], v[56:59]
  s_waitcnt lgkmcnt(6)
  ds_read_b64_tr_b16 v[148:149], v241 offset:61440
  ds_read_b64_tr_b16 v[150:151], v245 offset:2048
  v_mfma_f32_16x16x32_bf16 v[176:179], v[160:163], a[16:19], v[176:179]
  s_lshl_b32 s60, s62, 10
  ds_read_b64_tr_b16 v[152:153], v242 offset:49152
  v_mfma_f32_16x16x32_bf16 v[176:179], v[164:167], a[24:27], v[176:179]
  ds_read_b64_tr_b16 v[154:155], v242 offset:55296
  v_mfma_f32_16x16x32_bf16 v[180:183], v[164:167], a[28:31], v[180:183]
  buffer_load_dwordx4 v237, s[84:87], s61 offen offset:1024 lds
  v_mfma_f32_16x16x32_bf16 v[180:183], v[160:163], a[20:23], v[180:183]
  s_waitcnt lgkmcnt(6)
  ds_read_b64_tr_b16 v[156:157], v242 offset:61440
  ds_read_b64_tr_b16 v[158:159], v246 offset:2048
  v_mfma_f32_16x16x32_bf16 v[204:207], v[168:171], a[20:23], v[204:207]
  ds_read_b64_tr_b16 v[160:161], v243 offset:49152
  v_mfma_f32_16x16x32_bf16 v[204:207], v[172:175], a[28:31], v[204:207]
  ds_read_b64_tr_b16 v[162:163], v243 offset:55296
  v_mfma_f32_16x16x32_bf16 v[200:203], v[172:175], a[24:27], v[200:203]
  buffer_load_dwordx4 v238, s[84:87], s61 offen offset:2048 lds
  v_mfma_f32_16x16x32_bf16 v[200:203], v[168:171], a[16:19], v[200:203]
  s_waitcnt lgkmcnt(6)
  ds_read_b64_tr_b16 v[164:165], v243 offset:61440
  ds_read_b64_tr_b16 v[166:167], v247 offset:2048
  v_mfma_f32_16x16x32_bf16 v[16:19], v[144:147], a[32:35], v[16:19]
  ds_read_b64_tr_b16 v[168:169], v244 offset:49152
  v_cmp_gt_u32 vcc, v223, v218
  v_mfma_f32_16x16x32_bf16 v[16:19], v[148:151], a[40:43], v[16:19]
  s_cbranch_vccnz L_g_sp2
L_g_bk2:
  ds_read_b64_tr_b16 v[170:171], v244 offset:55296
  v_mfma_f32_16x16x32_bf16 v[20:23], v[148:151], a[44:47], v[20:23]
  ds_read_b64_tr_b16 v[172:173], v244 offset:61440
  v_mfma_f32_16x16x32_bf16 v[20:23], v[144:147], a[36:39], v[20:23]
  s_waitcnt lgkmcnt(7)
  ds_read_b64_tr_b16 v[174:175], v248 offset:2048
  v_mfma_f32_16x16x32_bf16 v[44:47], v[152:155], a[36:39], v[44:47]
  buffer_load_dwordx4 a[0:3], v239, s[16:19], s60 offen sc1
  v_mfma_f32_16x16x32_bf16 v[44:47], v[156:159], a[44:47], v[44:47]
  ds_read_b64_tr_b16 v[144:145], v241 offset:50176
  ds_read_b64_tr_b16 v[146:147], v241 offset:56320
  v_mfma_f32_16x16x32_bf16 v[40:43], v[156:159], a[40:43], v[40:43]
  ds_read_b64_tr_b16 v[148:149], v241 offset:62464
  v_readlane_b32 s62, v222, 13
  v_mfma_f32_16x16x32_bf16 v[40:43], v[152:155], a[32:35], v[40:43]
  s_waitcnt lgkmcnt(7)
  ds_read_b64_tr_b16 v[150:151], v245 offset:3072
  v_mfma_f32_16x16x32_bf16 v[64:67], v[160:163], a[32:35], v[64:67]
  buffer_load_dwordx4 a[4:7], v240, s[16:19], s60 offen sc1
  v_mfma_f32_16x16x32_bf16 v[64:67], v[164:167], a[40:43], v[64:67]
  s_add_u32 m0, s63, 12288
  ds_read_b64_tr_b16 v[152:153], v242 offset:50176
  ds_read_b64_tr_b16 v[154:155], v242 offset:56320
  v_mfma_f32_16x16x32_bf16 v[68:71], v[164:167], a[44:47], v[68:71]
  s_mul_i32 s61, s62, 36864
  ds_read_b64_tr_b16 v[156:157], v242 offset:62464
  v_mfma_f32_16x16x32_bf16 v[68:71], v[160:163], a[36:39], v[68:71]
  s_waitcnt lgkmcnt(7)
  ds_read_b64_tr_b16 v[158:159], v246 offset:3072
  v_mfma_f32_16x16x32_bf16 v[188:191], v[168:171], a[36:39], v[188:191]
  ds_read_b64_tr_b16 v[160:161], v243 offset:50176
  v_mfma_f32_16x16x32_bf16 v[188:191], v[172:175], a[44:47], v[188:191]
  ds_read_b64_tr_b16 v[162:163], v243 offset:56320
  v_mfma_f32_16x16x32_bf16 v[184:187], v[172:175], a[40:43], v[184:187]
  buffer_load_dwordx4 v236, s[84:87], s61 offen lds
  v_mfma_f32_16x16x32_bf16 v[184:187], v[168:171], a[32:35], v[184:187]
  s_waitcnt lgkmcnt(6)
  ds_read_b64_tr_b16 v[164:165], v243 offset:62464
  ds_read_b64_tr_b16 v[166:167], v247 offset:3072
  v_mfma_f32_16x16x32_bf16 v[24:27], v[144:147], a[32:35], v[24:27]
  s_lshl_b32 s60, s62, 10
  ds_read_b64_tr_b16 v[168:169], v244 offset:50176
  v_mfma_f32_16x16x32_bf16 v[24:27], v[148:151], a[40:43], v[24:27]
  ds_read_b64_tr_b16 v[170:171], v244 offset:56320
  v_mfma_f32_16x16x32_bf16 v[28:31], v[148:151], a[44:47], v[28:31]
  buffer_load_dwordx4 v237, s[84:87], s61 offen offset:1024 lds
  v_mfma_f32_16x16x32_bf16 v[28:31], v[144:147], a[36:39], v[28:31]
  s_waitcnt lgkmcnt(6)
  ds_read_b64_tr_b16 v[172:173], v244 offset:62464
  ds_read_b64_tr_b16 v[174:175], v248 offset:3072
  v_mfma_f32_16x16x32_bf16 v[52:55], v[152:155], a[36:39], v[52:55]
  ds_read_b64_tr_b16 v[144:145], v241 offset:51200
  v_mfma_f32_16x16x32_bf16 v[52:55], v[156:159], a[44:47], v[52:55]
  ds_read_b64_tr_b16 v[146:147], v241 offset:57344
  v_mfma_f32_16x16x32_bf16 v[48:51], v[156:159], a[40:43], v[48:51]
  buffer_load_dwordx4 v238, s[84:87], s61 offen offset:2048 lds
  v_mfma_f32_16x16x32_bf16 v[48:51], v[152:155], a[32:35], v[48:51]
  s_waitcnt lgkmcnt(6)
  ds_read_b64_tr_b16 v[148:149], v241 offset:63488
  ds_read_b64_tr_b16 v[150:151], v245 offset:4096
  v_mfma_f32_16x16x32_bf16 v[72:75], v[160:163], a[32:35], v[72:75]
  s_mul_i32 s35, s82, 12
  ds_read_b64_tr_b16 v[152:153], v242 offset:51200
  v_mfma_f32_16x16x32_bf16 v[72:75], v[164:167], a[40:43], v[72:75]
  s_add_u32 s35, s35, s81
  ds_read_b64_tr_b16 v[154:155], v242 offset:57344
  v_mov_b32_e64 v10, v12
  v_mfma_f32_16x16x32_bf16 v[76:79], v[164:167], a[44:47], v[76:79]
  ds_read_b64_tr_b16 v[156:157], v242 offset:63488
  v_min_u32_e64 v5, 5, v0
  v_mfma_f32_16x16x32_bf16 v[76:79], v[160:163], a[36:39], v[76:79]
  s_waitcnt lgkmcnt(7)
  ds_read_b64_tr_b16 v[158:159], v246 offset:4096
  v_lshrrev_b32 v12, 1, v5
  v_mfma_f32_16x16x32_bf16 v[196:199], v[168:171], a[36:39], v[196:199]
  buffer_load_dwordx4 a[8:11], v239, s[16:19], s60 offen sc1
  v_mfma_f32_16x16x32_bf16 v[196:199], v[172:175], a[44:47], v[196:199]
  ds_read_b64_tr_b16 v[160:161], v243 offset:51200
  ds_read_b64_tr_b16 v[162:163], v243 offset:57344
  v_mfma_f32_16x16x32_bf16 v[192:195], v[172:175], a[40:43], v[192:195]
  ds_read_b64_tr_b16 v[164:165], v243 offset:63488
  v_readlane_b32 s62, v222, 14
  v_mfma_f32_16x16x32_bf16 v[192:195], v[168:171], a[32:35], v[192:195]
  s_waitcnt lgkmcnt(7)
  ds_read_b64_tr_b16 v[166:167], v247 offset:4096
  v_and_b32 v5, 1, v5
  v_mfma_f32_16x16x32_bf16 v[32:35], v[144:147], a[32:35], v[32:35]
  buffer_load_dwordx4 a[12:15], v240, s[16:19], s60 offen sc1
  v_mfma_f32_16x16x32_bf16 v[32:35], v[148:151], a[40:43], v[32:35]
  s_add_u32 m0, s63, 24576
  ds_read_b64_tr_b16 v[168:169], v244 offset:51200
  ds_read_b64_tr_b16 v[170:171], v244 offset:57344
  v_mfma_f32_16x16x32_bf16 v[36:39], v[148:151], a[44:47], v[36:39]
  s_mul_i32 s61, s62, 36864
  ds_read_b64_tr_b16 v[172:173], v244 offset:63488
  v_mul_u32_u24_e64 v5, 15, v5
  v_mfma_f32_16x16x32_bf16 v[36:39], v[144:147], a[36:39], v[36:39]
  s_waitcnt lgkmcnt(7)
  ds_read_b64_tr_b16 v[174:175], v248 offset:4096
  v_lshl_add_u32 v5, v12, 6, v5
  v_mfma_f32_16x16x32_bf16 v[60:63], v[152:155], a[36:39], v[60:63]
  s_lshl_b32 s34, s35, 4
  ds_read_b64_tr_b16 v[144:145], v245 offset:8192
  v_add_u32_e64 v5, s34, v5
  v_mfma_f32_16x16x32_bf16 v[60:63], v[156:159], a[44:47], v[60:63]
  ds_read_b64_tr_b16 v[146:147], v245 offset:14336
  v_mul_u32_u24 v5, 3641, v5
  v_mfma_f32_16x16x32_bf16 v[56:59], v[156:159], a[40:43], v[56:59]
  buffer_load_dwordx4 v236, s[84:87], s61 offen lds
  v_mfma_f32_16x16x32_bf16 v[56:59], v[152:155], a[32:35], v[56:59]
  s_waitcnt lgkmcnt(6)
  ds_read_b64_tr_b16 v[148:149], v245 offset:20480
  ds_read_b64_tr_b16 v[150:151], v245 offset:26624
  v_mfma_f32_16x16x32_bf16 v[176:179], v[160:163], a[32:35], v[176:179]
  s_lshl_b32 s60, s62, 10
  ds_read_b64_tr_b16 v[152:153], v246 offset:8192
  v_lshrrev_b32_e64 v5, 16, v5
  v_mfma_f32_16x16x32_bf16 v[176:179], v[164:167], a[40:43], v[176:179]
  ds_read_b64_tr_b16 v[154:155], v246 offset:14336
  v_lshlrev_b32_e64 v5, 7, v5
  v_mfma_f32_16x16x32_bf16 v[180:183], v[164:167], a[44:47], v[180:183]
  buffer_load_dwordx4 v237, s[84:87], s61 offen offset:1024 lds
  v_mfma_f32_16x16x32_bf16 v[180:183], v[160:163], a[36:39], v[180:183]
  s_waitcnt lgkmcnt(6)
  ds_read_b64_tr_b16 v[156:157], v246 offset:20480
  ds_read_b64_tr_b16 v[158:159], v246 offset:26624
  v_mfma_f32_16x16x32_bf16 v[204:207], v[168:171], a[36:39], v[204:207]
  s_mov_b32 s52, 54591488
  ds_read_b64_tr_b16 v[160:161], v247 offset:8192
  v_lshrrev_b32 v12, 2, v0
  v_mfma_f32_16x16x32_bf16 v[204:207], v[172:175], a[44:47], v[204:207]
  ds_read_b64_tr_b16 v[162:163], v247 offset:14336
  v_and_b32_e64 v13, 3, v0
  v_mfma_f32_16x16x32_bf16 v[200:203], v[172:175], a[40:43], v[200:203]
  buffer_load_dwordx4 v238, s[84:87], s61 offen offset:2048 lds
  v_mfma_f32_16x16x32_bf16 v[200:203], v[168:171], a[32:35], v[200:203]
  s_waitcnt lgkmcnt(6)
  ds_read_b64_tr_b16 v[164:165], v247 offset:20480
  ds_read_b64_tr_b16 v[166:167], v247 offset:26624
  v_mfma_f32_16x16x32_bf16 v[16:19], v[144:147], a[48:51], v[16:19]
  ds_read_b64_tr_b16 v[168:169], v248 offset:8192
  v_mul_u32_u24 v1, 4352, v12
  v_mfma_f32_16x16x32_bf16 v[16:19], v[148:151], a[56:59], v[16:19]
  ds_read_b64_tr_b16 v[170:171], v248 offset:14336
  v_lshl_add_u32 v1, v13, 4, v1
  v_mfma_f32_16x16x32_bf16 v[20:23], v[148:151], a[60:63], v[20:23]
  s_mul_i32 s37, s35, 69632
  ds_read_b64_tr_b16 v[172:173], v248 offset:20480
  v_mfma_f32_16x16x32_bf16 v[20:23], v[144:147], a[52:55], v[20:23]
  s_waitcnt lgkmcnt(7)
  ds_read_b64_tr_b16 v[174:175], v248 offset:26624
  v_mfma_f32_16x16x32_bf16 v[44:47], v[152:155], a[52:55], v[44:47]
  buffer_load_dwordx4 a[16:19], v239, s[16:19], s60 offen sc1
  v_mfma_f32_16x16x32_bf16 v[44:47], v[156:159], a[60:63], v[44:47]
  s_lshl_b32 s34, s83, 5
  ds_read_b64_tr_b16 v[144:145], v245 offset:9216
  ds_read_b64_tr_b16 v[146:147], v245 offset:15360
  v_mfma_f32_16x16x32_bf16 v[40:43], v[156:159], a[56:59], v[40:43]
  s_add_u32 s37, s37, s34
  ds_read_b64_tr_b16 v[148:149], v245 offset:21504
  v_readlane_b32 s62, v222, 15
  v_mfma_f32_16x16x32_bf16 v[40:43], v[152:155], a[48:51], v[40:43]
  s_waitcnt lgkmcnt(7)
  ds_read_b64_tr_b16 v[150:151], v245 offset:27648
  v_mfma_f32_16x16x32_bf16 v[64:67], v[160:163], a[48:51], v[64:67]
  buffer_load_dwordx4 a[20:23], v240, s[16:19], s60 offen sc1
  v_mfma_f32_16x16x32_bf16 v[64:67], v[164:167], a[56:59], v[64:67]
  s_add_u32 m0, s63, 36864
  ds_read_b64_tr_b16 v[152:153], v246 offset:9216
  ds_read_b64_tr_b16 v[154:155], v246 offset:15360
  v_mfma_f32_16x16x32_bf16 v[68:71], v[164:167], a[60:63], v[68:71]
  s_mul_i32 s61, s62, 36864
  ds_read_b64_tr_b16 v[156:157], v246 offset:21504
  v_mfma_f32_16x16x32_bf16 v[68:71], v[160:163], a[52:55], v[68:71]
  s_waitcnt lgkmcnt(7)
  ds_read_b64_tr_b16 v[158:159], v246 offset:27648
  v_mfma_f32_16x16x32_bf16 v[188:191], v[168:171], a[52:55], v[188:191]
  s_add_u32 s40, s37, 24117248
  ds_read_b64_tr_b16 v[160:161], v247 offset:9216
  v_mfma_f32_16x16x32_bf16 v[188:191], v[172:175], a[60:63], v[188:191]
  s_add_u32 s41, s40, 277504
  ds_read_b64_tr_b16 v[162:163], v247 offset:15360
  v_mfma_f32_16x16x32_bf16 v[184:187], v[172:175], a[56:59], v[184:187]
  buffer_load_dwordx4 v236, s[84:87], s61 offen lds
  v_mfma_f32_16x16x32_bf16 v[184:187], v[168:171], a[48:51], v[184:187]
  s_waitcnt lgkmcnt(6)
  ds_read_b64_tr_b16 v[164:165], v247 offset:21504
  ds_read_b64_tr_b16 v[166:167], v247 offset:27648
  v_mfma_f32_16x16x32_bf16 v[24:27], v[144:147], a[48:51], v[24:27]
  s_lshl_b32 s60, s62, 10
  ds_read_b64_tr_b16 v[168:169], v248 offset:9216
  v_mfma_f32_16x16x32_bf16 v[24:27], v[148:151], a[56:59], v[24:27]
  s_add_u32 s42, s41, 277504
L_pg7:
  s_cbranch_execz L_pg11
  ds_read_b64_tr_b16 v[170:171], v248 offset:15360
  v_mfma_f32_16x16x32_bf16 v[28:31], v[148:151], a[60:63], v[28:31]
  buffer_load_dwordx4 v237, s[84:87], s61 offen offset:1024 lds
  v_mfma_f32_16x16x32_bf16 v[28:31], v[144:147], a[52:55], v[28:31]
  s_waitcnt lgkmcnt(6)
  ds_read_b64_tr_b16 v[172:173], v248 offset:21504
  ds_read_b64_tr_b16 v[174:175], v248 offset:27648
  v_mfma_f32_16x16x32_bf16 v[52:55], v[152:155], a[52:55], v[52:55]
  s_lshl_b32 s28, s24, 12
  ds_read_b64_tr_b16 v[144:145], v245 offset:10240
  v_mfma_f32_16x16x32_bf16 v[52:55], v[156:159], a[60:63], v[52:55]
  s_add_u32 s28, s28, 147456
  ds_read_b64_tr_b16 v[146:147], v245 offset:16384
  v_lshlrev_b32 v3, 6, v12
  v_mfma_f32_16x16x32_bf16 v[48:51], v[156:159], a[56:59], v[48:51]
  buffer_load_dwordx4 v238, s[84:87], s61 offen offset:2048 lds
  v_mfma_f32_16x16x32_bf16 v[48:51], v[152:155], a[48:51], v[48:51]
  s_waitcnt lgkmcnt(6)
  ds_read_b64_tr_b16 v[148:149], v245 offset:22528
  ds_read_b64_tr_b16 v[150:151], v245 offset:28672
  v_mfma_f32_16x16x32_bf16 v[72:75], v[160:163], a[48:51], v[72:75]
  ds_read_b64_tr_b16 v[152:153], v246 offset:10240
  v_lshl_add_u32 v3, v13, 3, v3
  v_mfma_f32_16x16x32_bf16 v[72:75], v[164:167], a[56:59], v[72:75]
  ds_read_b64_tr_b16 v[154:155], v246 offset:16384
  v_add_u32 v3, s28, v3
  v_mfma_f32_16x16x32_bf16 v[76:79], v[164:167], a[60:63], v[76:79]
  s_mov_b32 s8, s74
  ds_read_b64_tr_b16 v[156:157], v246 offset:22528
  v_mfma_f32_16x16x32_bf16 v[76:79], v[160:163], a[52:55], v[76:79]
  s_waitcnt lgkmcnt(7)
  ds_read_b64_tr_b16 v[158:159], v246 offset:28672
  v_mfma_f32_16x16x32_bf16 v[196:199], v[168:171], a[52:55], v[196:199]
  buffer_load_dwordx4 a[24:27], v239, s[16:19], s60 offen sc1
  v_mfma_f32_16x16x32_bf16 v[196:199], v[172:175], a[60:63], v[196:199]
  s_mov_b32 s9, s75
  ds_read_b64_tr_b16 v[160:161], v247 offset:10240
  ds_read_b64_tr_b16 v[162:163], v247 offset:16384
  v_mfma_f32_16x16x32_bf16 v[192:195], v[172:175], a[56:59], v[192:195]
  s_mov_b32 s10, 2359296
  ds_read_b64_tr_b16 v[164:165], v247 offset:22528
  v_readlane_b32 s62, v222, 16
  v_mfma_f32_16x16x32_bf16 v[192:195], v[168:171], a[48:51], v[192:195]
  s_waitcnt lgkmcnt(7)
  ds_read_b64_tr_b16 v[166:167], v247 offset:28672
  v_mfma_f32_16x16x32_bf16 v[32:35], v[144:147], a[48:51], v[32:35]
  buffer_load_dwordx4 a[28:31], v240, s[16:19], s60 offen sc1
  v_mfma_f32_16x16x32_bf16 v[32:35], v[148:151], a[56:59], v[32:35]
  s_add_u32 m0, s63, 49152
  ds_read_b64_tr_b16 v[168:169], v248 offset:10240
  ds_read_b64_tr_b16 v[170:171], v248 offset:16384
  v_mfma_f32_16x16x32_bf16 v[36:39], v[148:151], a[60:63], v[36:39]
  s_waitcnt vmcnt(20)
  ds_read_b64_tr_b16 v[172:173], v248 offset:22528
  v_mfma_f32_16x16x32_bf16 v[36:39], v[144:147], a[52:55], v[36:39]
  s_waitcnt lgkmcnt(7)
  ds_read_b64_tr_b16 v[174:175], v248 offset:28672
  v_mfma_f32_16x16x32_bf16 v[60:63], v[152:155], a[52:55], v[60:63]
  s_barrier
  ds_read_b64_tr_b16 v[144:145], v245 offset:32768
  v_add_u32 v219, 1, v219
  v_mfma_f32_16x16x32_bf16 v[60:63], v[156:159], a[60:63], v[60:63]
  s_mul_i32 s61, s62, 36864
  ds_read_b64_tr_b16 v[146:147], v245 offset:38912
  v_mfma_f32_16x16x32_bf16 v[56:59], v[156:159], a[56:59], v[56:59]
  buffer_load_dwordx4 v236, s[84:87], s61 offen lds
  v_mfma_f32_16x16x32_bf16 v[56:59], v[152:155], a[48:51], v[56:59]
  s_waitcnt lgkmcnt(6)
  ds_read_b64_tr_b16 v[148:149], v245 offset:45056
  ds_read_b64_tr_b16 v[150:151], v245 offset:51200
  v_mfma_f32_16x16x32_bf16 v[176:179], v[160:163], a[48:51], v[176:179]
  s_lshl_b32 s60, s62, 10
  ds_read_b64_tr_b16 v[152:153], v246 offset:32768
  v_mfma_f32_16x16x32_bf16 v[176:179], v[164:167], a[56:59], v[176:179]
  s_add_u32 s43, s67, 3072
  ds_read_b64_tr_b16 v[154:155], v246 offset:38912
  v_mfma_f32_16x16x32_bf16 v[180:183], v[164:167], a[60:63], v[180:183]
  buffer_load_dwordx4 v237, s[84:87], s61 offen offset:1024 lds
  v_mfma_f32_16x16x32_bf16 v[180:183], v[160:163], a[52:55], v[180:183]
  s_waitcnt lgkmcnt(6)
  ds_read_b64_tr_b16 v[156:157], v246 offset:45056
  ds_read_b64_tr_b16 v[158:159], v246 offset:51200
  v_mfma_f32_16x16x32_bf16 v[204:207], v[168:171], a[52:55], v[204:207]
  buffer_store_dword v219, v216, s[20:23], s36 offen sc1
  v_mfma_f32_16x16x32_bf16 v[204:207], v[172:175], a[60:63], v[204:207]
  s_add_u32 s44, s67, 6144
  ds_read_b64_tr_b16 v[160:161], v247 offset:32768
  ds_read_b64_tr_b16 v[162:163], v247 offset:38912
  v_mfma_f32_16x16x32_bf16 v[200:203], v[172:175], a[56:59], v[200:203]
  buffer_load_dwordx4 v238, s[84:87], s61 offen offset:2048 lds
  v_mfma_f32_16x16x32_bf16 v[200:203], v[168:171], a[48:51], v[200:203]
  s_waitcnt lgkmcnt(6)
  ds_read_b64_tr_b16 v[164:165], v247 offset:45056
  ds_read_b64_tr_b16 v[166:167], v247 offset:51200
  v_mfma_f32_16x16x32_bf16 v[16:19], v[144:147], a[64:67], v[16:19]
  s_mov_b32 s46, 0x3f80
  ds_read_b64_tr_b16 v[168:169], v248 offset:32768
  v_mfma_f32_16x16x32_bf16 v[16:19], v[148:151], a[72:75], v[16:19]
  s_mov_b32 s47, 0x3f800000
  ds_read_b64_tr_b16 v[170:171], v248 offset:38912
  v_and_b32 v7, 3, v0
  v_mfma_f32_16x16x32_bf16 v[20:23], v[148:151], a[76:79], v[20:23]
  ds_read_b64_tr_b16 v[172:173], v248 offset:45056
  v_lshlrev_b32_e64 v7, 7, v7
  v_mfma_f32_16x16x32_bf16 v[20:23], v[144:147], a[68:71], v[20:23]
  s_waitcnt lgkmcnt(7)
  ds_read_b64_tr_b16 v[174:175], v248 offset:51200
  v_mfma_f32_16x16x32_bf16 v[44:47], v[152:155], a[68:71], v[44:47]
  buffer_load_dwordx4 a[32:35], v239, s[16:19], s60 offen sc1
  v_mfma_f32_16x16x32_bf16 v[44:47], v[156:159], a[76:79], v[44:47]
  s_lshl_b32 s33, s81, 7
  ds_read_b64_tr_b16 v[144:145], v245 offset:33792
  ds_read_b64_tr_b16 v[146:147], v245 offset:39936
  v_mfma_f32_16x16x32_bf16 v[40:43], v[156:159], a[72:75], v[40:43]
  s_sub_u32 s45, s36, s33
  ds_read_b64_tr_b16 v[148:149], v245 offset:46080
  v_readlane_b32 s62, v222, 17
  v_mfma_f32_16x16x32_bf16 v[40:43], v[152:155], a[64:67], v[40:43]
  s_waitcnt lgkmcnt(7)
  ds_read_b64_tr_b16 v[150:151], v245 offset:52224
  v_mfma_f32_16x16x32_bf16 v[64:67], v[160:163], a[64:67], v[64:67]
  buffer_load_dwordx4 a[36:39], v240, s[16:19], s60 offen sc1
  v_mfma_f32_16x16x32_bf16 v[64:67], v[164:167], a[72:75], v[64:67]
  s_add_u32 m0, s63, 61440
  ds_read_b64_tr_b16 v[152:153], v246 offset:33792
  ds_read_b64_tr_b16 v[154:155], v246 offset:39936
  v_mfma_f32_16x16x32_bf16 v[68:71], v[164:167], a[76:79], v[68:71]
  s_mul_i32 s61, s62, 36864
  ds_read_b64_tr_b16 v[156:157], v246 offset:46080
  v_mfma_f32_16x16x32_bf16 v[68:71], v[160:163], a[68:71], v[68:71]
  s_waitcnt lgkmcnt(7)
  ds_read_b64_tr_b16 v[158:159], v246 offset:52224
  v_mfma_f32_16x16x32_bf16 v[188:191], v[168:171], a[68:71], v[188:191]
  s_lshl_b32 s33, s24, 12
  ds_read_b64_tr_b16 v[160:161], v247 offset:33792
  v_mfma_f32_16x16x32_bf16 v[188:191], v[172:175], a[76:79], v[188:191]
  s_add_u32 s33, s33, 147456
  ds_read_b64_tr_b16 v[162:163], v247 offset:39936
  v_add_u32_e64 v11, s33, v9
  v_mfma_f32_16x16x32_bf16 v[184:187], v[172:175], a[72:75], v[184:187]
  buffer_load_dwordx4 v236, s[84:87], s61 offen lds
  v_mfma_f32_16x16x32_bf16 v[184:187], v[168:171], a[64:67], v[184:187]
  s_waitcnt lgkmcnt(6)
  ds_read_b64_tr_b16 v[164:165], v247 offset:46080
  ds_read_b64_tr_b16 v[166:167], v247 offset:52224
  v_mfma_f32_16x16x32_bf16 v[24:27], v[144:147], a[64:67], v[24:27]
  s_lshl_b32 s60, s62, 10
  ds_read_b64_tr_b16 v[168:169], v248 offset:33792
  ds_read_b128 v[224:227], v11 offset:0
  v_mfma_f32_16x16x32_bf16 v[24:27], v[148:151], a[72:75], v[24:27]
  ds_read_b64_tr_b16 v[170:171], v248 offset:39936
  ds_read_b128 v[228:231], v11 offset:1024
  v_mfma_f32_16x16x32_bf16 v[28:31], v[148:151], a[76:79], v[28:31]
  buffer_load_dwordx4 v237, s[84:87], s61 offen offset:1024 lds
  v_mfma_f32_16x16x32_bf16 v[28:31], v[144:147], a[68:71], v[28:31]
  s_waitcnt lgkmcnt(6)
  ds_read_b64_tr_b16 v[172:173], v248 offset:46080
  ds_read_b64_tr_b16 v[174:175], v248 offset:52224
  v_mfma_f32_16x16x32_bf16 v[52:55], v[152:155], a[68:71], v[52:55]
  ds_read_b64_tr_b16 v[144:145], v245 offset:34816
  ds_read_b128 v[232:235], v11 offset:2048
  v_mfma_f32_16x16x32_bf16 v[52:55], v[156:159], a[76:79], v[52:55]
  ds_read_b64_tr_b16 v[146:147], v245 offset:40960
  v_mfma_f32_16x16x32_bf16 v[48:51], v[156:159], a[72:75], v[48:51]
  buffer_load_dwordx4 v238, s[84:87], s61 offen offset:2048 lds
  v_mfma_f32_16x16x32_bf16 v[48:51], v[152:155], a[64:67], v[48:51]
  s_waitcnt lgkmcnt(6)
  ds_read_b64_tr_b16 v[148:149], v245 offset:47104
  ds_read_b64_tr_b16 v[150:151], v245 offset:53248
  v_mfma_f32_16x16x32_bf16 v[72:75], v[160:163], a[64:67], v[72:75]
  ds_read_b64_tr_b16 v[152:153], v246 offset:34816
  v_mfma_f32_16x16x32_bf16 v[72:75], v[164:167], a[72:75], v[72:75]
  ds_read_b64_tr_b16 v[154:155], v246 offset:40960
  v_mfma_f32_16x16x32_bf16 v[76:79], v[164:167], a[76:79], v[76:79]
  ds_read_b64_tr_b16 v[156:157], v246 offset:47104
  v_mfma_f32_16x16x32_bf16 v[76:79], v[160:163], a[68:71], v[76:79]
  s_waitcnt lgkmcnt(7)
  ds_read_b64_tr_b16 v[158:159], v246 offset:53248
  v_mfma_f32_16x16x32_bf16 v[196:199], v[168:171], a[68:71], v[196:199]
  buffer_load_dwordx4 a[40:43], v239, s[16:19], s60 offen sc1
  v_mfma_f32_16x16x32_bf16 v[196:199], v[172:175], a[76:79], v[196:199]
  ds_read_b64_tr_b16 v[160:161], v247 offset:34816
  ds_read_b64_tr_b16 v[162:163], v247 offset:40960
  v_mfma_f32_16x16x32_bf16 v[192:195], v[172:175], a[72:75], v[192:195]
  ds_read_b64_tr_b16 v[164:165], v247 offset:47104
  v_readlane_b32 s62, v222, 18
  v_mfma_f32_16x16x32_bf16 v[192:195], v[168:171], a[64:67], v[192:195]
  s_waitcnt lgkmcnt(7)
  ds_read_b64_tr_b16 v[166:167], v247 offset:53248
  v_mfma_f32_16x16x32_bf16 v[32:35], v[144:147], a[64:67], v[32:35]
  buffer_load_dwordx4 a[44:47], v240, s[16:19], s60 offen sc1
  v_mfma_f32_16x16x32_bf16 v[32:35], v[148:151], a[72:75], v[32:35]
  s_add_u32 m0, s63, 73728
  ds_read_b64_tr_b16 v[168:169], v248 offset:34816
  ds_read_b64_tr_b16 v[170:171], v248 offset:40960
  v_mfma_f32_16x16x32_bf16 v[36:39], v[148:151], a[76:79], v[36:39]
  s_mul_i32 s61, s62, 36864
  ds_read_b64_tr_b16 v[172:173], v248 offset:47104
  v_mfma_f32_16x16x32_bf16 v[36:39], v[144:147], a[68:71], v[36:39]
  s_waitcnt lgkmcnt(7)
  ds_read_b64_tr_b16 v[174:175], v248 offset:53248
  v_mfma_f32_16x16x32_bf16 v[60:63], v[152:155], a[68:71], v[60:63]
  ds_read_b64_tr_b16 v[144:145], v245 offset:57344
  v_mfma_f32_16x16x32_bf16 v[60:63], v[156:159], a[76:79], v[60:63]
  ds_read_b64_tr_b16 v[146:147], v245 offset:63488
  v_mfma_f32_16x16x32_bf16 v[56:59], v[156:159], a[72:75], v[56:59]
  buffer_load_dwordx4 v236, s[84:87], s61 offen lds
  v_mfma_f32_16x16x32_bf16 v[56:59], v[152:155], a[64:67], v[56:59]
  s_waitcnt lgkmcnt(6)
  ds_read_b64_tr_b16 v[148:149], v249 offset:4096
  ds_read_b64_tr_b16 v[150:151], v249 offset:10240
  v_mfma_f32_16x16x32_bf16 v[176:179], v[160:163], a[64:67], v[176:179]
  s_lshl_b32 s60, s62, 10
  ds_read_b64_tr_b16 v[152:153], v246 offset:57344
  v_mfma_f32_16x16x32_bf16 v[176:179], v[164:167], a[72:75], v[176:179]
  ds_read_b64_tr_b16 v[154:155], v246 offset:63488
  v_mfma_f32_16x16x32_bf16 v[180:183], v[164:167], a[76:79], v[180:183]
  buffer_load_dwordx4 v237, s[84:87], s61 offen offset:1024 lds
  v_mfma_f32_16x16x32_bf16 v[180:183], v[160:163], a[68:71], v[180:183]
  s_waitcnt lgkmcnt(6)
  ds_read_b64_tr_b16 v[156:157], v250 offset:4096
  ds_read_b64_tr_b16 v[158:159], v250 offset:10240
  v_mfma_f32_16x16x32_bf16 v[204:207], v[168:171], a[68:71], v[204:207]
  ds_read_b64_tr_b16 v[160:161], v247 offset:57344
  v_mfma_f32_16x16x32_bf16 v[204:207], v[172:175], a[76:79], v[204:207]
  ds_read_b64_tr_b16 v[162:163], v247 offset:63488
  v_permlane16_swap_b32 v224, v226
  v_mfma_f32_16x16x32_bf16 v[200:203], v[172:175], a[72:75], v[200:203]
  buffer_load_dwordx4 v238, s[84:87], s61 offen offset:2048 lds
  v_mfma_f32_16x16x32_bf16 v[200:203], v[168:171], a[64:67], v[200:203]
  s_waitcnt lgkmcnt(6)
  ds_read_b64_tr_b16 v[164:165], v251 offset:4096
  ds_read_b64_tr_b16 v[166:167], v251 offset:10240
  v_mfma_f32_16x16x32_bf16 v[16:19], v[144:147], a[80:83], v[16:19]
  ds_read_b64_tr_b16 v[168:169], v248 offset:57344
  v_permlane16_swap_b32 v225, v227
  v_mfma_f32_16x16x32_bf16 v[16:19], v[148:151], a[88:91], v[16:19]
  ds_read_b64_tr_b16 v[170:171], v248 offset:63488
  v_permlane16_swap_b32 v228, v230
  v_mfma_f32_16x16x32_bf16 v[20:23], v[148:151], a[92:95], v[20:23]
  ds_read_b64_tr_b16 v[172:173], v252 offset:4096
  v_permlane16_swap_b32 v229, v231
  v_mfma_f32_16x16x32_bf16 v[20:23], v[144:147], a[84:87], v[20:23]
  s_waitcnt lgkmcnt(7)
  ds_read_b64_tr_b16 v[174:175], v252 offset:10240
  v_permlane16_swap_b32 v232, v234
  v_mfma_f32_16x16x32_bf16 v[44:47], v[152:155], a[84:87], v[44:47]
  buffer_load_dwordx4 a[48:51], v239, s[16:19], s60 offen sc1
  v_mfma_f32_16x16x32_bf16 v[44:47], v[156:159], a[92:95], v[44:47]
  ds_read_b64_tr_b16 v[144:145], v245 offset:58368
  ds_read_b64_tr_b16 v[146:147], v245 offset:64512
  v_mfma_f32_16x16x32_bf16 v[40:43], v[156:159], a[88:91], v[40:43]
  ds_read_b64_tr_b16 v[148:149], v249 offset:5120
  v_readlane_b32 s62, v222, 19
  v_mfma_f32_16x16x32_bf16 v[40:43], v[152:155], a[80:83], v[40:43]
  s_waitcnt lgkmcnt(7)
  ds_read_b64_tr_b16 v[150:151], v249 offset:11264
  v_permlane16_swap_b32 v233, v235
  v_mfma_f32_16x16x32_bf16 v[64:67], v[160:163], a[80:83], v[64:67]
  buffer_load_dwordx4 a[52:55], v240, s[16:19], s60 offen sc1
  v_mfma_f32_16x16x32_bf16 v[64:67], v[164:167], a[88:91], v[64:67]
  s_add_u32 m0, s63, 86016
  ds_read_b64_tr_b16 v[152:153], v246 offset:58368
  ds_read_b64_tr_b16 v[154:155], v246 offset:64512
  v_mfma_f32_16x16x32_bf16 v[68:71], v[164:167], a[92:95], v[68:71]
  s_mul_i32 s61, s62, 36864
  ds_read_b64_tr_b16 v[156:157], v250 offset:5120
  v_lshlrev_b32 v116, 16, v224
  v_mfma_f32_16x16x32_bf16 v[68:71], v[160:163], a[84:87], v[68:71]
  s_waitcnt lgkmcnt(7)
  ds_read_b64_tr_b16 v[158:159], v250 offset:11264
  v_and_b32 v117, s3, v224
  v_mfma_f32_16x16x32_bf16 v[188:191], v[168:171], a[84:87], v[188:191]
  ds_read_b64_tr_b16 v[160:161], v247 offset:58368
  v_lshlrev_b32_e64 v118, 16, v225
  v_mfma_f32_16x16x32_bf16 v[188:191], v[172:175], a[92:95], v[188:191]
  ds_read_b64_tr_b16 v[162:163], v247 offset:64512
  v_and_b32_e64 v119, s3, v225
  v_mfma_f32_16x16x32_bf16 v[184:187], v[172:175], a[88:91], v[184:187]
  buffer_load_dwordx4 v236, s[84:87], s61 offen lds
  v_mfma_f32_16x16x32_bf16 v[184:187], v[168:171], a[80:83], v[184:187]
  s_waitcnt lgkmcnt(6)
  ds_read_b64_tr_b16 v[164:165], v251 offset:5120
  ds_read_b64_tr_b16 v[166:167], v251 offset:11264
  v_mfma_f32_16x16x32_bf16 v[24:27], v[144:147], a[80:83], v[24:27]
  s_lshl_b32 s60, s62, 10
  ds_read_b64_tr_b16 v[168:169], v248 offset:58368
  v_lshlrev_b32_e64 v120, 16, v226
  v_mfma_f32_16x16x32_bf16 v[24:27], v[148:151], a[88:91], v[24:27]
  ds_read_b64_tr_b16 v[170:171], v248 offset:64512
  v_and_b32_e64 v121, s3, v226
  v_mfma_f32_16x16x32_bf16 v[28:31], v[148:151], a[92:95], v[28:31]
  buffer_load_dwordx4 v237, s[84:87], s61 offen offset:1024 lds
  v_mfma_f32_16x16x32_bf16 v[28:31], v[144:147], a[84:87], v[28:31]
  s_waitcnt lgkmcnt(6)
  ds_read_b64_tr_b16 v[172:173], v252 offset:5120
  ds_read_b64_tr_b16 v[174:175], v252 offset:11264
  v_mfma_f32_16x16x32_bf16 v[52:55], v[152:155], a[84:87], v[52:55]
  ds_read_b64_tr_b16 v[144:145], v245 offset:59392
  v_lshlrev_b32 v122, 16, v227
  v_mfma_f32_16x16x32_bf16 v[52:55], v[156:159], a[92:95], v[52:55]
  ds_read_b64_tr_b16 v[146:147], v249 offset:0
  v_and_b32_e64 v123, s3, v227
  v_mfma_f32_16x16x32_bf16 v[48:51], v[156:159], a[88:91], v[48:51]
  buffer_load_dwordx4 v238, s[84:87], s61 offen offset:2048 lds
  v_mfma_f32_16x16x32_bf16 v[48:51], v[152:155], a[80:83], v[48:51]
  s_waitcnt lgkmcnt(6)
  ds_read_b64_tr_b16 v[148:149], v249 offset:6144
  ds_read_b64_tr_b16 v[150:151], v249 offset:12288
  v_mfma_f32_16x16x32_bf16 v[72:75], v[160:163], a[80:83], v[72:75]
  ds_read_b64_tr_b16 v[152:153], v246 offset:59392
  v_lshlrev_b32 v124, 16, v228
  v_mfma_f32_16x16x32_bf16 v[72:75], v[164:167], a[88:91], v[72:75]
  ds_read_b64_tr_b16 v[154:155], v250 offset:0
  v_and_b32_e64 v125, s3, v228
  v_mfma_f32_16x16x32_bf16 v[76:79], v[164:167], a[92:95], v[76:79]
  ds_read_b64_tr_b16 v[156:157], v250 offset:6144
  v_lshlrev_b32_e64 v126, 16, v229
  v_mfma_f32_16x16x32_bf16 v[76:79], v[160:163], a[84:87], v[76:79]
  s_waitcnt lgkmcnt(7)
  ds_read_b64_tr_b16 v[158:159], v250 offset:12288
  v_and_b32 v127, s3, v229
  v_mfma_f32_16x16x32_bf16 v[196:199], v[168:171], a[84:87], v[196:199]
  buffer_load_dwordx4 a[56:59], v239, s[16:19], s60 offen sc1
  v_mfma_f32_16x16x32_bf16 v[196:199], v[172:175], a[92:95], v[196:199]
  ds_read_b64_tr_b16 v[160:161], v247 offset:59392
  ds_read_b64_tr_b16 v[162:163], v251 offset:0
  v_mfma_f32_16x16x32_bf16 v[192:195], v[172:175], a[88:91], v[192:195]
  ds_read_b64_tr_b16 v[164:165], v251 offset:6144
  v_readlane_b32 s62, v222, 20
  v_mfma_f32_16x16x32_bf16 v[192:195], v[168:171], a[80:83], v[192:195]
  s_waitcnt lgkmcnt(7)
  ds_read_b64_tr_b16 v[166:167], v251 offset:12288
  v_lshlrev_b32 v128, 16, v230
  v_mfma_f32_16x16x32_bf16 v[32:35], v[144:147], a[80:83], v[32:35]
  buffer_load_dwordx4 a[60:63], v240, s[16:19], s60 offen sc1
  v_mfma_f32_16x16x32_bf16 v[32:35], v[148:151], a[88:91], v[32:35]
  s_add_u32 m0, s63, 98304
  ds_read_b64_tr_b16 v[168:169], v248 offset:59392
  ds_read_b64_tr_b16 v[170:171], v252 offset:0
  v_mfma_f32_16x16x32_bf16 v[36:39], v[148:151], a[92:95], v[36:39]
  s_waitcnt vmcnt(20)
  ds_read_b64_tr_b16 v[172:173], v252 offset:6144
  v_and_b32 v129, s3, v230
  v_mfma_f32_16x16x32_bf16 v[36:39], v[144:147], a[84:87], v[36:39]
  s_waitcnt lgkmcnt(7)
  ds_read_b64_tr_b16 v[174:175], v252 offset:12288
  v_lshlrev_b32 v130, 16, v231
  v_mfma_f32_16x16x32_bf16 v[60:63], v[152:155], a[84:87], v[60:63]
  s_barrier
  ds_read_b64_tr_b16 v[144:145], v241 offset:0
  v_and_b32 v131, s3, v231
  v_mfma_f32_16x16x32_bf16 v[60:63], v[156:159], a[92:95], v[60:63]
  s_mul_i32 s61, s62, 36864
  ds_read_b64_tr_b16 v[146:147], v241 offset:6144
  v_lshlrev_b32_e64 v132, 16, v232
  v_mfma_f32_16x16x32_bf16 v[56:59], v[156:159], a[88:91], v[56:59]
  buffer_load_dwordx4 v236, s[84:87], s61 offen lds
  v_mfma_f32_16x16x32_bf16 v[56:59], v[152:155], a[80:83], v[56:59]
  s_waitcnt lgkmcnt(6)
  ds_read_b64_tr_b16 v[148:149], v241 offset:12288
  ds_read_b64_tr_b16 v[150:151], v241 offset:18432
  v_mfma_f32_16x16x32_bf16 v[176:179], v[160:163], a[80:83], v[176:179]
  buffer_load_dword v218, v220, s[4:7], 0 offen sc1
  v_mfma_f32_16x16x32_bf16 v[176:179], v[164:167], a[88:91], v[176:179]
  s_lshl_b32 s60, s62, 10
  ds_read_b64_tr_b16 v[152:153], v242 offset:0
  ds_read_b64_tr_b16 v[154:155], v242 offset:6144
  v_mfma_f32_16x16x32_bf16 v[180:183], v[164:167], a[92:95], v[180:183]
  buffer_load_dwordx4 v237, s[84:87], s61 offen offset:1024 lds
  v_mfma_f32_16x16x32_bf16 v[180:183], v[160:163], a[84:87], v[180:183]
  s_waitcnt lgkmcnt(6)
  ds_read_b64_tr_b16 v[156:157], v242 offset:12288
  ds_read_b64_tr_b16 v[158:159], v242 offset:18432
  v_mfma_f32_16x16x32_bf16 v[204:207], v[168:171], a[84:87], v[204:207]
  ds_read_b64_tr_b16 v[160:161], v243 offset:0
  v_and_b32 v133, s3, v232
  v_mfma_f32_16x16x32_bf16 v[204:207], v[172:175], a[92:95], v[204:207]
  ds_read_b64_tr_b16 v[162:163], v243 offset:6144
  v_lshlrev_b32_e64 v134, 16, v233
  v_mfma_f32_16x16x32_bf16 v[200:203], v[172:175], a[88:91], v[200:203]
  buffer_load_dwordx4 v238, s[84:87], s61 offen offset:2048 lds
  v_mfma_f32_16x16x32_bf16 v[200:203], v[168:171], a[80:83], v[200:203]
  s_waitcnt lgkmcnt(6)
  ds_read_b64_tr_b16 v[164:165], v243 offset:12288
  ds_read_b64_tr_b16 v[166:167], v243 offset:18432
  v_mfma_f32_16x16x32_bf16 v[16:19], v[144:147], a[0:3], v[16:19]
  ds_read_b64_tr_b16 v[168:169], v244 offset:0
  v_and_b32 v135, s3, v233
  v_mfma_f32_16x16x32_bf16 v[16:19], v[148:151], a[8:11], v[16:19]
  ds_read_b64_tr_b16 v[170:171], v244 offset:6144
  v_lshlrev_b32_e64 v136, 16, v234
  v_mfma_f32_16x16x32_bf16 v[20:23], v[148:151], a[12:15], v[20:23]
  ds_read_b64_tr_b16 v[172:173], v244 offset:12288
  v_and_b32_e64 v137, s3, v234
  v_mfma_f32_16x16x32_bf16 v[20:23], v[144:147], a[4:7], v[20:23]
  s_waitcnt lgkmcnt(7)
  ds_read_b64_tr_b16 v[174:175], v244 offset:18432
  v_lshlrev_b32 v138, 16, v235
  v_mfma_f32_16x16x32_bf16 v[44:47], v[152:155], a[4:7], v[44:47]
  buffer_load_dwordx4 a[64:67], v239, s[16:19], s60 offen sc1
  v_mfma_f32_16x16x32_bf16 v[44:47], v[156:159], a[12:15], v[44:47]
  ds_read_b64_tr_b16 v[144:145], v241 offset:1024
  ds_read_b64_tr_b16 v[146:147], v241 offset:7168
  v_mfma_f32_16x16x32_bf16 v[40:43], v[156:159], a[8:11], v[40:43]
  ds_read_b64_tr_b16 v[148:149], v241 offset:13312
  v_readlane_b32 s62, v222, 21
  v_mfma_f32_16x16x32_bf16 v[40:43], v[152:155], a[0:3], v[40:43]
  s_waitcnt lgkmcnt(7)
  ds_read_b64_tr_b16 v[150:151], v241 offset:19456
  v_and_b32 v139, s3, v235
  v_mfma_f32_16x16x32_bf16 v[64:67], v[160:163], a[0:3], v[64:67]
  buffer_load_dwordx4 a[68:71], v240, s[16:19], s60 offen sc1
  v_mfma_f32_16x16x32_bf16 v[64:67], v[164:167], a[8:11], v[64:67]
  s_add_u32 m0, s63, 110592
  ds_read_b64_tr_b16 v[152:153], v242 offset:1024
  ds_read_b64_tr_b16 v[154:155], v242 offset:7168
  v_mfma_f32_16x16x32_bf16 v[68:71], v[164:167], a[12:15], v[68:71]
  s_mul_i32 s61, s62, 36864
  ds_read_b64_tr_b16 v[156:157], v242 offset:13312
  v_mfma_f32_16x16x32_bf16 v[68:71], v[160:163], a[4:7], v[68:71]
  s_waitcnt lgkmcnt(7)
  ds_read_b64_tr_b16 v[158:159], v242 offset:19456
  v_mfma_f32_16x16x32_bf16 v[188:191], v[168:171], a[4:7], v[188:191]
  s_mov_b32 s48, s20
  ds_read_b64_tr_b16 v[160:161], v243 offset:1024
  v_mfma_f32_16x16x32_bf16 v[188:191], v[172:175], a[12:15], v[188:191]
  s_mov_b32 s49, s21
  ds_read_b64_tr_b16 v[162:163], v243 offset:7168
  v_mfma_f32_16x16x32_bf16 v[184:187], v[172:175], a[8:11], v[184:187]
  buffer_load_dwordx4 v236, s[84:87], s61 offen lds
  v_mfma_f32_16x16x32_bf16 v[184:187], v[168:171], a[0:3], v[184:187]
  s_waitcnt lgkmcnt(6)
  ds_read_b64_tr_b16 v[164:165], v243 offset:13312
  ds_read_b64_tr_b16 v[166:167], v243 offset:19456
  v_mfma_f32_16x16x32_bf16 v[24:27], v[144:147], a[0:3], v[24:27]
  s_lshl_b32 s60, s62, 10
  ds_read_b64_tr_b16 v[168:169], v244 offset:1024
  v_mfma_f32_16x16x32_bf16 v[24:27], v[148:151], a[8:11], v[24:27]
  s_mov_b32 s51, 0x20000
  ds_read_b64_tr_b16 v[170:171], v244 offset:7168
  v_mfma_f32_16x16x32_bf16 v[28:31], v[148:151], a[12:15], v[28:31]
  buffer_load_dwordx4 v237, s[84:87], s61 offen offset:1024 lds
  v_mfma_f32_16x16x32_bf16 v[28:31], v[144:147], a[4:7], v[28:31]
  s_waitcnt lgkmcnt(6)
  ds_read_b64_tr_b16 v[172:173], v244 offset:13312
  ds_read_b64_tr_b16 v[174:175], v244 offset:19456
  v_mfma_f32_16x16x32_bf16 v[52:55], v[152:155], a[4:7], v[52:55]
  ds_read_b64_tr_b16 v[144:145], v241 offset:2048
  v_mfma_f32_16x16x32_bf16 v[52:55], v[156:159], a[12:15], v[52:55]
  ds_read_b64_tr_b16 v[146:147], v241 offset:8192
  v_mfma_f32_16x16x32_bf16 v[48:51], v[156:159], a[8:11], v[48:51]
  buffer_load_dwordx4 v238, s[84:87], s61 offen offset:2048 lds
  v_mfma_f32_16x16x32_bf16 v[48:51], v[152:155], a[0:3], v[48:51]
  s_waitcnt lgkmcnt(6)
  ds_read_b64_tr_b16 v[148:149], v241 offset:14336
  ds_read_b64_tr_b16 v[150:151], v241 offset:20480
  v_mfma_f32_16x16x32_bf16 v[72:75], v[160:163], a[0:3], v[72:75]
  ds_read_b64_tr_b16 v[152:153], v242 offset:2048
  v_mfma_f32_16x16x32_bf16 v[72:75], v[164:167], a[8:11], v[72:75]
  ds_read_b64_tr_b16 v[154:155], v242 offset:8192
  v_mfma_f32_16x16x32_bf16 v[76:79], v[164:167], a[12:15], v[76:79]
  ds_read_b64_tr_b16 v[156:157], v242 offset:14336
  v_mfma_f32_16x16x32_bf16 v[76:79], v[160:163], a[4:7], v[76:79]
  s_waitcnt lgkmcnt(7)
  ds_read_b64_tr_b16 v[158:159], v242 offset:20480
  v_mfma_f32_16x16x32_bf16 v[196:199], v[168:171], a[4:7], v[196:199]
  buffer_load_dwordx4 a[72:75], v239, s[16:19], s60 offen sc1
  v_mfma_f32_16x16x32_bf16 v[196:199], v[172:175], a[12:15], v[196:199]
  ds_read_b64_tr_b16 v[160:161], v243 offset:2048
  ds_read_b64_tr_b16 v[162:163], v243 offset:8192
  v_mfma_f32_16x16x32_bf16 v[192:195], v[172:175], a[8:11], v[192:195]
  ds_read_b64_tr_b16 v[164:165], v243 offset:14336
  v_readlane_b32 s62, v222, 22
  v_mfma_f32_16x16x32_bf16 v[192:195], v[168:171], a[0:3], v[192:195]
  s_waitcnt lgkmcnt(7)
  ds_read_b64_tr_b16 v[166:167], v243 offset:20480
  v_mfma_f32_16x16x32_bf16 v[32:35], v[144:147], a[0:3], v[32:35]
  buffer_load_dwordx4 a[76:79], v240, s[16:19], s60 offen sc1
  v_mfma_f32_16x16x32_bf16 v[32:35], v[148:151], a[8:11], v[32:35]
  s_add_u32 m0, s63, 122880
  ds_read_b64_tr_b16 v[168:169], v244 offset:2048
  ds_read_b64_tr_b16 v[170:171], v244 offset:8192
  v_mfma_f32_16x16x32_bf16 v[36:39], v[148:151], a[12:15], v[36:39]
  s_mul_i32 s61, s62, 36864
  ds_read_b64_tr_b16 v[172:173], v244 offset:14336
  v_mfma_f32_16x16x32_bf16 v[36:39], v[144:147], a[4:7], v[36:39]
  s_waitcnt lgkmcnt(7)
  ds_read_b64_tr_b16 v[174:175], v244 offset:20480
  v_mfma_f32_16x16x32_bf16 v[60:63], v[152:155], a[4:7], v[60:63]
  ds_read_b64_tr_b16 v[144:145], v241 offset:24576
  v_mfma_f32_16x16x32_bf16 v[60:63], v[156:159], a[12:15], v[60:63]
  ds_read_b64_tr_b16 v[146:147], v241 offset:30720
  v_mfma_f32_16x16x32_bf16 v[56:59], v[156:159], a[8:11], v[56:59]
  buffer_load_dwordx4 v236, s[84:87], s61 offen lds
  v_mfma_f32_16x16x32_bf16 v[56:59], v[152:155], a[0:3], v[56:59]
  s_waitcnt lgkmcnt(6)
  ds_read_b64_tr_b16 v[148:149], v241 offset:36864
  ds_read_b64_tr_b16 v[150:151], v241 offset:43008
  v_mfma_f32_16x16x32_bf16 v[176:179], v[160:163], a[0:3], v[176:179]
  s_lshl_b32 s60, s62, 10
  ds_read_b64_tr_b16 v[152:153], v242 offset:24576
  v_mfma_f32_16x16x32_bf16 v[176:179], v[164:167], a[8:11], v[176:179]
  ds_read_b64_tr_b16 v[154:155], v242 offset:30720
  v_mfma_f32_16x16x32_bf16 v[180:183], v[164:167], a[12:15], v[180:183]
  buffer_load_dwordx4 v237, s[84:87], s61 offen offset:1024 lds
  v_mfma_f32_16x16x32_bf16 v[180:183], v[160:163], a[4:7], v[180:183]
  s_waitcnt lgkmcnt(6)
  ds_read_b64_tr_b16 v[156:157], v242 offset:36864
  ds_read_b64_tr_b16 v[158:159], v242 offset:43008
  v_mfma_f32_16x16x32_bf16 v[204:207], v[168:171], a[4:7], v[204:207]
  ds_read_b64_tr_b16 v[160:161], v243 offset:24576
  v_mfma_f32_16x16x32_bf16 v[204:207], v[172:175], a[12:15], v[204:207]
  ds_read_b64_tr_b16 v[162:163], v243 offset:30720
  v_mfma_f32_16x16x32_bf16 v[200:203], v[172:175], a[8:11], v[200:203]
  buffer_load_dwordx4 v238, s[84:87], s61 offen offset:2048 lds
  v_mfma_f32_16x16x32_bf16 v[200:203], v[168:171], a[0:3], v[200:203]
  s_waitcnt lgkmcnt(6)
  ds_read_b64_tr_b16 v[164:165], v243 offset:36864
  ds_read_b64_tr_b16 v[166:167], v243 offset:43008
  v_mfma_f32_16x16x32_bf16 v[16:19], v[144:147], a[16:19], v[16:19]
  ds_read_b64_tr_b16 v[168:169], v244 offset:24576
  v_mfma_f32_16x16x32_bf16 v[16:19], v[148:151], a[24:27], v[16:19]
  ds_read_b64_tr_b16 v[170:171], v244 offset:30720
  v_mfma_f32_16x16x32_bf16 v[20:23], v[148:151], a[28:31], v[20:23]
  ds_read_b64_tr_b16 v[172:173], v244 offset:36864
  v_mfma_f32_16x16x32_bf16 v[20:23], v[144:147], a[20:23], v[20:23]
  s_waitcnt lgkmcnt(7)
  ds_read_b64_tr_b16 v[174:175], v244 offset:43008
  v_mfma_f32_16x16x32_bf16 v[44:47], v[152:155], a[20:23], v[44:47]
  buffer_load_dwordx4 a[80:83], v239, s[16:19], s60 offen sc1
  v_mfma_f32_16x16x32_bf16 v[44:47], v[156:159], a[28:31], v[44:47]
  ds_read_b64_tr_b16 v[144:145], v241 offset:25600
  ds_read_b64_tr_b16 v[146:147], v241 offset:31744
  v_mfma_f32_16x16x32_bf16 v[40:43], v[156:159], a[24:27], v[40:43]
  ds_read_b64_tr_b16 v[148:149], v241 offset:37888
  v_readlane_b32 s62, v222, 23
  v_mfma_f32_16x16x32_bf16 v[40:43], v[152:155], a[16:19], v[40:43]
  s_waitcnt lgkmcnt(7)
  ds_read_b64_tr_b16 v[150:151], v241 offset:44032
  v_mfma_f32_16x16x32_bf16 v[64:67], v[160:163], a[16:19], v[64:67]
  buffer_load_dwordx4 a[84:87], v240, s[16:19], s60 offen sc1
  v_mfma_f32_16x16x32_bf16 v[64:67], v[164:167], a[24:27], v[64:67]
  s_add_u32 m0, s63, 135168
  ds_read_b64_tr_b16 v[152:153], v242 offset:25600
  ds_read_b64_tr_b16 v[154:155], v242 offset:31744
  v_mfma_f32_16x16x32_bf16 v[68:71], v[164:167], a[28:31], v[68:71]
  s_mul_i32 s61, s62, 36864
  ds_read_b64_tr_b16 v[156:157], v242 offset:37888
  v_mfma_f32_16x16x32_bf16 v[68:71], v[160:163], a[20:23], v[68:71]
  s_waitcnt lgkmcnt(7)
  ds_read_b64_tr_b16 v[158:159], v242 offset:44032
  v_mfma_f32_16x16x32_bf16 v[188:191], v[168:171], a[20:23], v[188:191]
L_pg8:
  s_cbranch_execz L_back
  ds_read_b64_tr_b16 v[160:161], v243 offset:25600
  v_mfma_f32_16x16x32_bf16 v[188:191], v[172:175], a[28:31], v[188:191]
  ds_read_b64_tr_b16 v[162:163], v243 offset:31744
  v_mfma_f32_16x16x32_bf16 v[184:187], v[172:175], a[24:27], v[184:187]
  buffer_load_dwordx4 v236, s[84:87], s61 offen lds
  v_mfma_f32_16x16x32_bf16 v[184:187], v[168:171], a[16:19], v[184:187]
  s_waitcnt lgkmcnt(6)
  ds_read_b64_tr_b16 v[164:165], v243 offset:37888
  ds_read_b64_tr_b16 v[166:167], v243 offset:44032
  v_mfma_f32_16x16x32_bf16 v[24:27], v[144:147], a[16:19], v[24:27]
  s_lshl_b32 s60, s62, 10
  ds_read_b64_tr_b16 v[168:169], v244 offset:25600
  v_mfma_f32_16x16x32_bf16 v[24:27], v[148:151], a[24:27], v[24:27]
  ds_read_b64_tr_b16 v[170:171], v244 offset:31744
  v_mfma_f32_16x16x32_bf16 v[28:31], v[148:151], a[28:31], v[28:31]
  buffer_load_dwordx4 v237, s[84:87], s61 offen offset:1024 lds
  v_mfma_f32_16x16x32_bf16 v[28:31], v[144:147], a[20:23], v[28:31]
  s_waitcnt lgkmcnt(6)
  ds_read_b64_tr_b16 v[172:173], v244 offset:37888
  ds_read_b64_tr_b16 v[174:175], v244 offset:44032
  v_mfma_f32_16x16x32_bf16 v[52:55], v[152:155], a[20:23], v[52:55]
  ds_read_b64_tr_b16 v[144:145], v241 offset:26624
  v_and_b32 v223, 15, v221
  v_mfma_f32_16x16x32_bf16 v[52:55], v[156:159], a[28:31], v[52:55]
  ds_read_b64_tr_b16 v[146:147], v241 offset:32768
  v_lshrrev_b32_e64 v221, 4, v221
  v_mfma_f32_16x16x32_bf16 v[48:51], v[156:159], a[24:27], v[48:51]
  buffer_load_dwordx4 v238, s[84:87], s61 offen offset:2048 lds
  v_mfma_f32_16x16x32_bf16 v[48:51], v[152:155], a[16:19], v[48:51]
  s_waitcnt lgkmcnt(6)
  ds_read_b64_tr_b16 v[148:149], v241 offset:38912
  ds_read_b64_tr_b16 v[150:151], v241 offset:45056
  v_mfma_f32_16x16x32_bf16 v[72:75], v[160:163], a[16:19], v[72:75]
  ds_read_b64_tr_b16 v[152:153], v242 offset:26624
  v_mfma_f32_16x16x32_bf16 v[72:75], v[164:167], a[24:27], v[72:75]
  ds_read_b64_tr_b16 v[154:155], v242 offset:32768
  v_mfma_f32_16x16x32_bf16 v[76:79], v[164:167], a[28:31], v[76:79]
  ds_read_b64_tr_b16 v[156:157], v242 offset:38912
  v_mfma_f32_16x16x32_bf16 v[76:79], v[160:163], a[20:23], v[76:79]
  s_waitcnt lgkmcnt(7)
  ds_read_b64_tr_b16 v[158:159], v242 offset:45056
  v_mfma_f32_16x16x32_bf16 v[196:199], v[168:171], a[20:23], v[196:199]
  buffer_load_dwordx4 a[88:91], v239, s[16:19], s60 offen sc1
  v_mfma_f32_16x16x32_bf16 v[196:199], v[172:175], a[28:31], v[196:199]
  ds_read_b64_tr_b16 v[160:161], v243 offset:26624
  ds_read_b64_tr_b16 v[162:163], v243 offset:32768
  v_mfma_f32_16x16x32_bf16 v[192:195], v[172:175], a[24:27], v[192:195]
  ds_read_b64_tr_b16 v[164:165], v243 offset:38912
  v_readlane_b32 s62, v222, 24
  v_mfma_f32_16x16x32_bf16 v[192:195], v[168:171], a[16:19], v[192:195]
  s_waitcnt lgkmcnt(7)
  ds_read_b64_tr_b16 v[166:167], v243 offset:45056
  v_mfma_f32_16x16x32_bf16 v[32:35], v[144:147], a[16:19], v[32:35]
  buffer_load_dwordx4 a[92:95], v240, s[16:19], s60 offen sc1
  v_mfma_f32_16x16x32_bf16 v[32:35], v[148:151], a[24:27], v[32:35]
  s_add_u32 m0, s63, 0
  ds_read_b64_tr_b16 v[168:169], v244 offset:26624
  ds_read_b64_tr_b16 v[170:171], v244 offset:32768
  v_mfma_f32_16x16x32_bf16 v[36:39], v[148:151], a[28:31], v[36:39]
  s_waitcnt vmcnt(19)
  ds_read_b64_tr_b16 v[172:173], v244 offset:38912
  v_mfma_f32_16x16x32_bf16 v[36:39], v[144:147], a[20:23], v[36:39]
  s_waitcnt lgkmcnt(7)
  ds_read_b64_tr_b16 v[174:175], v244 offset:45056
  v_mfma_f32_16x16x32_bf16 v[60:63], v[152:155], a[20:23], v[60:63]
  s_barrier
  ds_read_b64_tr_b16 v[144:145], v241 offset:49152
  v_mfma_f32_16x16x32_bf16 v[60:63], v[156:159], a[28:31], v[60:63]
  s_mul_i32 s61, s62, 36864
  ds_read_b64_tr_b16 v[146:147], v241 offset:55296
  v_mfma_f32_16x16x32_bf16 v[56:59], v[156:159], a[24:27], v[56:59]
  buffer_load_dwordx4 v236, s[84:87], s61 offen lds
  v_mfma_f32_16x16x32_bf16 v[56:59], v[152:155], a[16:19], v[56:59]
  s_waitcnt lgkmcnt(6)
  ds_read_b64_tr_b16 v[148:149], v241 offset:61440
  ds_read_b64_tr_b16 v[150:151], v245 offset:2048
  v_mfma_f32_16x16x32_bf16 v[176:179], v[160:163], a[16:19], v[176:179]
  s_lshl_b32 s60, s62, 10
  ds_read_b64_tr_b16 v[152:153], v242 offset:49152
  v_mfma_f32_16x16x32_bf16 v[176:179], v[164:167], a[24:27], v[176:179]
  ds_read_b64_tr_b16 v[154:155], v242 offset:55296
  v_mfma_f32_16x16x32_bf16 v[180:183], v[164:167], a[28:31], v[180:183]
  buffer_load_dwordx4 v237, s[84:87], s61 offen offset:1024 lds
  v_mfma_f32_16x16x32_bf16 v[180:183], v[160:163], a[20:23], v[180:183]
  s_waitcnt lgkmcnt(6)
  ds_read_b64_tr_b16 v[156:157], v242 offset:61440
  ds_read_b64_tr_b16 v[158:159], v246 offset:2048
  v_mfma_f32_16x16x32_bf16 v[204:207], v[168:171], a[20:23], v[204:207]
  ds_read_b64_tr_b16 v[160:161], v243 offset:49152
  v_mfma_f32_16x16x32_bf16 v[204:207], v[172:175], a[28:31], v[204:207]
  ds_read_b64_tr_b16 v[162:163], v243 offset:55296
  v_mfma_f32_16x16x32_bf16 v[200:203], v[172:175], a[24:27], v[200:203]
  buffer_load_dwordx4 v238, s[84:87], s61 offen offset:2048 lds
  v_mfma_f32_16x16x32_bf16 v[200:203], v[168:171], a[16:19], v[200:203]
  s_waitcnt lgkmcnt(6)
  ds_read_b64_tr_b16 v[164:165], v243 offset:61440
  ds_read_b64_tr_b16 v[166:167], v247 offset:2048
  v_mfma_f32_16x16x32_bf16 v[16:19], v[144:147], a[32:35], v[16:19]
  ds_read_b64_tr_b16 v[168:169], v244 offset:49152
  v_cmp_gt_u32 vcc, v223, v218
  v_mfma_f32_16x16x32_bf16 v[16:19], v[148:151], a[40:43], v[16:19]
  s_cbranch_vccnz L_g_sp3
L_g_bk3:
  ds_read_b64_tr_b16 v[170:171], v244 offset:55296
  v_mfma_f32_16x16x32_bf16 v[20:23], v[148:151], a[44:47], v[20:23]
  ds_read_b64_tr_b16 v[172:173], v244 offset:61440
  v_mfma_f32_16x16x32_bf16 v[20:23], v[144:147], a[36:39], v[20:23]
  s_waitcnt lgkmcnt(7)
  ds_read_b64_tr_b16 v[174:175], v248 offset:2048
  v_mfma_f32_16x16x32_bf16 v[44:47], v[152:155], a[36:39], v[44:47]
  buffer_load_dwordx4 a[0:3], v239, s[16:19], s60 offen sc1
  v_mfma_f32_16x16x32_bf16 v[44:47], v[156:159], a[44:47], v[44:47]
  ds_read_b64_tr_b16 v[144:145], v241 offset:50176
  ds_read_b64_tr_b16 v[146:147], v241 offset:56320
  v_mfma_f32_16x16x32_bf16 v[40:43], v[156:159], a[40:43], v[40:43]
  ds_read_b64_tr_b16 v[148:149], v241 offset:62464
  v_readlane_b32 s62, v222, 25
  v_mfma_f32_16x16x32_bf16 v[40:43], v[152:155], a[32:35], v[40:43]
  s_waitcnt lgkmcnt(7)
  ds_read_b64_tr_b16 v[150:151], v245 offset:3072
  v_mfma_f32_16x16x32_bf16 v[64:67], v[160:163], a[32:35], v[64:67]
  buffer_load_dwordx4 a[4:7], v240, s[16:19], s60 offen sc1
  v_mfma_f32_16x16x32_bf16 v[64:67], v[164:167], a[40:43], v[64:67]
  s_add_u32 m0, s63, 12288
  ds_read_b64_tr_b16 v[152:153], v242 offset:50176
  ds_read_b64_tr_b16 v[154:155], v242 offset:56320
  v_mfma_f32_16x16x32_bf16 v[68:71], v[164:167], a[44:47], v[68:71]
  s_mul_i32 s61, s62, 36864
  ds_read_b64_tr_b16 v[156:157], v242 offset:62464
  v_mfma_f32_16x16x32_bf16 v[68:71], v[160:163], a[36:39], v[68:71]
  s_waitcnt lgkmcnt(7)
  ds_read_b64_tr_b16 v[158:159], v246 offset:3072
  v_mfma_f32_16x16x32_bf16 v[188:191], v[168:171], a[36:39], v[188:191]
  ds_read_b64_tr_b16 v[160:161], v243 offset:50176
  v_mfma_f32_16x16x32_bf16 v[188:191], v[172:175], a[44:47], v[188:191]
  ds_read_b64_tr_b16 v[162:163], v243 offset:56320
  v_mfma_f32_16x16x32_bf16 v[184:187], v[172:175], a[40:43], v[184:187]
  buffer_load_dwordx4 v236, s[84:87], s61 offen lds
  v_mfma_f32_16x16x32_bf16 v[184:187], v[168:171], a[32:35], v[184:187]
  s_waitcnt lgkmcnt(6)
  ds_read_b64_tr_b16 v[164:165], v243 offset:62464
  ds_read_b64_tr_b16 v[166:167], v247 offset:3072
  v_mfma_f32_16x16x32_bf16 v[24:27], v[144:147], a[32:35], v[24:27]
  s_lshl_b32 s60, s62, 10
  ds_read_b64_tr_b16 v[168:169], v244 offset:50176
  v_mfma_f32_16x16x32_bf16 v[24:27], v[148:151], a[40:43], v[24:27]
  ds_read_b64_tr_b16 v[170:171], v244 offset:56320
  v_mfma_f32_16x16x32_bf16 v[28:31], v[148:151], a[44:47], v[28:31]
  buffer_load_dwordx4 v237, s[84:87], s61 offen offset:1024 lds
  v_mfma_f32_16x16x32_bf16 v[28:31], v[144:147], a[36:39], v[28:31]
  s_waitcnt lgkmcnt(6)
  ds_read_b64_tr_b16 v[172:173], v244 offset:62464
  ds_read_b64_tr_b16 v[174:175], v248 offset:3072
  v_mfma_f32_16x16x32_bf16 v[52:55], v[152:155], a[36:39], v[52:55]
  ds_read_b64_tr_b16 v[144:145], v241 offset:51200
  v_mfma_f32_16x16x32_bf16 v[52:55], v[156:159], a[44:47], v[52:55]
  ds_read_b64_tr_b16 v[146:147], v241 offset:57344
  v_mfma_f32_16x16x32_bf16 v[48:51], v[156:159], a[40:43], v[48:51]
  buffer_load_dwordx4 v238, s[84:87], s61 offen offset:2048 lds
  v_mfma_f32_16x16x32_bf16 v[48:51], v[152:155], a[32:35], v[48:51]
  s_waitcnt lgkmcnt(6)
  ds_read_b64_tr_b16 v[148:149], v241 offset:63488
  ds_read_b64_tr_b16 v[150:151], v245 offset:4096
  v_mfma_f32_16x16x32_bf16 v[72:75], v[160:163], a[32:35], v[72:75]
  ds_read_b64_tr_b16 v[152:153], v242 offset:51200
  v_mfma_f32_16x16x32_bf16 v[72:75], v[164:167], a[40:43], v[72:75]
  ds_read_b64_tr_b16 v[154:155], v242 offset:57344
  v_mfma_f32_16x16x32_bf16 v[76:79], v[164:167], a[44:47], v[76:79]
  ds_read_b64_tr_b16 v[156:157], v242 offset:63488
  v_mfma_f32_16x16x32_bf16 v[76:79], v[160:163], a[36:39], v[76:79]
  s_waitcnt lgkmcnt(7)
  ds_read_b64_tr_b16 v[158:159], v246 offset:4096
  v_mfma_f32_16x16x32_bf16 v[196:199], v[168:171], a[36:39], v[196:199]
  buffer_load_dwordx4 a[8:11], v239, s[16:19], s60 offen sc1
  v_mfma_f32_16x16x32_bf16 v[196:199], v[172:175], a[44:47], v[196:199]
  ds_read_b64_tr_b16 v[160:161], v243 offset:51200
  ds_read_b64_tr_b16 v[162:163], v243 offset:57344
  v_mfma_f32_16x16x32_bf16 v[192:195], v[172:175], a[40:43], v[192:195]
  ds_read_b64_tr_b16 v[164:165], v243 offset:63488
  v_readlane_b32 s62, v222, 26
  v_mfma_f32_16x16x32_bf16 v[192:195], v[168:171], a[32:35], v[192:195]
  s_waitcnt lgkmcnt(7)
  ds_read_b64_tr_b16 v[166:167], v247 offset:4096
  v_mfma_f32_16x16x32_bf16 v[32:35], v[144:147], a[32:35], v[32:35]
  buffer_load_dwordx4 a[12:15], v240, s[16:19], s60 offen sc1
  v_mfma_f32_16x16x32_bf16 v[32:35], v[148:151], a[40:43], v[32:35]
  s_add_u32 m0, s63, 24576
  ds_read_b64_tr_b16 v[168:169], v244 offset:51200
  ds_read_b64_tr_b16 v[170:171], v244 offset:57344
  v_mfma_f32_16x16x32_bf16 v[36:39], v[148:151], a[44:47], v[36:39]
  s_mul_i32 s61, s62, 36864
  ds_read_b64_tr_b16 v[172:173], v244 offset:63488
  v_mfma_f32_16x16x32_bf16 v[36:39], v[144:147], a[36:39], v[36:39]
  s_waitcnt lgkmcnt(7)
  ds_read_b64_tr_b16 v[174:175], v248 offset:4096
  v_mfma_f32_16x16x32_bf16 v[60:63], v[152:155], a[36:39], v[60:63]
  ds_read_b64_tr_b16 v[144:145], v245 offset:8192
  v_mfma_f32_16x16x32_bf16 v[60:63], v[156:159], a[44:47], v[60:63]
  ds_read_b64_tr_b16 v[146:147], v245 offset:14336
  v_mfma_f32_16x16x32_bf16 v[56:59], v[156:159], a[40:43], v[56:59]
  buffer_load_dwordx4 v236, s[84:87], s61 offen lds
  v_mfma_f32_16x16x32_bf16 v[56:59], v[152:155], a[32:35], v[56:59]
  s_waitcnt lgkmcnt(6)
  ds_read_b64_tr_b16 v[148:149], v245 offset:20480
  ds_read_b64_tr_b16 v[150:151], v245 offset:26624
  v_mfma_f32_16x16x32_bf16 v[176:179], v[160:163], a[32:35], v[176:179]
  s_lshl_b32 s60, s62, 10
  ds_read_b64_tr_b16 v[152:153], v246 offset:8192
  v_mfma_f32_16x16x32_bf16 v[176:179], v[164:167], a[40:43], v[176:179]
  ds_read_b64_tr_b16 v[154:155], v246 offset:14336
  v_mfma_f32_16x16x32_bf16 v[180:183], v[164:167], a[44:47], v[180:183]
  buffer_load_dwordx4 v237, s[84:87], s61 offen offset:1024 lds
  v_mfma_f32_16x16x32_bf16 v[180:183], v[160:163], a[36:39], v[180:183]
  s_waitcnt lgkmcnt(6)
  ds_read_b64_tr_b16 v[156:157], v246 offset:20480
  ds_read_b64_tr_b16 v[158:159], v246 offset:26624
  v_mfma_f32_16x16x32_bf16 v[204:207], v[168:171], a[36:39], v[204:207]
  ds_read_b64_tr_b16 v[160:161], v247 offset:8192
  v_mfma_f32_16x16x32_bf16 v[204:207], v[172:175], a[44:47], v[204:207]
  ds_read_b64_tr_b16 v[162:163], v247 offset:14336
  v_mfma_f32_16x16x32_bf16 v[200:203], v[172:175], a[40:43], v[200:203]
  buffer_load_dwordx4 v238, s[84:87], s61 offen offset:2048 lds
  v_mfma_f32_16x16x32_bf16 v[200:203], v[168:171], a[32:35], v[200:203]
  s_waitcnt lgkmcnt(6)
  ds_read_b64_tr_b16 v[164:165], v247 offset:20480
  ds_read_b64_tr_b16 v[166:167], v247 offset:26624
  v_mfma_f32_16x16x32_bf16 v[16:19], v[144:147], a[48:51], v[16:19]
  ds_read_b64_tr_b16 v[168:169], v248 offset:8192
  v_mfma_f32_16x16x32_bf16 v[16:19], v[148:151], a[56:59], v[16:19]
  ds_read_b64_tr_b16 v[170:171], v248 offset:14336
  v_mfma_f32_16x16x32_bf16 v[20:23], v[148:151], a[60:63], v[20:23]
  ds_read_b64_tr_b16 v[172:173], v248 offset:20480
  v_mfma_f32_16x16x32_bf16 v[20:23], v[144:147], a[52:55], v[20:23]
  s_waitcnt lgkmcnt(7)
  ds_read_b64_tr_b16 v[174:175], v248 offset:26624
  v_mfma_f32_16x16x32_bf16 v[44:47], v[152:155], a[52:55], v[44:47]
  buffer_load_dwordx4 a[16:19], v239, s[16:19], s60 offen sc1
  v_mfma_f32_16x16x32_bf16 v[44:47], v[156:159], a[60:63], v[44:47]
  ds_read_b64_tr_b16 v[144:145], v245 offset:9216
  ds_read_b64_tr_b16 v[146:147], v245 offset:15360
  v_mfma_f32_16x16x32_bf16 v[40:43], v[156:159], a[56:59], v[40:43]
  ds_read_b64_tr_b16 v[148:149], v245 offset:21504
  v_readlane_b32 s62, v222, 27
  v_mfma_f32_16x16x32_bf16 v[40:43], v[152:155], a[48:51], v[40:43]
  s_waitcnt lgkmcnt(7)
  ds_read_b64_tr_b16 v[150:151], v245 offset:27648
  v_mfma_f32_16x16x32_bf16 v[64:67], v[160:163], a[48:51], v[64:67]
  buffer_load_dwordx4 a[20:23], v240, s[16:19], s60 offen sc1
  v_mfma_f32_16x16x32_bf16 v[64:67], v[164:167], a[56:59], v[64:67]
  s_add_u32 m0, s63, 36864
  ds_read_b64_tr_b16 v[152:153], v246 offset:9216
  ds_read_b64_tr_b16 v[154:155], v246 offset:15360
  v_mfma_f32_16x16x32_bf16 v[68:71], v[164:167], a[60:63], v[68:71]
  s_mul_i32 s61, s62, 36864
  ds_read_b64_tr_b16 v[156:157], v246 offset:21504
  v_mfma_f32_16x16x32_bf16 v[68:71], v[160:163], a[52:55], v[68:71]
  s_waitcnt lgkmcnt(7)
  ds_read_b64_tr_b16 v[158:159], v246 offset:27648
  v_mfma_f32_16x16x32_bf16 v[188:191], v[168:171], a[52:55], v[188:191]
  ds_read_b64_tr_b16 v[160:161], v247 offset:9216
  v_mfma_f32_16x16x32_bf16 v[188:191], v[172:175], a[60:63], v[188:191]
  ds_read_b64_tr_b16 v[162:163], v247 offset:15360
  v_mfma_f32_16x16x32_bf16 v[184:187], v[172:175], a[56:59], v[184:187]
  buffer_load_dwordx4 v236, s[84:87], s61 offen lds
  v_mfma_f32_16x16x32_bf16 v[184:187], v[168:171], a[48:51], v[184:187]
  s_waitcnt lgkmcnt(6)
  ds_read_b64_tr_b16 v[164:165], v247 offset:21504
  ds_read_b64_tr_b16 v[166:167], v247 offset:27648
  v_mfma_f32_16x16x32_bf16 v[24:27], v[144:147], a[48:51], v[24:27]
  s_lshl_b32 s60, s62, 10
  ds_read_b64_tr_b16 v[168:169], v248 offset:9216
  v_mfma_f32_16x16x32_bf16 v[24:27], v[148:151], a[56:59], v[24:27]
  ds_read_b64_tr_b16 v[170:171], v248 offset:15360
  v_mfma_f32_16x16x32_bf16 v[28:31], v[148:151], a[60:63], v[28:31]
  buffer_load_dwordx4 v237, s[84:87], s61 offen offset:1024 lds
  v_mfma_f32_16x16x32_bf16 v[28:31], v[144:147], a[52:55], v[28:31]
  s_waitcnt lgkmcnt(6)
  ds_read_b64_tr_b16 v[172:173], v248 offset:21504
  ds_read_b64_tr_b16 v[174:175], v248 offset:27648
  v_mfma_f32_16x16x32_bf16 v[52:55], v[152:155], a[52:55], v[52:55]
  ds_read_b64_tr_b16 v[144:145], v245 offset:10240
  v_mfma_f32_16x16x32_bf16 v[52:55], v[156:159], a[60:63], v[52:55]
  ds_read_b64_tr_b16 v[146:147], v245 offset:16384
  v_mfma_f32_16x16x32_bf16 v[48:51], v[156:159], a[56:59], v[48:51]
  buffer_load_dwordx4 v238, s[84:87], s61 offen offset:2048 lds
  v_mfma_f32_16x16x32_bf16 v[48:51], v[152:155], a[48:51], v[48:51]
  s_waitcnt lgkmcnt(6)
  ds_read_b64_tr_b16 v[148:149], v245 offset:22528
  ds_read_b64_tr_b16 v[150:151], v245 offset:28672
  v_mfma_f32_16x16x32_bf16 v[72:75], v[160:163], a[48:51], v[72:75]
  ds_read_b64_tr_b16 v[152:153], v246 offset:10240
  v_mfma_f32_16x16x32_bf16 v[72:75], v[164:167], a[56:59], v[72:75]
  ds_read_b64_tr_b16 v[154:155], v246 offset:16384
  v_mfma_f32_16x16x32_bf16 v[76:79], v[164:167], a[60:63], v[76:79]
  ds_read_b64_tr_b16 v[156:157], v246 offset:22528
  v_mfma_f32_16x16x32_bf16 v[76:79], v[160:163], a[52:55], v[76:79]
  s_waitcnt lgkmcnt(7)
  ds_read_b64_tr_b16 v[158:159], v246 offset:28672
  v_mfma_f32_16x16x32_bf16 v[196:199], v[168:171], a[52:55], v[196:199]
  buffer_load_dwordx4 a[24:27], v239, s[16:19], s60 offen sc1
  v_mfma_f32_16x16x32_bf16 v[196:199], v[172:175], a[60:63], v[196:199]
  ds_read_b64_tr_b16 v[160:161], v247 offset:10240
  ds_read_b64_tr_b16 v[162:163], v247 offset:16384
  v_mfma_f32_16x16x32_bf16 v[192:195], v[172:175], a[56:59], v[192:195]
  ds_read_b64_tr_b16 v[164:165], v247 offset:22528
  v_readlane_b32 s62, v222, 28
  v_mfma_f32_16x16x32_bf16 v[192:195], v[168:171], a[48:51], v[192:195]
  s_waitcnt lgkmcnt(7)
  ds_read_b64_tr_b16 v[166:167], v247 offset:28672
  v_mfma_f32_16x16x32_bf16 v[32:35], v[144:147], a[48:51], v[32:35]
  buffer_load_dwordx4 a[28:31], v240, s[16:19], s60 offen sc1
  v_mfma_f32_16x16x32_bf16 v[32:35], v[148:151], a[56:59], v[32:35]
  s_add_u32 m0, s63, 49152
  ds_read_b64_tr_b16 v[168:169], v248 offset:10240
  ds_read_b64_tr_b16 v[170:171], v248 offset:16384
  v_mfma_f32_16x16x32_bf16 v[36:39], v[148:151], a[60:63], v[36:39]
  s_waitcnt vmcnt(20)
  ds_read_b64_tr_b16 v[172:173], v248 offset:22528
  v_mfma_f32_16x16x32_bf16 v[36:39], v[144:147], a[52:55], v[36:39]
  s_waitcnt lgkmcnt(7)
  ds_read_b64_tr_b16 v[174:175], v248 offset:28672
  v_mfma_f32_16x16x32_bf16 v[60:63], v[152:155], a[52:55], v[60:63]
  s_barrier
  ds_read_b64_tr_b16 v[144:145], v245 offset:32768
  v_mfma_f32_16x16x32_bf16 v[60:63], v[156:159], a[60:63], v[60:63]
  s_mul_i32 s61, s62, 36864
  ds_read_b64_tr_b16 v[146:147], v245 offset:38912
  v_mfma_f32_16x16x32_bf16 v[56:59], v[156:159], a[56:59], v[56:59]
  buffer_load_dwordx4 v236, s[84:87], s61 offen lds
  v_mfma_f32_16x16x32_bf16 v[56:59], v[152:155], a[48:51], v[56:59]
  s_waitcnt lgkmcnt(6)
  ds_read_b64_tr_b16 v[148:149], v245 offset:45056
  ds_read_b64_tr_b16 v[150:151], v245 offset:51200
  v_mfma_f32_16x16x32_bf16 v[176:179], v[160:163], a[48:51], v[176:179]
  buffer_load_dword v218, v220, s[4:7], 0 offen sc1
  v_mfma_f32_16x16x32_bf16 v[176:179], v[164:167], a[56:59], v[176:179]
  s_lshl_b32 s60, s62, 10
  ds_read_b64_tr_b16 v[152:153], v246 offset:32768
  ds_read_b64_tr_b16 v[154:155], v246 offset:38912
  v_mfma_f32_16x16x32_bf16 v[180:183], v[164:167], a[60:63], v[180:183]
  buffer_load_dwordx4 v237, s[84:87], s61 offen offset:1024 lds
  v_mfma_f32_16x16x32_bf16 v[180:183], v[160:163], a[52:55], v[180:183]
  s_waitcnt lgkmcnt(6)
  ds_read_b64_tr_b16 v[156:157], v246 offset:45056
  ds_read_b64_tr_b16 v[158:159], v246 offset:51200
  v_mfma_f32_16x16x32_bf16 v[204:207], v[168:171], a[52:55], v[204:207]
  ds_read_b64_tr_b16 v[160:161], v247 offset:32768
  v_mfma_f32_16x16x32_bf16 v[204:207], v[172:175], a[60:63], v[204:207]
  ds_read_b64_tr_b16 v[162:163], v247 offset:38912
  v_mfma_f32_16x16x32_bf16 v[200:203], v[172:175], a[56:59], v[200:203]
  buffer_load_dwordx4 v238, s[84:87], s61 offen offset:2048 lds
  v_mfma_f32_16x16x32_bf16 v[200:203], v[168:171], a[48:51], v[200:203]
  s_waitcnt lgkmcnt(6)
  ds_read_b64_tr_b16 v[164:165], v247 offset:45056
  ds_read_b64_tr_b16 v[166:167], v247 offset:51200
  v_mfma_f32_16x16x32_bf16 v[16:19], v[144:147], a[64:67], v[16:19]
  ds_read_b64_tr_b16 v[168:169], v248 offset:32768
  v_mfma_f32_16x16x32_bf16 v[16:19], v[148:151], a[72:75], v[16:19]
  ds_read_b64_tr_b16 v[170:171], v248 offset:38912
  v_mfma_f32_16x16x32_bf16 v[20:23], v[148:151], a[76:79], v[20:23]
  ds_read_b64_tr_b16 v[172:173], v248 offset:45056
  v_mfma_f32_16x16x32_bf16 v[20:23], v[144:147], a[68:71], v[20:23]
  s_waitcnt lgkmcnt(7)
  ds_read_b64_tr_b16 v[174:175], v248 offset:51200
  v_mfma_f32_16x16x32_bf16 v[44:47], v[152:155], a[68:71], v[44:47]
  buffer_load_dwordx4 a[32:35], v239, s[16:19], s60 offen sc1
  v_mfma_f32_16x16x32_bf16 v[44:47], v[156:159], a[76:79], v[44:47]
  ds_read_b64_tr_b16 v[144:145], v245 offset:33792
  ds_read_b64_tr_b16 v[146:147], v245 offset:39936
  v_mfma_f32_16x16x32_bf16 v[40:43], v[156:159], a[72:75], v[40:43]
  ds_read_b64_tr_b16 v[148:149], v245 offset:46080
  v_readlane_b32 s62, v222, 29
  v_mfma_f32_16x16x32_bf16 v[40:43], v[152:155], a[64:67], v[40:43]
  s_waitcnt lgkmcnt(7)
  ds_read_b64_tr_b16 v[150:151], v245 offset:52224
  v_mfma_f32_16x16x32_bf16 v[64:67], v[160:163], a[64:67], v[64:67]
  buffer_load_dwordx4 a[36:39], v240, s[16:19], s60 offen sc1
  v_mfma_f32_16x16x32_bf16 v[64:67], v[164:167], a[72:75], v[64:67]
  s_add_u32 m0, s63, 61440
  ds_read_b64_tr_b16 v[152:153], v246 offset:33792
  ds_read_b64_tr_b16 v[154:155], v246 offset:39936
  v_mfma_f32_16x16x32_bf16 v[68:71], v[164:167], a[76:79], v[68:71]
  s_mul_i32 s61, s62, 36864
  ds_read_b64_tr_b16 v[156:157], v246 offset:46080
  v_mfma_f32_16x16x32_bf16 v[68:71], v[160:163], a[68:71], v[68:71]
  s_waitcnt lgkmcnt(7)
  ds_read_b64_tr_b16 v[158:159], v246 offset:52224
  v_mfma_f32_16x16x32_bf16 v[188:191], v[168:171], a[68:71], v[188:191]
  ds_read_b64_tr_b16 v[160:161], v247 offset:33792
  v_mfma_f32_16x16x32_bf16 v[188:191], v[172:175], a[76:79], v[188:191]
  ds_read_b64_tr_b16 v[162:163], v247 offset:39936
  v_mfma_f32_16x16x32_bf16 v[184:187], v[172:175], a[72:75], v[184:187]
  buffer_load_dwordx4 v236, s[84:87], s61 offen lds
  v_mfma_f32_16x16x32_bf16 v[184:187], v[168:171], a[64:67], v[184:187]
  s_waitcnt lgkmcnt(6)
  ds_read_b64_tr_b16 v[164:165], v247 offset:46080
  ds_read_b64_tr_b16 v[166:167], v247 offset:52224
  v_mfma_f32_16x16x32_bf16 v[24:27], v[144:147], a[64:67], v[24:27]
  s_lshl_b32 s60, s62, 10
  ds_read_b64_tr_b16 v[168:169], v248 offset:33792
  v_mfma_f32_16x16x32_bf16 v[24:27], v[148:151], a[72:75], v[24:27]
  ds_read_b64_tr_b16 v[170:171], v248 offset:39936
  v_mfma_f32_16x16x32_bf16 v[28:31], v[148:151], a[76:79], v[28:31]
  buffer_load_dwordx4 v237, s[84:87], s61 offen offset:1024 lds
  v_mfma_f32_16x16x32_bf16 v[28:31], v[144:147], a[68:71], v[28:31]
  s_waitcnt lgkmcnt(6)
  ds_read_b64_tr_b16 v[172:173], v248 offset:46080
  ds_read_b64_tr_b16 v[174:175], v248 offset:52224
  v_mfma_f32_16x16x32_bf16 v[52:55], v[152:155], a[68:71], v[52:55]
  ds_read_b64_tr_b16 v[144:145], v245 offset:34816
  v_mfma_f32_16x16x32_bf16 v[52:55], v[156:159], a[76:79], v[52:55]
  ds_read_b64_tr_b16 v[146:147], v245 offset:40960
  v_mfma_f32_16x16x32_bf16 v[48:51], v[156:159], a[72:75], v[48:51]
  buffer_load_dwordx4 v238, s[84:87], s61 offen offset:2048 lds
  v_mfma_f32_16x16x32_bf16 v[48:51], v[152:155], a[64:67], v[48:51]
  s_waitcnt lgkmcnt(6)
  ds_read_b64_tr_b16 v[148:149], v245 offset:47104
  ds_read_b64_tr_b16 v[150:151], v245 offset:53248
  v_mfma_f32_16x16x32_bf16 v[72:75], v[160:163], a[64:67], v[72:75]
  global_load_dword v253, v14, s[68:69]
  v_mfma_f32_16x16x32_bf16 v[72:75], v[164:167], a[72:75], v[72:75]
  ds_read_b64_tr_b16 v[152:153], v246 offset:34816
  ds_read_b64_tr_b16 v[154:155], v246 offset:40960
  v_mfma_f32_16x16x32_bf16 v[76:79], v[164:167], a[76:79], v[76:79]
  ds_read_b64_tr_b16 v[156:157], v246 offset:47104
  v_mfma_f32_16x16x32_bf16 v[76:79], v[160:163], a[68:71], v[76:79]
  s_waitcnt lgkmcnt(7)
  ds_read_b64_tr_b16 v[158:159], v246 offset:53248
  v_mfma_f32_16x16x32_bf16 v[196:199], v[168:171], a[68:71], v[196:199]
  buffer_load_dwordx4 a[40:43], v239, s[16:19], s60 offen sc1
  v_mfma_f32_16x16x32_bf16 v[196:199], v[172:175], a[76:79], v[196:199]
  ds_read_b64_tr_b16 v[160:161], v247 offset:34816
  ds_read_b64_tr_b16 v[162:163], v247 offset:40960
  v_mfma_f32_16x16x32_bf16 v[192:195], v[172:175], a[72:75], v[192:195]
  ds_read_b64_tr_b16 v[164:165], v247 offset:47104
  v_readlane_b32 s62, v222, 30
  v_mfma_f32_16x16x32_bf16 v[192:195], v[168:171], a[64:67], v[192:195]
  s_waitcnt lgkmcnt(7)
  ds_read_b64_tr_b16 v[166:167], v247 offset:53248
  v_mfma_f32_16x16x32_bf16 v[32:35], v[144:147], a[64:67], v[32:35]
  buffer_load_dwordx4 a[44:47], v240, s[16:19], s60 offen sc1
  v_mfma_f32_16x16x32_bf16 v[32:35], v[148:151], a[72:75], v[32:35]
  s_add_u32 m0, s63, 73728
  ds_read_b64_tr_b16 v[168:169], v248 offset:34816
  ds_read_b64_tr_b16 v[170:171], v248 offset:40960
  v_mfma_f32_16x16x32_bf16 v[36:39], v[148:151], a[76:79], v[36:39]
  s_mul_i32 s61, s62, 36864
  ds_read_b64_tr_b16 v[172:173], v248 offset:47104
  v_mfma_f32_16x16x32_bf16 v[36:39], v[144:147], a[68:71], v[36:39]
  s_waitcnt lgkmcnt(7)
  ds_read_b64_tr_b16 v[174:175], v248 offset:53248
  v_mfma_f32_16x16x32_bf16 v[60:63], v[152:155], a[68:71], v[60:63]
  ds_read_b64_tr_b16 v[144:145], v245 offset:57344
  v_mfma_f32_16x16x32_bf16 v[60:63], v[156:159], a[76:79], v[60:63]
  ds_read_b64_tr_b16 v[146:147], v245 offset:63488
  v_mfma_f32_16x16x32_bf16 v[56:59], v[156:159], a[72:75], v[56:59]
  buffer_load_dwordx4 v236, s[84:87], s61 offen lds
  v_mfma_f32_16x16x32_bf16 v[56:59], v[152:155], a[64:67], v[56:59]
  s_waitcnt lgkmcnt(6)
  ds_read_b64_tr_b16 v[148:149], v249 offset:4096
  ds_read_b64_tr_b16 v[150:151], v249 offset:10240
  v_mfma_f32_16x16x32_bf16 v[176:179], v[160:163], a[64:67], v[176:179]
  s_lshl_b32 s60, s62, 10
  ds_read_b64_tr_b16 v[152:153], v246 offset:57344
  v_mfma_f32_16x16x32_bf16 v[176:179], v[164:167], a[72:75], v[176:179]
  ds_read_b64_tr_b16 v[154:155], v246 offset:63488
  v_mfma_f32_16x16x32_bf16 v[180:183], v[164:167], a[76:79], v[180:183]
  buffer_load_dwordx4 v237, s[84:87], s61 offen offset:1024 lds
  v_mfma_f32_16x16x32_bf16 v[180:183], v[160:163], a[68:71], v[180:183]
  s_waitcnt lgkmcnt(6)
  ds_read_b64_tr_b16 v[156:157], v250 offset:4096
  ds_read_b64_tr_b16 v[158:159], v250 offset:10240
  v_mfma_f32_16x16x32_bf16 v[204:207], v[168:171], a[68:71], v[204:207]
  ds_read_b64_tr_b16 v[160:161], v247 offset:57344
  v_mfma_f32_16x16x32_bf16 v[204:207], v[172:175], a[76:79], v[204:207]
  ds_read_b64_tr_b16 v[162:163], v247 offset:63488
  v_mfma_f32_16x16x32_bf16 v[200:203], v[172:175], a[72:75], v[200:203]
  buffer_load_dwordx4 v238, s[84:87], s61 offen offset:2048 lds
  v_mfma_f32_16x16x32_bf16 v[200:203], v[168:171], a[64:67], v[200:203]
  s_waitcnt lgkmcnt(6)
  ds_read_b64_tr_b16 v[164:165], v251 offset:4096
  ds_read_b64_tr_b16 v[166:167], v251 offset:10240
  v_mfma_f32_16x16x32_bf16 v[16:19], v[144:147], a[80:83], v[16:19]
  ds_read_b64_tr_b16 v[168:169], v248 offset:57344
  v_mfma_f32_16x16x32_bf16 v[16:19], v[148:151], a[88:91], v[16:19]
  ds_read_b64_tr_b16 v[170:171], v248 offset:63488
  v_mfma_f32_16x16x32_bf16 v[20:23], v[148:151], a[92:95], v[20:23]
  ds_read_b64_tr_b16 v[172:173], v252 offset:4096
  v_mfma_f32_16x16x32_bf16 v[20:23], v[144:147], a[84:87], v[20:23]
  s_waitcnt lgkmcnt(7)
  ds_read_b64_tr_b16 v[174:175], v252 offset:10240
  v_mfma_f32_16x16x32_bf16 v[44:47], v[152:155], a[84:87], v[44:47]
  buffer_load_dwordx4 a[48:51], v239, s[16:19], s60 offen sc1
  v_mfma_f32_16x16x32_bf16 v[44:47], v[156:159], a[92:95], v[44:47]
  ds_read_b64_tr_b16 v[144:145], v245 offset:58368
  ds_read_b64_tr_b16 v[146:147], v245 offset:64512
  v_mfma_f32_16x16x32_bf16 v[40:43], v[156:159], a[88:91], v[40:43]
  ds_read_b64_tr_b16 v[148:149], v249 offset:5120
  v_readlane_b32 s62, v222, 31
  v_mfma_f32_16x16x32_bf16 v[40:43], v[152:155], a[80:83], v[40:43]
  s_waitcnt lgkmcnt(7)
  ds_read_b64_tr_b16 v[150:151], v249 offset:11264
  v_mfma_f32_16x16x32_bf16 v[64:67], v[160:163], a[80:83], v[64:67]
  buffer_load_dwordx4 a[52:55], v240, s[16:19], s60 offen sc1
  v_mfma_f32_16x16x32_bf16 v[64:67], v[164:167], a[88:91], v[64:67]
  s_add_u32 m0, s63, 86016
  ds_read_b64_tr_b16 v[152:153], v246 offset:58368
  ds_read_b64_tr_b16 v[154:155], v246 offset:64512
  v_mfma_f32_16x16x32_bf16 v[68:71], v[164:167], a[92:95], v[68:71]
  s_mul_i32 s61, s62, 36864
  ds_read_b64_tr_b16 v[156:157], v250 offset:5120
  v_mfma_f32_16x16x32_bf16 v[68:71], v[160:163], a[84:87], v[68:71]
  s_waitcnt lgkmcnt(7)
  ds_read_b64_tr_b16 v[158:159], v250 offset:11264
  v_mfma_f32_16x16x32_bf16 v[188:191], v[168:171], a[84:87], v[188:191]
  ds_read_b64_tr_b16 v[160:161], v247 offset:58368
  v_mfma_f32_16x16x32_bf16 v[188:191], v[172:175], a[92:95], v[188:191]
  ds_read_b64_tr_b16 v[162:163], v247 offset:64512
  v_mfma_f32_16x16x32_bf16 v[184:187], v[172:175], a[88:91], v[184:187]
  buffer_load_dwordx4 v236, s[84:87], s61 offen lds
  v_mfma_f32_16x16x32_bf16 v[184:187], v[168:171], a[80:83], v[184:187]
  s_waitcnt lgkmcnt(6)
  ds_read_b64_tr_b16 v[164:165], v251 offset:5120
  ds_read_b64_tr_b16 v[166:167], v251 offset:11264
  v_mfma_f32_16x16x32_bf16 v[24:27], v[144:147], a[80:83], v[24:27]
  s_lshl_b32 s60, s62, 10
  ds_read_b64_tr_b16 v[168:169], v248 offset:58368
  v_mfma_f32_16x16x32_bf16 v[24:27], v[148:151], a[88:91], v[24:27]
  ds_read_b64_tr_b16 v[170:171], v248 offset:64512
  v_mfma_f32_16x16x32_bf16 v[28:31], v[148:151], a[92:95], v[28:31]
  buffer_load_dwordx4 v237, s[84:87], s61 offen offset:1024 lds
  v_mfma_f32_16x16x32_bf16 v[28:31], v[144:147], a[84:87], v[28:31]
  s_waitcnt lgkmcnt(6)
  ds_read_b64_tr_b16 v[172:173], v252 offset:5120
  ds_read_b64_tr_b16 v[174:175], v252 offset:11264
  v_mfma_f32_16x16x32_bf16 v[52:55], v[152:155], a[84:87], v[52:55]
  ds_read_b64_tr_b16 v[144:145], v245 offset:59392
  v_and_b32 v223, 15, v221
  v_mfma_f32_16x16x32_bf16 v[52:55], v[156:159], a[92:95], v[52:55]
  ds_read_b64_tr_b16 v[146:147], v249 offset:0
  v_lshrrev_b32_e64 v221, 4, v221
  v_mfma_f32_16x16x32_bf16 v[48:51], v[156:159], a[88:91], v[48:51]
  buffer_load_dwordx4 v238, s[84:87], s61 offen offset:2048 lds
  v_mfma_f32_16x16x32_bf16 v[48:51], v[152:155], a[80:83], v[48:51]
  s_waitcnt lgkmcnt(6)
  ds_read_b64_tr_b16 v[148:149], v249 offset:6144
  ds_read_b64_tr_b16 v[150:151], v249 offset:12288
  v_mfma_f32_16x16x32_bf16 v[72:75], v[160:163], a[80:83], v[72:75]
L_pg9:
  s_cbranch_execz L_back
  ds_read_b64_tr_b16 v[152:153], v246 offset:59392
  v_mfma_f32_16x16x32_bf16 v[72:75], v[164:167], a[88:91], v[72:75]
  ds_read_b64_tr_b16 v[154:155], v250 offset:0
  v_mfma_f32_16x16x32_bf16 v[76:79], v[164:167], a[92:95], v[76:79]
  ds_read_b64_tr_b16 v[156:157], v250 offset:6144
  v_mfma_f32_16x16x32_bf16 v[76:79], v[160:163], a[84:87], v[76:79]
  s_waitcnt lgkmcnt(7)
  ds_read_b64_tr_b16 v[158:159], v250 offset:12288
  v_mfma_f32_16x16x32_bf16 v[196:199], v[168:171], a[84:87], v[196:199]
  buffer_load_dwordx4 a[56:59], v239, s[16:19], s60 offen sc1
  v_mfma_f32_16x16x32_bf16 v[196:199], v[172:175], a[92:95], v[196:199]
  ds_read_b64_tr_b16 v[160:161], v247 offset:59392
  ds_read_b64_tr_b16 v[162:163], v251 offset:0
  v_mfma_f32_16x16x32_bf16 v[192:195], v[172:175], a[88:91], v[192:195]
  ds_read_b64_tr_b16 v[164:165], v251 offset:6144
  v_readlane_b32 s62, v222, 32
  v_mfma_f32_16x16x32_bf16 v[192:195], v[168:171], a[80:83], v[192:195]
  s_waitcnt lgkmcnt(7)
  ds_read_b64_tr_b16 v[166:167], v251 offset:12288
  v_mfma_f32_16x16x32_bf16 v[32:35], v[144:147], a[80:83], v[32:35]
  buffer_load_dwordx4 a[60:63], v240, s[16:19], s60 offen sc1
  v_mfma_f32_16x16x32_bf16 v[32:35], v[148:151], a[88:91], v[32:35]
  s_add_u32 m0, s63, 98304
  ds_read_b64_tr_b16 v[168:169], v248 offset:59392
  ds_read_b64_tr_b16 v[170:171], v252 offset:0
  v_mfma_f32_16x16x32_bf16 v[36:39], v[148:151], a[92:95], v[36:39]
  s_waitcnt vmcnt(20)
  ds_read_b64_tr_b16 v[172:173], v252 offset:6144
  v_mfma_f32_16x16x32_bf16 v[36:39], v[144:147], a[84:87], v[36:39]
  s_waitcnt lgkmcnt(7)
  ds_read_b64_tr_b16 v[174:175], v252 offset:12288
  v_mfma_f32_16x16x32_bf16 v[60:63], v[152:155], a[84:87], v[60:63]
  s_barrier
  ds_read_b64_tr_b16 v[144:145], v241 offset:0
  v_mfma_f32_16x16x32_bf16 v[60:63], v[156:159], a[92:95], v[60:63]
  s_mul_i32 s61, s62, 36864
  ds_read_b64_tr_b16 v[146:147], v241 offset:6144
  v_mfma_f32_16x16x32_bf16 v[56:59], v[156:159], a[88:91], v[56:59]
  buffer_load_dwordx4 v236, s[84:87], s61 offen lds
  v_mfma_f32_16x16x32_bf16 v[56:59], v[152:155], a[80:83], v[56:59]
  s_waitcnt lgkmcnt(6)
  ds_read_b64_tr_b16 v[148:149], v241 offset:12288
  ds_read_b64_tr_b16 v[150:151], v241 offset:18432
  v_mfma_f32_16x16x32_bf16 v[176:179], v[160:163], a[80:83], v[176:179]
  s_lshl_b32 s60, s62, 10
  ds_read_b64_tr_b16 v[152:153], v242 offset:0
  v_mfma_f32_16x16x32_bf16 v[176:179], v[164:167], a[88:91], v[176:179]
  ds_read_b64_tr_b16 v[154:155], v242 offset:6144
  v_mfma_f32_16x16x32_bf16 v[180:183], v[164:167], a[92:95], v[180:183]
  buffer_load_dwordx4 v237, s[84:87], s61 offen offset:1024 lds
  v_mfma_f32_16x16x32_bf16 v[180:183], v[160:163], a[84:87], v[180:183]
  s_waitcnt lgkmcnt(6)
  ds_read_b64_tr_b16 v[156:157], v242 offset:12288
  ds_read_b64_tr_b16 v[158:159], v242 offset:18432
  v_mfma_f32_16x16x32_bf16 v[204:207], v[168:171], a[84:87], v[204:207]
  ds_read_b64_tr_b16 v[160:161], v243 offset:0
  v_mfma_f32_16x16x32_bf16 v[204:207], v[172:175], a[92:95], v[204:207]
  ds_read_b64_tr_b16 v[162:163], v243 offset:6144
  v_mfma_f32_16x16x32_bf16 v[200:203], v[172:175], a[88:91], v[200:203]
  buffer_load_dwordx4 v238, s[84:87], s61 offen offset:2048 lds
  v_mfma_f32_16x16x32_bf16 v[200:203], v[168:171], a[80:83], v[200:203]
  s_waitcnt lgkmcnt(6)
  ds_read_b64_tr_b16 v[164:165], v243 offset:12288
  ds_read_b64_tr_b16 v[166:167], v243 offset:18432
  v_mfma_f32_16x16x32_bf16 v[16:19], v[144:147], a[0:3], v[16:19]
  ds_read_b64_tr_b16 v[168:169], v241 offset:1024
  v_cmp_gt_u32 vcc, v223, v218
  v_mfma_f32_16x16x32_bf16 v[16:19], v[148:151], a[8:11], v[16:19]
  s_cbranch_vccnz L_g_sp4
L_g_bk4:
  ds_read_b64_tr_b16 v[170:171], v241 offset:7168
  v_mfma_f32_16x16x32_bf16 v[20:23], v[148:151], a[12:15], v[20:23]
  buffer_load_dwordx4 a[64:67], v239, s[16:19], s60 offen sc1
  v_mfma_f32_16x16x32_bf16 v[20:23], v[144:147], a[4:7], v[20:23]
  s_waitcnt lgkmcnt(6)
  ds_read_b64_tr_b16 v[172:173], v241 offset:13312
  ds_read_b64_tr_b16 v[174:175], v241 offset:19456
  v_mfma_f32_16x16x32_bf16 v[44:47], v[152:155], a[4:7], v[44:47]
  ds_read_b64_tr_b16 v[144:145], v242 offset:1024
  v_readlane_b32 s62, v222, 33
  v_mfma_f32_16x16x32_bf16 v[44:47], v[156:159], a[12:15], v[44:47]
  ds_read_b64_tr_b16 v[146:147], v242 offset:7168
  v_mfma_f32_16x16x32_bf16 v[40:43], v[156:159], a[8:11], v[40:43]
  buffer_load_dwordx4 a[68:71], v240, s[16:19], s60 offen sc1
  v_mfma_f32_16x16x32_bf16 v[40:43], v[152:155], a[0:3], v[40:43]
  s_waitcnt lgkmcnt(6)
  ds_read_b64_tr_b16 v[148:149], v242 offset:13312
  ds_read_b64_tr_b16 v[150:151], v242 offset:19456
  v_mfma_f32_16x16x32_bf16 v[64:67], v[160:163], a[0:3], v[64:67]
  s_add_u32 m0, s63, 110592
  ds_read_b64_tr_b16 v[152:153], v243 offset:1024
  v_mfma_f32_16x16x32_bf16 v[64:67], v[164:167], a[8:11], v[64:67]
  s_mul_i32 s61, s62, 36864
  ds_read_b64_tr_b16 v[154:155], v243 offset:7168
  v_mfma_f32_16x16x32_bf16 v[68:71], v[164:167], a[12:15], v[68:71]
  buffer_load_dwordx4 v236, s[84:87], s61 offen lds
  v_mfma_f32_16x16x32_bf16 v[68:71], v[160:163], a[4:7], v[68:71]
  s_waitcnt lgkmcnt(6)
  ds_read_b64_tr_b16 v[156:157], v243 offset:13312
  ds_read_b64_tr_b16 v[158:159], v243 offset:19456
  v_mfma_f32_16x16x32_bf16 v[28:31], v[168:171], a[4:7], v[28:31]
  s_lshl_b32 s60, s62, 10
  ds_read_b64_tr_b16 v[160:161], v241 offset:2048
  v_mfma_f32_16x16x32_bf16 v[28:31], v[172:175], a[12:15], v[28:31]
  ds_read_b64_tr_b16 v[162:163], v241 offset:8192
  v_mfma_f32_16x16x32_bf16 v[24:27], v[172:175], a[8:11], v[24:27]
  buffer_load_dwordx4 v237, s[84:87], s61 offen offset:1024 lds
  v_mfma_f32_16x16x32_bf16 v[24:27], v[168:171], a[0:3], v[24:27]
  s_waitcnt lgkmcnt(6)
  ds_read_b64_tr_b16 v[164:165], v241 offset:14336
  ds_read_b64_tr_b16 v[166:167], v241 offset:20480
  v_mfma_f32_16x16x32_bf16 v[48:51], v[144:147], a[0:3], v[48:51]
  buffer_load_dwordx4 v238, s[84:87], s61 offen offset:2048 lds
  v_mfma_f32_16x16x32_bf16 v[48:51], v[148:151], a[8:11], v[48:51]
  ds_read_b64_tr_b16 v[168:169], v242 offset:2048
  ds_read_b64_tr_b16 v[170:171], v242 offset:8192
  v_mfma_f32_16x16x32_bf16 v[52:55], v[148:151], a[12:15], v[52:55]
  ds_read_b64_tr_b16 v[172:173], v242 offset:14336
  v_mfma_f32_16x16x32_bf16 v[52:55], v[144:147], a[4:7], v[52:55]
  s_waitcnt lgkmcnt(7)
  ds_read_b64_tr_b16 v[174:175], v242 offset:20480
  v_mfma_f32_16x16x32_bf16 v[76:79], v[152:155], a[4:7], v[76:79]
  buffer_load_dwordx4 a[72:75], v239, s[16:19], s60 offen sc1
  v_mfma_f32_16x16x32_bf16 v[76:79], v[156:159], a[12:15], v[76:79]
  ds_read_b64_tr_b16 v[144:145], v243 offset:2048
  ds_read_b64_tr_b16 v[146:147], v243 offset:8192
  v_mfma_f32_16x16x32_bf16 v[72:75], v[156:159], a[8:11], v[72:75]
  ds_read_b64_tr_b16 v[148:149], v243 offset:14336
  v_readlane_b32 s62, v222, 34
  v_mfma_f32_16x16x32_bf16 v[72:75], v[152:155], a[0:3], v[72:75]
  s_waitcnt lgkmcnt(7)
  ds_read_b64_tr_b16 v[150:151], v243 offset:20480
  v_mfma_f32_16x16x32_bf16 v[32:35], v[160:163], a[0:3], v[32:35]
  buffer_load_dwordx4 a[76:79], v240, s[16:19], s60 offen sc1
  v_mfma_f32_16x16x32_bf16 v[32:35], v[164:167], a[8:11], v[32:35]
  s_add_u32 m0, s63, 122880
  ds_read_b64_tr_b16 v[152:153], v241 offset:24576
  ds_read_b64_tr_b16 v[154:155], v241 offset:30720
  v_mfma_f32_16x16x32_bf16 v[36:39], v[164:167], a[12:15], v[36:39]
  s_mul_i32 s61, s62, 36864
  ds_read_b64_tr_b16 v[156:157], v241 offset:36864
  v_mfma_f32_16x16x32_bf16 v[36:39], v[160:163], a[4:7], v[36:39]
  s_waitcnt lgkmcnt(7)
  ds_read_b64_tr_b16 v[158:159], v241 offset:43008
  v_mfma_f32_16x16x32_bf16 v[60:63], v[168:171], a[4:7], v[60:63]
  buffer_load_dwordx4 v236, s[84:87], s61 offen lds
  v_mfma_f32_16x16x32_bf16 v[60:63], v[172:175], a[12:15], v[60:63]
  s_lshl_b32 s60, s62, 10
  ds_read_b64_tr_b16 v[160:161], v242 offset:24576
  ds_read_b64_tr_b16 v[162:163], v242 offset:30720
  v_mfma_f32_16x16x32_bf16 v[56:59], v[172:175], a[8:11], v[56:59]
  ds_read_b64_tr_b16 v[164:165], v242 offset:36864
  v_mfma_f32_16x16x32_bf16 v[56:59], v[168:171], a[0:3], v[56:59]
  s_waitcnt lgkmcnt(7)
  ds_read_b64_tr_b16 v[166:167], v242 offset:43008
  v_mfma_f32_16x16x32_bf16 v[176:179], v[144:147], a[0:3], v[176:179]
  buffer_load_dwordx4 v237, s[84:87], s61 offen offset:1024 lds
  v_mfma_f32_16x16x32_bf16 v[176:179], v[148:151], a[8:11], v[176:179]
  ds_read_b64_tr_b16 v[168:169], v243 offset:24576
  ds_read_b64_tr_b16 v[170:171], v243 offset:30720
  v_mfma_f32_16x16x32_bf16 v[180:183], v[148:151], a[12:15], v[180:183]
  buffer_load_dwordx4 v238, s[84:87], s61 offen offset:2048 lds
  v_mfma_f32_16x16x32_bf16 v[180:183], v[144:147], a[4:7], v[180:183]
  s_waitcnt lgkmcnt(6)
  ds_read_b64_tr_b16 v[172:173], v243 offset:36864
  ds_read_b64_tr_b16 v[174:175], v243 offset:43008
  v_mfma_f32_16x16x32_bf16 v[20:23], v[152:155], a[20:23], v[20:23]
  ds_read_b64_tr_b16 v[144:145], v241 offset:25600
  v_mfma_f32_16x16x32_bf16 v[20:23], v[156:159], a[28:31], v[20:23]
  ds_read_b64_tr_b16 v[146:147], v241 offset:31744
  v_mfma_f32_16x16x32_bf16 v[16:19], v[156:159], a[24:27], v[16:19]
  buffer_load_dwordx4 a[80:83], v239, s[16:19], s60 offen sc1
  v_mfma_f32_16x16x32_bf16 v[16:19], v[152:155], a[16:19], v[16:19]
  s_waitcnt lgkmcnt(6)
  ds_read_b64_tr_b16 v[148:149], v241 offset:37888
  ds_read_b64_tr_b16 v[150:151], v241 offset:44032
  v_mfma_f32_16x16x32_bf16 v[40:43], v[160:163], a[16:19], v[40:43]
  ds_read_b64_tr_b16 v[152:153], v242 offset:25600
  v_readlane_b32 s62, v222, 35
  v_mfma_f32_16x16x32_bf16 v[40:43], v[164:167], a[24:27], v[40:43]
  ds_read_b64_tr_b16 v[154:155], v242 offset:31744
  v_mfma_f32_16x16x32_bf16 v[44:47], v[164:167], a[28:31], v[44:47]
  buffer_load_dwordx4 a[84:87], v240, s[16:19], s60 offen sc1
  v_mfma_f32_16x16x32_bf16 v[44:47], v[160:163], a[20:23], v[44:47]
  s_waitcnt lgkmcnt(6)
  ds_read_b64_tr_b16 v[156:157], v242 offset:37888
  ds_read_b64_tr_b16 v[158:159], v242 offset:44032
  v_mfma_f32_16x16x32_bf16 v[68:71], v[168:171], a[20:23], v[68:71]
  s_add_u32 m0, s63, 135168
  ds_read_b64_tr_b16 v[160:161], v243 offset:25600
  v_mfma_f32_16x16x32_bf16 v[68:71], v[172:175], a[28:31], v[68:71]
  s_mul_i32 s61, s62, 36864
  ds_read_b64_tr_b16 v[162:163], v243 offset:31744
  v_mfma_f32_16x16x32_bf16 v[64:67], v[172:175], a[24:27], v[64:67]
  buffer_load_dwordx4 v236, s[84:87], s61 offen lds
  v_mfma_f32_16x16x32_bf16 v[64:67], v[168:171], a[16:19], v[64:67]
  s_waitcnt lgkmcnt(6)
  ds_read_b64_tr_b16 v[164:165], v243 offset:37888
  ds_read_b64_tr_b16 v[166:167], v243 offset:44032
  v_mfma_f32_16x16x32_bf16 v[24:27], v[144:147], a[16:19], v[24:27]
  s_lshl_b32 s60, s62, 10
  ds_read_b64_tr_b16 v[168:169], v241 offset:26624
  v_mfma_f32_16x16x32_bf16 v[24:27], v[148:151], a[24:27], v[24:27]
  ds_read_b64_tr_b16 v[170:171], v241 offset:32768
  v_mfma_f32_16x16x32_bf16 v[28:31], v[148:151], a[28:31], v[28:31]
  buffer_load_dwordx4 v237, s[84:87], s61 offen offset:1024 lds
  v_mfma_f32_16x16x32_bf16 v[28:31], v[144:147], a[20:23], v[28:31]
  s_waitcnt lgkmcnt(6)
  ds_read_b64_tr_b16 v[172:173], v241 offset:38912
  ds_read_b64_tr_b16 v[174:175], v241 offset:45056
  v_mfma_f32_16x16x32_bf16 v[52:55], v[152:155], a[20:23], v[52:55]
  buffer_load_dwordx4 v238, s[84:87], s61 offen offset:2048 lds
  v_mfma_f32_16x16x32_bf16 v[52:55], v[156:159], a[28:31], v[52:55]
  ds_read_b64_tr_b16 v[144:145], v242 offset:26624
  ds_read_b64_tr_b16 v[146:147], v242 offset:32768
  v_mfma_f32_16x16x32_bf16 v[48:51], v[156:159], a[24:27], v[48:51]
  ds_read_b64_tr_b16 v[148:149], v242 offset:38912
  v_mfma_f32_16x16x32_bf16 v[48:51], v[152:155], a[16:19], v[48:51]
  s_waitcnt lgkmcnt(7)
  ds_read_b64_tr_b16 v[150:151], v242 offset:45056
  v_mfma_f32_16x16x32_bf16 v[72:75], v[160:163], a[16:19], v[72:75]
  buffer_load_dwordx4 a[88:91], v239, s[16:19], s60 offen sc1
  v_mfma_f32_16x16x32_bf16 v[72:75], v[164:167], a[24:27], v[72:75]
  ds_read_b64_tr_b16 v[152:153], v243 offset:26624
  ds_read_b64_tr_b16 v[154:155], v243 offset:32768
  v_mfma_f32_16x16x32_bf16 v[76:79], v[164:167], a[28:31], v[76:79]
  s_waitcnt vmcnt(19)
  ds_read_b64_tr_b16 v[156:157], v243 offset:38912
  v_mfma_f32_16x16x32_bf16 v[76:79], v[160:163], a[20:23], v[76:79]
  s_waitcnt lgkmcnt(7)
  ds_read_b64_tr_b16 v[158:159], v243 offset:45056
  v_mfma_f32_16x16x32_bf16 v[36:39], v[168:171], a[20:23], v[36:39]
  s_barrier
  ds_read_b64_tr_b16 v[160:161], v241 offset:49152
  v_mfma_f32_16x16x32_bf16 v[36:39], v[172:175], a[28:31], v[36:39]
  ds_read_b64_tr_b16 v[162:163], v241 offset:55296
  v_mfma_f32_16x16x32_bf16 v[32:35], v[172:175], a[24:27], v[32:35]
  buffer_load_dwordx4 a[92:95], v240, s[16:19], s60 offen sc1
  v_mfma_f32_16x16x32_bf16 v[32:35], v[168:171], a[16:19], v[32:35]
  s_waitcnt lgkmcnt(6)
  ds_read_b64_tr_b16 v[164:165], v241 offset:61440
  ds_read_b64_tr_b16 v[166:167], v245 offset:2048
  v_mfma_f32_16x16x32_bf16 v[56:59], v[144:147], a[16:19], v[56:59]
  ds_read_b64_tr_b16 v[168:169], v241 offset:50176
  v_mfma_f32_16x16x32_bf16 v[56:59], v[148:151], a[24:27], v[56:59]
  ds_read_b64_tr_b16 v[170:171], v241 offset:56320
  v_mfma_f32_16x16x32_bf16 v[60:63], v[148:151], a[28:31], v[60:63]
  ds_read_b64_tr_b16 v[172:173], v241 offset:62464
  v_mfma_f32_16x16x32_bf16 v[60:63], v[144:147], a[20:23], v[60:63]
  s_waitcnt lgkmcnt(7)
  ds_read_b64_tr_b16 v[174:175], v245 offset:3072
  v_mfma_f32_16x16x32_bf16 v[180:183], v[152:155], a[20:23], v[180:183]
  ds_read_b64_tr_b16 v[144:145], v241 offset:51200
  v_mfma_f32_16x16x32_bf16 v[180:183], v[156:159], a[28:31], v[180:183]
  ds_read_b64_tr_b16 v[146:147], v241 offset:57344
  v_mfma_f32_16x16x32_bf16 v[176:179], v[156:159], a[24:27], v[176:179]
  ds_read_b64_tr_b16 v[148:149], v241 offset:63488
  v_mfma_f32_16x16x32_bf16 v[176:179], v[152:155], a[16:19], v[176:179]
  s_waitcnt lgkmcnt(7)
  ds_read_b64_tr_b16 v[150:151], v245 offset:4096
  v_mfma_f32_16x16x32_bf16 v[16:19], v[160:163], a[32:35], v[16:19]
  ds_read_b64_tr_b16 v[152:153], v245 offset:8192
  v_mfma_f32_16x16x32_bf16 v[16:19], v[164:167], a[40:43], v[16:19]
  ds_read_b64_tr_b16 v[154:155], v245 offset:14336
  v_mfma_f32_16x16x32_bf16 v[20:23], v[164:167], a[44:47], v[20:23]
  buffer_load_dword v4, v7, s[20:23], s45 offen sc1
  v_mfma_f32_16x16x32_bf16 v[20:23], v[160:163], a[36:39], v[20:23]
  s_waitcnt lgkmcnt(6)
  ds_read_b64_tr_b16 v[156:157], v245 offset:20480
  ds_read_b64_tr_b16 v[158:159], v245 offset:26624
  v_mfma_f32_16x16x32_bf16 v[28:31], v[168:171], a[36:39], v[28:31]
  s_mov_b32 m0, s28
  ds_read_b64_tr_b16 v[160:161], v245 offset:9216
  v_mfma_f32_16x16x32_bf16 v[28:31], v[172:175], a[44:47], v[28:31]
  ds_read_b64_tr_b16 v[162:163], v245 offset:15360
  v_mfma_f32_16x16x32_bf16 v[24:27], v[172:175], a[40:43], v[24:27]
  ds_read_b64_tr_b16 v[164:165], v245 offset:21504
  v_mfma_f32_16x16x32_bf16 v[24:27], v[168:171], a[32:35], v[24:27]
  s_waitcnt lgkmcnt(7)
  ds_read_b64_tr_b16 v[166:167], v245 offset:27648
  v_mfma_f32_16x16x32_bf16 v[32:35], v[144:147], a[32:35], v[32:35]
  ds_read_b64_tr_b16 v[168:169], v245 offset:10240
  v_mfma_f32_16x16x32_bf16 v[32:35], v[148:151], a[40:43], v[32:35]
  ds_read_b64_tr_b16 v[170:171], v245 offset:16384
  v_mfma_f32_16x16x32_bf16 v[36:39], v[148:151], a[44:47], v[36:39]
  s_waitcnt vmcnt(11)
  ds_read_b64_tr_b16 v[172:173], v245 offset:22528
  v_mfma_f32_16x16x32_bf16 v[36:39], v[144:147], a[36:39], v[36:39]
  s_waitcnt lgkmcnt(7)
  ds_read_b64_tr_b16 v[174:175], v245 offset:28672
  v_mfma_f32_16x16x32_bf16 v[20:23], v[152:155], a[52:55], v[20:23]
  s_barrier
  ds_read_b64_tr_b16 v[144:145], v245 offset:32768
  v_mfma_f32_16x16x32_bf16 v[20:23], v[156:159], a[60:63], v[20:23]
  ds_read_b64_tr_b16 v[146:147], v245 offset:38912
  v_mfma_f32_16x16x32_bf16 v[16:19], v[156:159], a[56:59], v[16:19]
  ds_read_b64_tr_b16 v[148:149], v245 offset:45056
  v_mfma_f32_16x16x32_bf16 v[16:19], v[152:155], a[48:51], v[16:19]
  s_waitcnt lgkmcnt(7)
  ds_read_b64_tr_b16 v[150:151], v245 offset:51200
  v_mfma_f32_16x16x32_bf16 v[24:27], v[160:163], a[48:51], v[24:27]
  ds_read_b64_tr_b16 v[152:153], v245 offset:33792
  v_mfma_f32_16x16x32_bf16 v[24:27], v[164:167], a[56:59], v[24:27]
  ds_read_b64_tr_b16 v[154:155], v245 offset:39936
  v_mfma_f32_16x16x32_bf16 v[28:31], v[164:167], a[60:63], v[28:31]
  ds_read_b64_tr_b16 v[156:157], v245 offset:46080
  v_mfma_f32_16x16x32_bf16 v[28:31], v[160:163], a[52:55], v[28:31]
  s_waitcnt lgkmcnt(7)
  ds_read_b64_tr_b16 v[158:159], v245 offset:52224
  v_mfma_f32_16x16x32_bf16 v[36:39], v[168:171], a[52:55], v[36:39]
  ds_read_b64_tr_b16 v[160:161], v245 offset:34816
  v_mfma_f32_16x16x32_bf16 v[36:39], v[172:175], a[60:63], v[36:39]
  ds_read_b64_tr_b16 v[162:163], v245 offset:40960
  v_mfma_f32_16x16x32_bf16 v[32:35], v[172:175], a[56:59], v[32:35]
  s_waitcnt vmcnt(1)
  ds_read_b64_tr_b16 v[164:165], v245 offset:47104
  v_mfma_f32_16x16x32_bf16 v[32:35], v[168:171], a[48:51], v[32:35]
  s_waitcnt lgkmcnt(7)
  ds_read_b64_tr_b16 v[166:167], v245 offset:53248
  v_mfma_f32_16x16x32_bf16 v[16:19], v[144:147], a[64:67], v[16:19]
  s_barrier
  ds_read_b64_tr_b16 v[168:169], v245 offset:57344
  v_mfma_f32_16x16x32_bf16 v[16:19], v[148:151], a[72:75], v[16:19]
  ds_read_b64_tr_b16 v[170:171], v245 offset:63488
  v_mfma_f32_16x16x32_bf16 v[20:23], v[148:151], a[76:79], v[20:23]
  ds_read_b64_tr_b16 v[172:173], v249 offset:4096
  v_mfma_f32_16x16x32_bf16 v[20:23], v[144:147], a[68:71], v[20:23]
  s_waitcnt lgkmcnt(7)
  ds_read_b64_tr_b16 v[174:175], v249 offset:10240
  v_mfma_f32_16x16x32_bf16 v[28:31], v[152:155], a[68:71], v[28:31]
  ds_read_b64_tr_b16 v[144:145], v245 offset:58368
  v_mfma_f32_16x16x32_bf16 v[28:31], v[156:159], a[76:79], v[28:31]
  ds_read_b64_tr_b16 v[146:147], v245 offset:64512
  v_mfma_f32_16x16x32_bf16 v[24:27], v[156:159], a[72:75], v[24:27]
  ds_read_b64_tr_b16 v[148:149], v249 offset:5120
  v_mfma_f32_16x16x32_bf16 v[24:27], v[152:155], a[64:67], v[24:27]
  s_waitcnt lgkmcnt(7)
  ds_read_b64_tr_b16 v[150:151], v249 offset:11264
  v_mfma_f32_16x16x32_bf16 v[32:35], v[160:163], a[64:67], v[32:35]
  ds_read_b64_tr_b16 v[152:153], v245 offset:59392
  v_mfma_f32_16x16x32_bf16 v[32:35], v[164:167], a[72:75], v[32:35]
  ds_read_b64_tr_b16 v[154:155], v249 offset:0
  v_mfma_f32_16x16x32_bf16 v[36:39], v[164:167], a[76:79], v[36:39]
  ds_read_b64_tr_b16 v[156:157], v249 offset:6144
  v_mfma_f32_16x16x32_bf16 v[36:39], v[160:163], a[68:71], v[36:39]
  s_waitcnt lgkmcnt(7)
  ds_read_b64_tr_b16 v[158:159], v249 offset:12288
  v_mfma_f32_16x16x32_bf16 v[20:23], v[168:171], a[84:87], v[20:23]
  ds_read_b64_tr_b16 v[160:161], v242 offset:49152
  v_mfma_f32_16x16x32_bf16 v[20:23], v[172:175], a[92:95], v[20:23]
  ds_read_b64_tr_b16 v[162:163], v242 offset:55296
  v_mfma_f32_16x16x32_bf16 v[16:19], v[172:175], a[88:91], v[16:19]
  ds_read_b64_tr_b16 v[164:165], v242 offset:61440
  v_mfma_f32_16x16x32_bf16 v[16:19], v[168:171], a[80:83], v[16:19]
  s_waitcnt lgkmcnt(7)
  ds_read_b64_tr_b16 v[166:167], v246 offset:2048
  v_mfma_f32_16x16x32_bf16 v[24:27], v[144:147], a[80:83], v[24:27]
  ds_read_b64_tr_b16 v[168:169], v246 offset:8192
  v_mfma_f32_16x16x32_bf16 v[24:27], v[148:151], a[88:91], v[24:27]
  ds_read_b64_tr_b16 v[170:171], v246 offset:14336
  v_mfma_f32_16x16x32_bf16 v[28:31], v[148:151], a[92:95], v[28:31]
  ds_read_b64_tr_b16 v[172:173], v246 offset:20480
  v_mfma_f32_16x16x32_bf16 v[28:31], v[144:147], a[84:87], v[28:31]
  s_waitcnt lgkmcnt(7)
  ds_read_b64_tr_b16 v[174:175], v246 offset:26624
  v_mfma_f32_16x16x32_bf16 v[36:39], v[152:155], a[84:87], v[36:39]
  ds_read_b64_tr_b16 v[144:145], v246 offset:32768
  v_cvt_pk_bf16_f32 v16, v16, v17
  v_mfma_f32_16x16x32_bf16 v[36:39], v[156:159], a[92:95], v[36:39]
  ds_read_b64_tr_b16 v[146:147], v246 offset:38912
  v_cvt_pk_bf16_f32 v17, v18, v19
  v_mfma_f32_16x16x32_bf16 v[32:35], v[156:159], a[88:91], v[32:35]
  ds_read_b64_tr_b16 v[148:149], v246 offset:45056
  v_cvt_pk_bf16_f32 v18, v20, v21
  v_mfma_f32_16x16x32_bf16 v[32:35], v[152:155], a[80:83], v[32:35]
  s_waitcnt lgkmcnt(7)
  ds_read_b64_tr_b16 v[150:151], v246 offset:51200
  v_cvt_pk_bf16_f32 v19, v22, v23
  v_mfma_f32_16x16x32_bf16 v[40:43], v[160:163], a[32:35], v[40:43]
  buffer_store_dwordx4 v[16:19], v9, s[20:23], s64 offen offset:0 sc1
  v_mfma_f32_16x16x32_bf16 v[40:43], v[164:167], a[40:43], v[40:43]
  ds_read_b64_tr_b16 v[152:153], v246 offset:57344
  ds_read_b64_tr_b16 v[154:155], v246 offset:63488
  v_mfma_f32_16x16x32_bf16 v[44:47], v[164:167], a[44:47], v[44:47]
  ds_read_b64_tr_b16 v[156:157], v250 offset:4096
  v_cvt_pk_bf16_f32 v24, v24, v25
  v_mfma_f32_16x16x32_bf16 v[44:47], v[160:163], a[36:39], v[44:47]
  s_waitcnt lgkmcnt(7)
  ds_read_b64_tr_b16 v[158:159], v250 offset:10240
  v_cvt_pk_bf16_f32 v25, v26, v27
  v_mfma_f32_16x16x32_bf16 v[44:47], v[168:171], a[52:55], v[44:47]
  ds_read_b64_tr_b16 v[160:161], v242 offset:50176
  v_cvt_pk_bf16_f32 v26, v28, v29
  v_mfma_f32_16x16x32_bf16 v[44:47], v[172:175], a[60:63], v[44:47]
  ds_read_b64_tr_b16 v[162:163], v242 offset:56320
  v_cvt_pk_bf16_f32 v27, v30, v31
  v_mfma_f32_16x16x32_bf16 v[40:43], v[172:175], a[56:59], v[40:43]
  buffer_store_dwordx4 v[24:27], v9, s[20:23], s64 offen offset:1024 sc1
  v_mfma_f32_16x16x32_bf16 v[40:43], v[168:171], a[48:51], v[40:43]
  s_waitcnt lgkmcnt(6)
  ds_read_b64_tr_b16 v[164:165], v242 offset:62464
  ds_read_b64_tr_b16 v[166:167], v246 offset:3072
  v_mfma_f32_16x16x32_bf16 v[40:43], v[144:147], a[64:67], v[40:43]
  ds_read_b64_tr_b16 v[168:169], v246 offset:9216
  v_cvt_pk_bf16_f32 v32, v32, v33
  v_mfma_f32_16x16x32_bf16 v[40:43], v[148:151], a[72:75], v[40:43]
  ds_read_b64_tr_b16 v[170:171], v246 offset:15360
  v_cvt_pk_bf16_f32 v33, v34, v35
  v_mfma_f32_16x16x32_bf16 v[44:47], v[148:151], a[76:79], v[44:47]
  ds_read_b64_tr_b16 v[172:173], v246 offset:21504
  v_cvt_pk_bf16_f32 v34, v36, v37
  v_mfma_f32_16x16x32_bf16 v[44:47], v[144:147], a[68:71], v[44:47]
  s_waitcnt lgkmcnt(7)
  ds_read_b64_tr_b16 v[174:175], v246 offset:27648
  v_cvt_pk_bf16_f32 v35, v38, v39
  v_mfma_f32_16x16x32_bf16 v[44:47], v[152:155], a[84:87], v[44:47]
  buffer_store_dwordx4 v[32:35], v9, s[20:23], s64 offen offset:2048 sc1
  v_mfma_f32_16x16x32_bf16 v[44:47], v[156:159], a[92:95], v[44:47]
  ds_read_b64_tr_b16 v[144:145], v246 offset:33792
  ds_read_b64_tr_b16 v[146:147], v246 offset:39936
  v_mfma_f32_16x16x32_bf16 v[40:43], v[156:159], a[88:91], v[40:43]
  ds_read_b64_tr_b16 v[148:149], v246 offset:46080
  v_mfma_f32_16x16x32_bf16 v[40:43], v[152:155], a[80:83], v[40:43]
  s_waitcnt lgkmcnt(7)
  ds_read_b64_tr_b16 v[150:151], v246 offset:52224
  v_mfma_f32_16x16x32_bf16 v[48:51], v[160:163], a[32:35], v[48:51]
  ds_read_b64_tr_b16 v[152:153], v246 offset:58368
  v_mfma_f32_16x16x32_bf16 v[48:51], v[164:167], a[40:43], v[48:51]
  ds_read_b64_tr_b16 v[154:155], v246 offset:64512
  v_mfma_f32_16x16x32_bf16 v[52:55], v[164:167], a[44:47], v[52:55]
  ds_read_b64_tr_b16 v[156:157], v250 offset:5120
  v_mfma_f32_16x16x32_bf16 v[52:55], v[160:163], a[36:39], v[52:55]
  s_waitcnt lgkmcnt(7)
  ds_read_b64_tr_b16 v[158:159], v250 offset:11264
  v_mfma_f32_16x16x32_bf16 v[52:55], v[168:171], a[52:55], v[52:55]
  ds_read_b64_tr_b16 v[160:161], v242 offset:51200
  v_cvt_pk_bf16_f32 v40, v40, v41
  v_mfma_f32_16x16x32_bf16 v[52:55], v[172:175], a[60:63], v[52:55]
  ds_read_b64_tr_b16 v[162:163], v242 offset:57344
  v_cvt_pk_bf16_f32 v41, v42, v43
  v_mfma_f32_16x16x32_bf16 v[48:51], v[172:175], a[56:59], v[48:51]
  ds_read_b64_tr_b16 v[164:165], v242 offset:63488
  v_cvt_pk_bf16_f32 v42, v44, v45
  v_mfma_f32_16x16x32_bf16 v[48:51], v[168:171], a[48:51], v[48:51]
  s_waitcnt lgkmcnt(7)
  ds_read_b64_tr_b16 v[166:167], v246 offset:4096
  v_cvt_pk_bf16_f32 v43, v46, v47
  v_mfma_f32_16x16x32_bf16 v[48:51], v[144:147], a[64:67], v[48:51]
  buffer_store_dwordx4 v[40:43], v9, s[20:23], s65 offen offset:0 sc1
  v_mfma_f32_16x16x32_bf16 v[48:51], v[148:151], a[72:75], v[48:51]
  ds_read_b64_tr_b16 v[168:169], v246 offset:10240
  ds_read_b64_tr_b16 v[170:171], v246 offset:16384
  v_mfma_f32_16x16x32_bf16 v[52:55], v[148:151], a[76:79], v[52:55]
  ds_read_b64_tr_b16 v[172:173], v246 offset:22528
  v_mfma_f32_16x16x32_bf16 v[52:55], v[144:147], a[68:71], v[52:55]
  s_waitcnt lgkmcnt(7)
  ds_read_b64_tr_b16 v[174:175], v246 offset:28672
  v_mfma_f32_16x16x32_bf16 v[52:55], v[152:155], a[84:87], v[52:55]
  s_waitcnt vmcnt(4)
  ds_read_b64_tr_b16 v[144:145], v246 offset:34816
  v_cmp_gt_u32 vcc, 5, v4
  v_mfma_f32_16x16x32_bf16 v[52:55], v[156:159], a[92:95], v[52:55]
  s_cbranch_vccnz L_g_spf
L_g_bkf:
  ds_read_b64_tr_b16 v[146:147], v246 offset:40960
  v_mfma_f32_16x16x32_bf16 v[48:51], v[156:159], a[88:91], v[48:51]
  ds_read_b64_tr_b16 v[148:149], v246 offset:47104
  v_mfma_f32_16x16x32_bf16 v[48:51], v[152:155], a[80:83], v[48:51]
  s_waitcnt lgkmcnt(7)
  ds_read_b64_tr_b16 v[150:151], v246 offset:53248
  v_mfma_f32_16x16x32_bf16 v[56:59], v[160:163], a[32:35], v[56:59]
  ds_read_b64_tr_b16 v[152:153], v246 offset:59392
  v_mfma_f32_16x16x32_bf16 v[56:59], v[164:167], a[40:43], v[56:59]
  ds_read_b64_tr_b16 v[154:155], v250 offset:0
  v_mfma_f32_16x16x32_bf16 v[60:63], v[164:167], a[44:47], v[60:63]
  ds_read_b64_tr_b16 v[156:157], v250 offset:6144
  v_mfma_f32_16x16x32_bf16 v[60:63], v[160:163], a[36:39], v[60:63]
  s_waitcnt lgkmcnt(7)
  ds_read_b64_tr_b16 v[158:159], v250 offset:12288
  v_mfma_f32_16x16x32_bf16 v[60:63], v[168:171], a[52:55], v[60:63]
  ds_read_b64_tr_b16 v[160:161], v243 offset:49152
  v_cvt_pk_bf16_f32 v48, v48, v49
  v_mfma_f32_16x16x32_bf16 v[60:63], v[172:175], a[60:63], v[60:63]
  ds_read_b64_tr_b16 v[162:163], v243 offset:55296
  v_cvt_pk_bf16_f32 v49, v50, v51
  v_mfma_f32_16x16x32_bf16 v[56:59], v[172:175], a[56:59], v[56:59]
  ds_read_b64_tr_b16 v[164:165], v243 offset:61440
  v_cvt_pk_bf16_f32 v50, v52, v53
  v_mfma_f32_16x16x32_bf16 v[56:59], v[168:171], a[48:51], v[56:59]
  s_waitcnt lgkmcnt(7)
  ds_read_b64_tr_b16 v[166:167], v247 offset:2048
  v_cvt_pk_bf16_f32 v51, v54, v55
  v_mfma_f32_16x16x32_bf16 v[56:59], v[144:147], a[64:67], v[56:59]
  buffer_store_dwordx4 v[48:51], v9, s[20:23], s65 offen offset:1024 sc1
  v_mfma_f32_16x16x32_bf16 v[56:59], v[148:151], a[72:75], v[56:59]
  ds_read_b64_tr_b16 v[168:169], v247 offset:8192
  ds_read_b64_tr_b16 v[170:171], v247 offset:14336
  v_mfma_f32_16x16x32_bf16 v[60:63], v[148:151], a[76:79], v[60:63]
  ds_read_b64_tr_b16 v[172:173], v247 offset:20480
  v_mfma_f32_16x16x32_bf16 v[60:63], v[144:147], a[68:71], v[60:63]
  s_waitcnt lgkmcnt(7)
  ds_read_b64_tr_b16 v[174:175], v247 offset:26624
  v_mfma_f32_16x16x32_bf16 v[60:63], v[152:155], a[84:87], v[60:63]
  ds_read_b64_tr_b16 v[144:145], v247 offset:32768
  v_mfma_f32_16x16x32_bf16 v[60:63], v[156:159], a[92:95], v[60:63]
  ds_read_b64_tr_b16 v[146:147], v247 offset:38912
  v_mfma_f32_16x16x32_bf16 v[56:59], v[156:159], a[88:91], v[56:59]
  ds_read_b64_tr_b16 v[148:149], v247 offset:45056
  v_mfma_f32_16x16x32_bf16 v[56:59], v[152:155], a[80:83], v[56:59]
  s_waitcnt lgkmcnt(7)
  ds_read_b64_tr_b16 v[150:151], v247 offset:51200
  v_mfma_f32_16x16x32_bf16 v[64:67], v[160:163], a[32:35], v[64:67]
  ds_read_b64_tr_b16 v[152:153], v247 offset:57344
  v_mfma_f32_16x16x32_bf16 v[64:67], v[164:167], a[40:43], v[64:67]
  ds_read_b64_tr_b16 v[154:155], v247 offset:63488
  v_mfma_f32_16x16x32_bf16 v[68:71], v[164:167], a[44:47], v[68:71]
  ds_read_b64_tr_b16 v[156:157], v251 offset:4096
  v_mfma_f32_16x16x32_bf16 v[68:71], v[160:163], a[36:39], v[68:71]
  s_waitcnt lgkmcnt(7)
  ds_read_b64_tr_b16 v[158:159], v251 offset:10240
  v_mfma_f32_16x16x32_bf16 v[68:71], v[168:171], a[52:55], v[68:71]
  ds_read_b64_tr_b16 v[160:161], v243 offset:50176
  v_cvt_pk_bf16_f32 v56, v56, v57
  v_mfma_f32_16x16x32_bf16 v[68:71], v[172:175], a[60:63], v[68:71]
  ds_read_b64_tr_b16 v[162:163], v243 offset:56320
  v_cvt_pk_bf16_f32 v57, v58, v59
  v_mfma_f32_16x16x32_bf16 v[64:67], v[172:175], a[56:59], v[64:67]
  ds_read_b64_tr_b16 v[164:165], v243 offset:62464
  v_cvt_pk_bf16_f32 v58, v60, v61
  v_mfma_f32_16x16x32_bf16 v[64:67], v[168:171], a[48:51], v[64:67]
  s_waitcnt lgkmcnt(7)
  ds_read_b64_tr_b16 v[166:167], v247 offset:3072
  v_cvt_pk_bf16_f32 v59, v62, v63
  v_mfma_f32_16x16x32_bf16 v[64:67], v[144:147], a[64:67], v[64:67]
  buffer_store_dwordx4 v[56:59], v9, s[20:23], s65 offen offset:2048 sc1
  v_mfma_f32_16x16x32_bf16 v[64:67], v[148:151], a[72:75], v[64:67]
  ds_read_b64_tr_b16 v[168:169], v247 offset:9216
  ds_read_b64_tr_b16 v[170:171], v247 offset:15360
  v_mfma_f32_16x16x32_bf16 v[68:71], v[148:151], a[76:79], v[68:71]
  ds_read_b64_tr_b16 v[172:173], v247 offset:21504
  v_mfma_f32_16x16x32_bf16 v[68:71], v[144:147], a[68:71], v[68:71]
  s_waitcnt lgkmcnt(7)
  ds_read_b64_tr_b16 v[174:175], v247 offset:27648
  v_mfma_f32_16x16x32_bf16 v[68:71], v[152:155], a[84:87], v[68:71]
  ds_read_b64_tr_b16 v[144:145], v247 offset:33792
  v_mfma_f32_16x16x32_bf16 v[68:71], v[156:159], a[92:95], v[68:71]
  ds_read_b64_tr_b16 v[146:147], v247 offset:39936
  v_mfma_f32_16x16x32_bf16 v[64:67], v[156:159], a[88:91], v[64:67]
L_pg10:
  s_cbranch_execz L_back
  ds_read_b64_tr_b16 v[148:149], v247 offset:46080
  v_mfma_f32_16x16x32_bf16 v[64:67], v[152:155], a[80:83], v[64:67]
  s_waitcnt lgkmcnt(7)
  ds_read_b64_tr_b16 v[150:151], v247 offset:52224
  v_mfma_f32_16x16x32_bf16 v[72:75], v[160:163], a[32:35], v[72:75]
  ds_read_b64_tr_b16 v[152:153], v247 offset:58368
  v_mfma_f32_16x16x32_bf16 v[72:75], v[164:167], a[40:43], v[72:75]
  ds_read_b64_tr_b16 v[154:155], v247 offset:64512
  v_mfma_f32_16x16x32_bf16 v[76:79], v[164:167], a[44:47], v[76:79]
  ds_read_b64_tr_b16 v[156:157], v251 offset:5120
  v_mfma_f32_16x16x32_bf16 v[76:79], v[160:163], a[36:39], v[76:79]
  s_waitcnt lgkmcnt(7)
  ds_read_b64_tr_b16 v[158:159], v251 offset:11264
  v_mfma_f32_16x16x32_bf16 v[76:79], v[168:171], a[52:55], v[76:79]
  ds_read_b64_tr_b16 v[160:161], v243 offset:51200
  v_cvt_pk_bf16_f32 v64, v64, v65
  v_mfma_f32_16x16x32_bf16 v[76:79], v[172:175], a[60:63], v[76:79]
  ds_read_b64_tr_b16 v[162:163], v243 offset:57344
  v_cvt_pk_bf16_f32 v65, v66, v67
  v_mfma_f32_16x16x32_bf16 v[72:75], v[172:175], a[56:59], v[72:75]
  ds_read_b64_tr_b16 v[164:165], v243 offset:63488
  v_cvt_pk_bf16_f32 v66, v68, v69
  v_mfma_f32_16x16x32_bf16 v[72:75], v[168:171], a[48:51], v[72:75]
  s_waitcnt lgkmcnt(7)
  ds_read_b64_tr_b16 v[166:167], v247 offset:4096
  v_cvt_pk_bf16_f32 v67, v70, v71
  v_mfma_f32_16x16x32_bf16 v[72:75], v[144:147], a[64:67], v[72:75]
  buffer_store_dwordx4 v[64:67], v9, s[20:23], s66 offen offset:0 sc1
  v_mfma_f32_16x16x32_bf16 v[72:75], v[148:151], a[72:75], v[72:75]
  ds_read_b64_tr_b16 v[168:169], v247 offset:10240
  ds_read_b64_tr_b16 v[170:171], v247 offset:16384
  v_mfma_f32_16x16x32_bf16 v[76:79], v[148:151], a[76:79], v[76:79]
  buffer_load_dwordx4 v[80:83], v9, s[20:23], s67 offen offset:0 sc1
  v_mfma_f32_16x16x32_bf16 v[76:79], v[144:147], a[68:71], v[76:79]
  s_waitcnt lgkmcnt(6)
  ds_read_b64_tr_b16 v[172:173], v247 offset:22528
  ds_read_b64_tr_b16 v[174:175], v247 offset:28672
  v_mfma_f32_16x16x32_bf16 v[76:79], v[152:155], a[84:87], v[76:79]
  ds_read_b64_tr_b16 v[144:145], v247 offset:34816
  v_mfma_f32_16x16x32_bf16 v[76:79], v[156:159], a[92:95], v[76:79]
  ds_read_b64_tr_b16 v[146:147], v247 offset:40960
  v_mfma_f32_16x16x32_bf16 v[72:75], v[156:159], a[88:91], v[72:75]
  buffer_load_dwordx4 v[84:87], v9, s[20:23], s67 offen offset:1024 sc1
  v_mfma_f32_16x16x32_bf16 v[72:75], v[152:155], a[80:83], v[72:75]
  s_waitcnt lgkmcnt(6)
  ds_read_b64_tr_b16 v[148:149], v247 offset:47104
  ds_read_b64_tr_b16 v[150:151], v247 offset:53248
  v_mfma_f32_16x16x32_bf16 v[176:179], v[160:163], a[32:35], v[176:179]
  ds_read_b64_tr_b16 v[152:153], v247 offset:59392
  v_mfma_f32_16x16x32_bf16 v[176:179], v[164:167], a[40:43], v[176:179]
  ds_read_b64_tr_b16 v[154:155], v251 offset:0
  v_mfma_f32_16x16x32_bf16 v[180:183], v[164:167], a[44:47], v[180:183]
  buffer_load_dwordx4 v[88:91], v9, s[20:23], s67 offen offset:2048 sc1
  v_mfma_f32_16x16x32_bf16 v[180:183], v[160:163], a[36:39], v[180:183]
  s_waitcnt lgkmcnt(6)
  ds_read_b64_tr_b16 v[156:157], v251 offset:6144
  ds_read_b64_tr_b16 v[158:159], v251 offset:12288
  v_mfma_f32_16x16x32_bf16 v[180:183], v[168:171], a[52:55], v[180:183]
  ds_read_b64_tr_b16 v[160:161], v244 offset:0
  v_cvt_pk_bf16_f32 v72, v72, v73
  v_mfma_f32_16x16x32_bf16 v[180:183], v[172:175], a[60:63], v[180:183]
  ds_read_b64_tr_b16 v[162:163], v244 offset:6144
  v_cvt_pk_bf16_f32 v73, v74, v75
  v_mfma_f32_16x16x32_bf16 v[176:179], v[172:175], a[56:59], v[176:179]
  ds_read_b64_tr_b16 v[164:165], v244 offset:12288
  v_cvt_pk_bf16_f32 v74, v76, v77
  v_mfma_f32_16x16x32_bf16 v[176:179], v[168:171], a[48:51], v[176:179]
  s_waitcnt lgkmcnt(7)
  ds_read_b64_tr_b16 v[166:167], v244 offset:18432
  v_cvt_pk_bf16_f32 v75, v78, v79
  v_mfma_f32_16x16x32_bf16 v[176:179], v[144:147], a[64:67], v[176:179]
  buffer_store_dwordx4 v[72:75], v9, s[20:23], s66 offen offset:1024 sc1
  v_mfma_f32_16x16x32_bf16 v[176:179], v[148:151], a[72:75], v[176:179]
  ds_read_b64_tr_b16 v[168:169], v244 offset:1024
  ds_read_b64_tr_b16 v[170:171], v244 offset:7168
  v_mfma_f32_16x16x32_bf16 v[180:183], v[148:151], a[76:79], v[180:183]
  ds_read_b64_tr_b16 v[172:173], v244 offset:13312
  v_mfma_f32_16x16x32_bf16 v[180:183], v[144:147], a[68:71], v[180:183]
  s_waitcnt lgkmcnt(7)
  ds_read_b64_tr_b16 v[174:175], v244 offset:19456
  v_mfma_f32_16x16x32_bf16 v[180:183], v[152:155], a[84:87], v[180:183]
  buffer_load_dword v6, v5, s[20:23], s52 offen sc1
  v_mfma_f32_16x16x32_bf16 v[180:183], v[156:159], a[92:95], v[180:183]
  ds_read_b64_tr_b16 v[144:145], v244 offset:2048
  ds_read_b64_tr_b16 v[146:147], v244 offset:8192
  v_mfma_f32_16x16x32_bf16 v[176:179], v[156:159], a[88:91], v[176:179]
  ds_read_b64_tr_b16 v[148:149], v244 offset:14336
  v_mfma_f32_16x16x32_bf16 v[176:179], v[152:155], a[80:83], v[176:179]
  s_waitcnt lgkmcnt(7)
  ds_read_b64_tr_b16 v[150:151], v244 offset:20480
  v_mfma_f32_16x16x32_bf16 v[184:187], v[160:163], a[0:3], v[184:187]
  ds_read_b64_tr_b16 v[152:153], v244 offset:24576
  v_mfma_f32_16x16x32_bf16 v[184:187], v[164:167], a[8:11], v[184:187]
  ds_read_b64_tr_b16 v[154:155], v244 offset:30720
  v_mfma_f32_16x16x32_bf16 v[188:191], v[164:167], a[12:15], v[188:191]
  ds_read_b64_tr_b16 v[156:157], v244 offset:36864
  v_mfma_f32_16x16x32_bf16 v[188:191], v[160:163], a[4:7], v[188:191]
  s_waitcnt lgkmcnt(7)
  ds_read_b64_tr_b16 v[158:159], v244 offset:43008
  v_mfma_f32_16x16x32_bf16 v[196:199], v[168:171], a[4:7], v[196:199]
  ds_read_b64_tr_b16 v[160:161], v244 offset:25600
  v_cvt_pk_bf16_f32 v176, v176, v177
  v_mfma_f32_16x16x32_bf16 v[196:199], v[172:175], a[12:15], v[196:199]
  ds_read_b64_tr_b16 v[162:163], v244 offset:31744
  v_cvt_pk_bf16_f32 v177, v178, v179
  v_mfma_f32_16x16x32_bf16 v[192:195], v[172:175], a[8:11], v[192:195]
  ds_read_b64_tr_b16 v[164:165], v244 offset:37888
  v_cvt_pk_bf16_f32 v178, v180, v181
  v_mfma_f32_16x16x32_bf16 v[192:195], v[168:171], a[0:3], v[192:195]
  s_waitcnt lgkmcnt(7)
  ds_read_b64_tr_b16 v[166:167], v244 offset:44032
  v_cvt_pk_bf16_f32 v179, v182, v183
  v_mfma_f32_16x16x32_bf16 v[200:203], v[144:147], a[0:3], v[200:203]
  buffer_store_dwordx4 v[176:179], v9, s[20:23], s66 offen offset:2048 sc1
  v_mfma_f32_16x16x32_bf16 v[200:203], v[148:151], a[8:11], v[200:203]
  ds_read_b64_tr_b16 v[168:169], v244 offset:26624
  ds_read_b64_tr_b16 v[170:171], v244 offset:32768
  v_mfma_f32_16x16x32_bf16 v[204:207], v[148:151], a[12:15], v[204:207]
  ds_read_b64_tr_b16 v[172:173], v244 offset:38912
  v_mfma_f32_16x16x32_bf16 v[204:207], v[144:147], a[4:7], v[204:207]
  s_waitcnt lgkmcnt(7)
  ds_read_b64_tr_b16 v[174:175], v244 offset:45056
  v_mfma_f32_16x16x32_bf16 v[188:191], v[152:155], a[20:23], v[188:191]
  ds_read_b64_tr_b16 v[144:145], v244 offset:49152
  v_mfma_f32_16x16x32_bf16 v[188:191], v[156:159], a[28:31], v[188:191]
  ds_read_b64_tr_b16 v[146:147], v244 offset:55296
  v_mfma_f32_16x16x32_bf16 v[184:187], v[156:159], a[24:27], v[184:187]
  buffer_load_dwordx4 v[92:95], v9, s[20:23], s43 offen offset:0 sc1
  v_mfma_f32_16x16x32_bf16 v[184:187], v[152:155], a[16:19], v[184:187]
  s_waitcnt lgkmcnt(6)
  ds_read_b64_tr_b16 v[148:149], v244 offset:61440
  ds_read_b64_tr_b16 v[150:151], v248 offset:2048
  v_mfma_f32_16x16x32_bf16 v[192:195], v[160:163], a[16:19], v[192:195]
  ds_read_b64_tr_b16 v[152:153], v244 offset:50176
  v_mfma_f32_16x16x32_bf16 v[192:195], v[164:167], a[24:27], v[192:195]
  ds_read_b64_tr_b16 v[154:155], v244 offset:56320
  v_mfma_f32_16x16x32_bf16 v[196:199], v[164:167], a[28:31], v[196:199]
  buffer_load_dwordx4 v[96:99], v9, s[20:23], s43 offen offset:1024 sc1
  v_mfma_f32_16x16x32_bf16 v[196:199], v[160:163], a[20:23], v[196:199]
  s_waitcnt lgkmcnt(6)
  ds_read_b64_tr_b16 v[156:157], v244 offset:62464
  ds_read_b64_tr_b16 v[158:159], v248 offset:3072
  v_mfma_f32_16x16x32_bf16 v[204:207], v[168:171], a[20:23], v[204:207]
  ds_read_b64_tr_b16 v[160:161], v244 offset:51200
  v_mfma_f32_16x16x32_bf16 v[204:207], v[172:175], a[28:31], v[204:207]
  ds_read_b64_tr_b16 v[162:163], v244 offset:57344
  v_mfma_f32_16x16x32_bf16 v[200:203], v[172:175], a[24:27], v[200:203]
  buffer_load_dwordx4 v[100:103], v9, s[20:23], s43 offen offset:2048 sc1
  v_mfma_f32_16x16x32_bf16 v[200:203], v[168:171], a[16:19], v[200:203]
  s_waitcnt lgkmcnt(6)
  ds_read_b64_tr_b16 v[164:165], v244 offset:63488
  ds_read_b64_tr_b16 v[166:167], v248 offset:4096
  v_mfma_f32_16x16x32_bf16 v[184:187], v[144:147], a[32:35], v[184:187]
  ds_read_b64_tr_b16 v[168:169], v248 offset:8192
  v_mfma_f32_16x16x32_bf16 v[184:187], v[148:151], a[40:43], v[184:187]
  ds_read_b64_tr_b16 v[170:171], v248 offset:14336
  v_mfma_f32_16x16x32_bf16 v[188:191], v[148:151], a[44:47], v[188:191]
  ds_read_b64_tr_b16 v[172:173], v248 offset:20480
  v_mfma_f32_16x16x32_bf16 v[188:191], v[144:147], a[36:39], v[188:191]
  s_waitcnt lgkmcnt(7)
  ds_read_b64_tr_b16 v[174:175], v248 offset:26624
  v_mfma_f32_16x16x32_bf16 v[196:199], v[152:155], a[36:39], v[196:199]
  ds_read_b64_tr_b16 v[144:145], v248 offset:9216
  v_mfma_f32_16x16x32_bf16 v[196:199], v[156:159], a[44:47], v[196:199]
  ds_read_b64_tr_b16 v[146:147], v248 offset:15360
  v_mfma_f32_16x16x32_bf16 v[192:195], v[156:159], a[40:43], v[192:195]
  ds_read_b64_tr_b16 v[148:149], v248 offset:21504
  v_mfma_f32_16x16x32_bf16 v[192:195], v[152:155], a[32:35], v[192:195]
  s_waitcnt lgkmcnt(7)
  ds_read_b64_tr_b16 v[150:151], v248 offset:27648
  v_mfma_f32_16x16x32_bf16 v[200:203], v[160:163], a[32:35], v[200:203]
  ds_read_b64_tr_b16 v[152:153], v248 offset:10240
  v_mfma_f32_16x16x32_bf16 v[200:203], v[164:167], a[40:43], v[200:203]
  ds_read_b64_tr_b16 v[154:155], v248 offset:16384
  v_mfma_f32_16x16x32_bf16 v[204:207], v[164:167], a[44:47], v[204:207]
  ds_read_b64_tr_b16 v[156:157], v248 offset:22528
  v_mfma_f32_16x16x32_bf16 v[204:207], v[160:163], a[36:39], v[204:207]
  s_waitcnt lgkmcnt(7)
  ds_read_b64_tr_b16 v[158:159], v248 offset:28672
  v_mfma_f32_16x16x32_bf16 v[188:191], v[168:171], a[52:55], v[188:191]
  ds_read_b64_tr_b16 v[160:161], v248 offset:32768
  v_mfma_f32_16x16x32_bf16 v[188:191], v[172:175], a[60:63], v[188:191]
  ds_read_b64_tr_b16 v[162:163], v248 offset:38912
  v_mfma_f32_16x16x32_bf16 v[184:187], v[172:175], a[56:59], v[184:187]
  ds_read_b64_tr_b16 v[164:165], v248 offset:45056
  v_mfma_f32_16x16x32_bf16 v[184:187], v[168:171], a[48:51], v[184:187]
  s_waitcnt lgkmcnt(7)
  ds_read_b64_tr_b16 v[166:167], v248 offset:51200
  v_mfma_f32_16x16x32_bf16 v[192:195], v[144:147], a[48:51], v[192:195]
  ds_read_b64_tr_b16 v[168:169], v248 offset:33792
  v_mfma_f32_16x16x32_bf16 v[192:195], v[148:151], a[56:59], v[192:195]
  ds_read_b64_tr_b16 v[170:171], v248 offset:39936
  v_mfma_f32_16x16x32_bf16 v[196:199], v[148:151], a[60:63], v[196:199]
  ds_read_b64_tr_b16 v[172:173], v248 offset:46080
  v_mfma_f32_16x16x32_bf16 v[196:199], v[144:147], a[52:55], v[196:199]
  s_waitcnt lgkmcnt(7)
  ds_read_b64_tr_b16 v[174:175], v248 offset:52224
  v_mfma_f32_16x16x32_bf16 v[204:207], v[152:155], a[52:55], v[204:207]
  ds_read_b64_tr_b16 v[144:145], v248 offset:34816
  v_mfma_f32_16x16x32_bf16 v[204:207], v[156:159], a[60:63], v[204:207]
  ds_read_b64_tr_b16 v[146:147], v248 offset:40960
  v_mfma_f32_16x16x32_bf16 v[200:203], v[156:159], a[56:59], v[200:203]
  ds_read_b64_tr_b16 v[148:149], v248 offset:47104
  v_mfma_f32_16x16x32_bf16 v[200:203], v[152:155], a[48:51], v[200:203]
  s_waitcnt lgkmcnt(7)
  ds_read_b64_tr_b16 v[150:151], v248 offset:53248
  v_mfma_f32_16x16x32_bf16 v[184:187], v[160:163], a[64:67], v[184:187]
  ds_read_b64_tr_b16 v[152:153], v248 offset:57344
  v_mfma_f32_16x16x32_bf16 v[184:187], v[164:167], a[72:75], v[184:187]
  ds_read_b64_tr_b16 v[154:155], v248 offset:63488
  v_mfma_f32_16x16x32_bf16 v[188:191], v[164:167], a[76:79], v[188:191]
  ds_read_b64_tr_b16 v[156:157], v252 offset:4096
  v_mfma_f32_16x16x32_bf16 v[188:191], v[160:163], a[68:71], v[188:191]
  s_waitcnt lgkmcnt(7)
  ds_read_b64_tr_b16 v[158:159], v252 offset:10240
  v_mfma_f32_16x16x32_bf16 v[196:199], v[168:171], a[68:71], v[196:199]
  buffer_load_dwordx4 v[104:107], v9, s[20:23], s44 offen offset:0 sc1
  v_mfma_f32_16x16x32_bf16 v[196:199], v[172:175], a[76:79], v[196:199]
  ds_read_b64_tr_b16 v[160:161], v248 offset:58368
  ds_read_b64_tr_b16 v[162:163], v248 offset:64512
  v_mfma_f32_16x16x32_bf16 v[192:195], v[172:175], a[72:75], v[192:195]
  ds_read_b64_tr_b16 v[164:165], v252 offset:5120
  v_mfma_f32_16x16x32_bf16 v[192:195], v[168:171], a[64:67], v[192:195]
  s_waitcnt lgkmcnt(7)
  ds_read_b64_tr_b16 v[166:167], v252 offset:11264
  v_mfma_f32_16x16x32_bf16 v[200:203], v[144:147], a[64:67], v[200:203]
  buffer_load_dwordx4 v[108:111], v9, s[20:23], s44 offen offset:1024 sc1
  v_mfma_f32_16x16x32_bf16 v[200:203], v[148:151], a[72:75], v[200:203]
  ds_read_b64_tr_b16 v[168:169], v248 offset:59392
  ds_read_b64_tr_b16 v[170:171], v252 offset:0
  v_mfma_f32_16x16x32_bf16 v[204:207], v[148:151], a[76:79], v[204:207]
  ds_read_b64_tr_b16 v[172:173], v252 offset:6144
  v_mfma_f32_16x16x32_bf16 v[204:207], v[144:147], a[68:71], v[204:207]
  s_waitcnt lgkmcnt(7)
  ds_read_b64_tr_b16 v[174:175], v252 offset:12288
  v_mfma_f32_16x16x32_bf16 v[188:191], v[152:155], a[84:87], v[188:191]
  buffer_load_dwordx4 v[112:115], v9, s[20:23], s44 offen offset:2048 sc1
  v_mfma_f32_16x16x32_bf16 v[188:191], v[156:159], a[92:95], v[188:191]
  v_mfma_f32_16x16x32_bf16 v[184:187], v[156:159], a[88:91], v[184:187]
  v_mfma_f32_16x16x32_bf16 v[184:187], v[152:155], a[80:83], v[184:187]
  s_waitcnt lgkmcnt(4)
  v_mfma_f32_16x16x32_bf16 v[192:195], v[160:163], a[80:83], v[192:195]
  v_mfma_f32_16x16x32_bf16 v[192:195], v[164:167], a[88:91], v[192:195]
  v_mfma_f32_16x16x32_bf16 v[196:199], v[164:167], a[92:95], v[196:199]
  v_mfma_f32_16x16x32_bf16 v[196:199], v[160:163], a[84:87], v[196:199]
  s_waitcnt lgkmcnt(0)
  v_mfma_f32_16x16x32_bf16 v[204:207], v[168:171], a[84:87], v[204:207]
  v_mfma_f32_16x16x32_bf16 v[204:207], v[172:175], a[92:95], v[204:207]
  v_mfma_f32_16x16x32_bf16 v[200:203], v[172:175], a[88:91], v[200:203]
  v_mfma_f32_16x16x32_bf16 v[200:203], v[168:171], a[80:83], v[200:203]
  s_waitcnt vmcnt(7)
  v_cmp_gt_u32 vcc, 1, v6
  s_nop 1
  s_cbranch_vccnz L_g_sps
L_g_bks:
  buffer_load_dwordx4 v1, s[20:23], s40 offen offset:0 sc1 lds
  buffer_load_dwordx4 v1, s[20:23], s41 offen offset:1024 sc1 lds
  buffer_load_dwordx4 v1, s[20:23], s42 offen offset:2048 sc1 lds
  s_waitcnt vmcnt(12)
  s_nop 0
  v_max3_u32 v7, v80, v81, v82
  v_max3_u32 v7, v7, v83, v84
  v_max3_u32 v7, v7, v85, v86
  v_max3_u32 v7, v7, v87, v88
  v_max3_u32 v7, v7, v89, v90
  v_max_u32 v7, v7, v91
  v_not_b32 v7, v7
  v_cmp_gt_u32 vcc, 1, v7
  s_nop 1
  s_cbranch_vccnz L_g_spi0
L_g_bki0:
  v_dot2c_f32_bf16 v184, s46, v80
  v_dot2c_f32_bf16 v185, s47, v80
  v_dot2c_f32_bf16 v186, s46, v81
  v_dot2c_f32_bf16 v187, s47, v81
  v_dot2c_f32_bf16 v188, s46, v82
  v_dot2c_f32_bf16 v189, s47, v82
  v_dot2c_f32_bf16 v190, s46, v83
  v_dot2c_f32_bf16 v191, s47, v83
  v_dot2c_f32_bf16 v192, s46, v84
  v_dot2c_f32_bf16 v193, s47, v84
  v_dot2c_f32_bf16 v194, s46, v85
  v_dot2c_f32_bf16 v195, s47, v85
  v_dot2c_f32_bf16 v196, s46, v86
  v_dot2c_f32_bf16 v197, s47, v86
  v_dot2c_f32_bf16 v198, s46, v87
  v_dot2c_f32_bf16 v199, s47, v87
  v_dot2c_f32_bf16 v200, s46, v88
  v_dot2c_f32_bf16 v201, s47, v88
  v_dot2c_f32_bf16 v202, s46, v89
  v_dot2c_f32_bf16 v203, s47, v89
  v_dot2c_f32_bf16 v204, s46, v90
  v_dot2c_f32_bf16 v205, s47, v90
  v_dot2c_f32_bf16 v206, s46, v91
  v_dot2c_f32_bf16 v207, s47, v91
  s_waitcnt vmcnt(6)
  v_max3_u32 v7, v92, v93, v94
  v_max3_u32 v7, v7, v95, v96
  v_max3_u32 v7, v7, v97, v98
  v_max3_u32 v7, v7, v99, v100
  v_max3_u32 v7, v7, v101, v102
  v_max_u32 v7, v7, v103
  v_not_b32 v7, v7
  v_cmp_gt_u32 vcc, 1, v7
  s_nop 1
  s_cbranch_vccnz L_g_spi1
L_g_bki1:
  v_dot2c_f32_bf16 v184, s46, v92
  v_dot2c_f32_bf16 v185, s47, v92
  v_dot2c_f32_bf16 v186, s46, v93
  v_dot2c_f32_bf16 v187, s47, v93
  v_dot2c_f32_bf16 v188, s46, v94
  v_dot2c_f32_bf16 v189, s47, v94
  v_dot2c_f32_bf16 v190, s46, v95
  v_dot2c_f32_bf16 v191, s47, v95
  v_dot2c_f32_bf16 v192, s46, v96
  v_dot2c_f32_bf16 v193, s47, v96
  v_dot2c_f32_bf16 v194, s46, v97
  v_dot2c_f32_bf16 v195, s47, v97
  v_dot2c_f32_bf16 v196, s46, v98
  v_dot2c_f32_bf16 v197, s47, v98
  v_dot2c_f32_bf16 v198, s46, v99
  v_dot2c_f32_bf16 v199, s47, v99
  v_dot2c_f32_bf16 v200, s46, v100
  v_dot2c_f32_bf16 v201, s47, v100
  v_dot2c_f32_bf16 v202, s46, v101
  v_dot2c_f32_bf16 v203, s47, v101
  v_dot2c_f32_bf16 v204, s46, v102
  v_dot2c_f32_bf16 v205, s47, v102
  v_dot2c_f32_bf16 v206, s46, v103
  v_dot2c_f32_bf16 v207, s47, v103
  s_waitcnt vmcnt(3)
  v_max3_u32 v7, v104, v105, v106
  v_max3_u32 v7, v7, v107, v108
  v_max3_u32 v7, v7, v109, v110
  v_max3_u32 v7, v7, v111, v112
  v_max3_u32 v7, v7, v113, v114
  v_max_u32 v7, v7, v115
  v_not_b32 v7, v7
  v_cmp_gt_u32_e64 vcc, 1, v7
  s_nop 1
  s_cbranch_vccnz L_g_spi2
L_g_bki2:
  v_dot2c_f32_bf16 v184, s46, v104
  v_dot2c_f32_bf16 v185, s47, v104
  v_dot2c_f32_bf16 v186, s46, v105
  v_dot2c_f32_bf16 v187, s47, v105
  v_dot2c_f32_bf16 v188, s46, v106
  v_dot2c_f32_bf16 v189, s47, v106
  v_dot2c_f32_bf16 v190, s46, v107
  v_dot2c_f32_bf16 v191, s47, v107
  v_dot2c_f32_bf16 v192, s46, v108
  v_dot2c_f32_bf16 v193, s47, v108
  v_dot2c_f32_bf16 v194, s46, v109
  v_dot2c_f32_bf16 v195, s47, v109
  v_dot2c_f32_bf16 v196, s46, v110
  v_dot2c_f32_bf16 v197, s47, v110
  v_dot2c_f32_bf16 v198, s46, v111
  v_dot2c_f32_bf16 v199, s47, v111
  v_dot2c_f32_bf16 v200, s46, v112
  v_dot2c_f32_bf16 v201, s47, v112
  v_dot2c_f32_bf16 v202, s46, v113
  v_dot2c_f32_bf16 v203, s47, v113
  v_dot2c_f32_bf16 v204, s46, v114
  v_dot2c_f32_bf16 v205, s47, v114
  v_dot2c_f32_bf16 v206, s46, v115
  v_dot2c_f32_bf16 v207, s47, v115
  s_mov_b32 s32, 0xc0d22e3c
  v_pk_mul_f32 v[80:81], v[184:185], s[32:33] op_sel_hi:[1,0]
  v_pk_mul_f32 v[82:83], v[186:187], s[32:33] op_sel_hi:[1,0]
  v_pk_mul_f32 v[84:85], v[188:189], s[32:33] op_sel_hi:[1,0]
  v_pk_mul_f32 v[86:87], v[190:191], s[32:33] op_sel_hi:[1,0]
  v_exp_f32 v80, v80
  v_exp_f32 v81, v81
  v_exp_f32 v82, v82
  v_exp_f32 v83, v83
  v_exp_f32 v84, v84
  v_exp_f32 v85, v85
  v_exp_f32_e64 v86, v86
  v_exp_f32 v87, v87
  s_waitcnt vmcnt(0)
  ds_read_b64_tr_b16 v[224:225], v3 offset:0
  ds_read_b64_tr_b16 v[226:227], v3 offset:32
  ds_read_b64_tr_b16 v[228:229], v3 offset:1024
  ds_read_b64_tr_b16 v[230:231], v3 offset:1056
  ds_read_b64_tr_b16 v[232:233], v3 offset:2048
  ds_read_b64_tr_b16 v[234:235], v3 offset:2080
  v_pk_add_f32 v[80:81], v[80:81], 1.0 op_sel_hi:[1,0]
  v_pk_add_f32 v[82:83], v[82:83], 1.0 op_sel_hi:[1,0]
  v_pk_add_f32 v[84:85], v[84:85], 1.0 op_sel_hi:[1,0]
  v_pk_add_f32 v[86:87], v[86:87], 1.0 op_sel_hi:[1,0]
  v_rcp_f32 v80, v80
  v_rcp_f32 v81, v81
  v_rcp_f32 v82, v82
  v_rcp_f32 v83, v83
  v_rcp_f32 v84, v84
  v_rcp_f32 v85, v85
  v_rcp_f32 v86, v86
  v_rcp_f32 v87, v87
  s_waitcnt lgkmcnt(0)
  v_lshlrev_b32 v16, 16, v224
  v_and_b32 v17, s3, v224
  v_lshlrev_b32 v18, 16, v225
  v_and_b32 v19, s3, v225
  v_lshlrev_b32 v20, 16, v226
  v_and_b32 v21, s3, v226
  v_lshlrev_b32 v22, 16, v227
  v_and_b32_e64 v23, s3, v227
  v_pk_mul_f32 v[184:185], v[184:185], v[16:17]
  v_pk_mul_f32 v[186:187], v[186:187], v[18:19]
  v_pk_mul_f32 v[188:189], v[188:189], v[20:21]
  v_pk_mul_f32 v[190:191], v[190:191], v[22:23]
  v_pk_fma_f32 v[184:185], v[184:185], v[80:81], v[116:117]
  v_pk_fma_f32 v[186:187], v[186:187], v[82:83], v[118:119]
  v_pk_fma_f32 v[188:189], v[188:189], v[84:85], v[120:121]
  v_pk_fma_f32 v[190:191], v[190:191], v[86:87], v[122:123]
  v_cvt_pk_bf16_f32 v184, v184, v185
  v_cvt_pk_bf16_f32 v185, v186, v187
  v_cvt_pk_bf16_f32 v186, v188, v189
  v_cvt_pk_bf16_f32 v187, v190, v191
  s_nop 0
  v_permlane16_swap_b32 v184, v186
  v_permlane16_swap_b32 v185, v187
  s_nop 0
  buffer_store_dwordx4 v[184:187], v10, s[8:11], s73 offen offset:0 sc1
  v_pk_mul_f32 v[88:89], v[192:193], s[32:33] op_sel_hi:[1,0]
  v_pk_mul_f32 v[90:91], v[194:195], s[32:33] op_sel_hi:[1,0]
  v_pk_mul_f32 v[92:93], v[196:197], s[32:33] op_sel_hi:[1,0]
  v_pk_mul_f32 v[94:95], v[198:199], s[32:33] op_sel_hi:[1,0]
  v_exp_f32 v88, v88
  v_exp_f32 v89, v89
  v_exp_f32 v90, v90
  v_exp_f32 v91, v91
  v_exp_f32 v92, v92
  v_exp_f32 v93, v93
  v_exp_f32 v94, v94
  v_exp_f32 v95, v95
  v_pk_add_f32 v[88:89], v[88:89], 1.0 op_sel_hi:[1,0]
  v_pk_add_f32 v[90:91], v[90:91], 1.0 op_sel_hi:[1,0]
  v_pk_add_f32 v[92:93], v[92:93], 1.0 op_sel_hi:[1,0]
  v_pk_add_f32 v[94:95], v[94:95], 1.0 op_sel_hi:[1,0]
  v_rcp_f32 v88, v88
  v_rcp_f32 v89, v89
  v_rcp_f32 v90, v90
  v_rcp_f32 v91, v91
  v_rcp_f32 v92, v92
  v_rcp_f32 v93, v93
  v_rcp_f32 v94, v94
  v_rcp_f32 v95, v95
  v_lshlrev_b32 v24, 16, v228
  v_and_b32 v25, s3, v228
  v_lshlrev_b32 v26, 16, v229
  v_and_b32 v27, s3, v229
  v_lshlrev_b32 v28, 16, v230
  v_and_b32 v29, s3, v230
  v_lshlrev_b32 v30, 16, v231
  v_and_b32 v31, s3, v231
  v_pk_mul_f32 v[192:193], v[192:193], v[24:25]
  v_pk_mul_f32 v[194:195], v[194:195], v[26:27]
  v_pk_mul_f32 v[196:197], v[196:197], v[28:29]
  v_pk_mul_f32 v[198:199], v[198:199], v[30:31]
  v_pk_fma_f32 v[192:193], v[192:193], v[88:89], v[124:125]
  v_pk_fma_f32 v[194:195], v[194:195], v[90:91], v[126:127]
  v_pk_fma_f32 v[196:197], v[196:197], v[92:93], v[128:129]
  v_pk_fma_f32 v[198:199], v[198:199], v[94:95], v[130:131]
  v_cvt_pk_bf16_f32 v192, v192, v193
  v_cvt_pk_bf16_f32 v193, v194, v195
  v_cvt_pk_bf16_f32 v194, v196, v197
  v_cvt_pk_bf16_f32 v195, v198, v199
  s_nop 0
  v_permlane16_swap_b32 v192, v194
  v_permlane16_swap_b32 v193, v195
  s_nop 0
  buffer_store_dwordx4 v[192:195], v10, s[8:11], s73 offen offset:128 sc1
  v_pk_mul_f32 v[96:97], v[200:201], s[32:33] op_sel_hi:[1,0]
  v_pk_mul_f32 v[98:99], v[202:203], s[32:33] op_sel_hi:[1,0]
  v_pk_mul_f32 v[100:101], v[204:205], s[32:33] op_sel_hi:[1,0]
  v_pk_mul_f32 v[102:103], v[206:207], s[32:33] op_sel_hi:[1,0]
  v_exp_f32 v96, v96
  v_exp_f32 v97, v97
  v_exp_f32 v98, v98
  v_exp_f32 v99, v99
  v_exp_f32 v100, v100
  v_exp_f32 v101, v101
  v_exp_f32 v102, v102
  v_exp_f32 v103, v103
  v_pk_add_f32 v[96:97], v[96:97], 1.0 op_sel_hi:[1,0]
  v_pk_add_f32 v[98:99], v[98:99], 1.0 op_sel_hi:[1,0]
  v_pk_add_f32 v[100:101], v[100:101], 1.0 op_sel_hi:[1,0]
  v_pk_add_f32 v[102:103], v[102:103], 1.0 op_sel_hi:[1,0]
  v_rcp_f32 v96, v96
  v_rcp_f32 v97, v97
  v_rcp_f32 v98, v98
  v_rcp_f32 v99, v99
  v_rcp_f32 v100, v100
  v_rcp_f32 v101, v101
  v_rcp_f32 v102, v102
  v_rcp_f32 v103, v103
  v_lshlrev_b32 v32, 16, v232
  v_and_b32 v33, s3, v232
  v_lshlrev_b32 v34, 16, v233
  v_and_b32 v35, s3, v233
  v_lshlrev_b32 v36, 16, v234
  v_and_b32 v37, s3, v234
  v_lshlrev_b32 v38, 16, v235
  v_and_b32 v39, s3, v235
  v_pk_mul_f32 v[200:201], v[200:201], v[32:33]
  v_pk_mul_f32 v[202:203], v[202:203], v[34:35]
  v_pk_mul_f32 v[204:205], v[204:205], v[36:37]
  v_pk_mul_f32 v[206:207], v[206:207], v[38:39]
  v_pk_fma_f32 v[200:201], v[200:201], v[96:97], v[132:133]
  v_pk_fma_f32 v[202:203], v[202:203], v[98:99], v[134:135]
  v_pk_fma_f32 v[204:205], v[204:205], v[100:101], v[136:137]
  v_pk_fma_f32 v[206:207], v[206:207], v[102:103], v[138:139]
  v_cvt_pk_bf16_f32 v200, v200, v201
  v_cvt_pk_bf16_f32 v201, v202, v203
  v_cvt_pk_bf16_f32 v202, v204, v205
  v_cvt_pk_bf16_f32 v203, v206, v207
  s_nop 0
  v_permlane16_swap_b32 v200, v202
  v_permlane16_swap_b32 v201, v203
  buffer_store_dwordx4 v[200:203], v10, s[8:11], s73 offen offset:256 sc1
  s_endpgm
L_pg11:
  s_cbranch_execz L_back
L_g_spi2:
  s_mov_b32 s100, 200000
L_g_spi2_l:
  buffer_load_dwordx4 v[104:107], v9, s[20:23], s44 offen offset:0 sc1
  buffer_load_dwordx4 v[108:111], v9, s[20:23], s44 offen offset:1024 sc1
  buffer_load_dwordx4 v[112:115], v9, s[20:23], s44 offen offset:2048 sc1
  s_waitcnt vmcnt(0)
  v_max3_u32 v7, v104, v105, v106
  v_max3_u32 v7, v7, v107, v108
  v_max3_u32 v7, v7, v109, v110
  v_max3_u32 v7, v7, v111, v112
  v_max3_u32 v7, v7, v113, v114
  v_max_u32 v7, v7, v115
  v_not_b32 v7, v7
  v_cmp_gt_u32_e64 vcc, 1, v7
  s_sub_u32 s100, s100, 1
  s_cbranch_scc1 L_g_bki2
  s_cbranch_vccz L_g_bki2
  s_branch L_g_spi2_l
L_g_spi1:
  s_mov_b32 s100, 200000
L_g_spi1_l:
  buffer_load_dwordx4 v[92:95], v9, s[20:23], s43 offen offset:0 sc1
  buffer_load_dwordx4 v[96:99], v9, s[20:23], s43 offen offset:1024 sc1
  buffer_load_dwordx4 v[100:103], v9, s[20:23], s43 offen offset:2048 sc1
  s_waitcnt vmcnt(0)
  s_nop 0
  v_max3_u32 v7, v92, v93, v94
  v_max3_u32 v7, v7, v95, v96
  v_max3_u32 v7, v7, v97, v98
  v_max3_u32 v7, v7, v99, v100
  v_max3_u32 v7, v7, v101, v102
  v_max_u32 v7, v7, v103
  v_not_b32 v7, v7
  v_cmp_gt_u32_e64 vcc, 1, v7
  s_sub_u32 s100, s100, 1
  s_cbranch_scc1 L_g_bki1
  s_cbranch_vccz L_g_bki1
  s_branch L_g_spi1_l
L_g_spi0:
  s_mov_b32 s100, 200000
L_g_spi0_l:
  buffer_load_dwordx4 v[80:83], v9, s[20:23], s67 offen offset:0 sc1
  buffer_load_dwordx4 v[84:87], v9, s[20:23], s67 offen offset:1024 sc1
  buffer_load_dwordx4 v[88:91], v9, s[20:23], s67 offen offset:2048 sc1
  s_waitcnt vmcnt(0)
  s_nop 0
  v_max3_u32 v7, v80, v81, v82
  v_max3_u32 v7, v7, v83, v84
  v_max3_u32 v7, v7, v85, v86
  v_max3_u32 v7, v7, v87, v88
  v_max3_u32 v7, v7, v89, v90
  v_max_u32 v7, v7, v91
  v_not_b32 v7, v7
  v_cmp_gt_u32_e64 vcc, 1, v7
  s_sub_u32 s100, s100, 1
  s_cbranch_scc1 L_g_bki0
  s_cbranch_vccz L_g_bki0
  s_branch L_g_spi0_l
L_g_sp0:
  s_mov_b32 s100, 200000
L_g_sp0_l:
  s_sleep 32
  buffer_load_dword v218, v220, s[4:7], 0 offen sc1
  s_waitcnt vmcnt(0)
  v_cmp_gt_u32_e64 vcc, v223, v218
  s_sub_u32 s100, s100, 1
  s_cbranch_scc1 L_g_bk0
  s_cbranch_vccz L_g_bk0
  s_branch L_g_sp0_l
L_g_sp1:
  s_mov_b32 s100, 200000
L_g_sp1_l:
  s_sleep 2
  buffer_load_dword v218, v220, s[4:7], 0 offen sc1
  s_waitcnt vmcnt(0)
  v_cmp_gt_u32_e64 vcc, v223, v218
  s_sub_u32 s100, s100, 1
  s_cbranch_scc1 L_g_bk1
  s_cbranch_vccz L_g_bk1
  s_branch L_g_sp1_l
L_g_sp2:
  s_mov_b32 s100, 200000
L_g_sp2_l:
  s_sleep 2
  buffer_load_dword v218, v220, s[4:7], 0 offen sc1
  s_waitcnt vmcnt(0)
  v_cmp_gt_u32_e64 vcc, v223, v218
  s_sub_u32 s100, s100, 1
  s_cbranch_scc1 L_g_bk2
  s_cbranch_vccz L_g_bk2
  s_branch L_g_sp2_l
L_g_sp3:
  s_mov_b32 s100, 200000
L_g_sp3_l:
  s_sleep 2
  buffer_load_dword v218, v220, s[4:7], 0 offen sc1
  s_waitcnt vmcnt(0)
  v_cmp_gt_u32_e64 vcc, v223, v218
  s_sub_u32 s100, s100, 1
  s_cbranch_scc1 L_g_bk3
  s_cbranch_vccz L_g_bk3
  s_branch L_g_sp3_l
L_g_sp4:
  s_mov_b32 s100, 200000
L_g_sp4_l:
  s_sleep 2
  buffer_load_dword v218, v220, s[4:7], 0 offen sc1
  s_waitcnt vmcnt(0)
  v_cmp_gt_u32_e64 vcc, v223, v218
  s_sub_u32 s100, s100, 1
  s_cbranch_scc1 L_g_bk4
  s_cbranch_vccz L_g_bk4
  s_branch L_g_sp4_l
L_g_sps:
  s_mov_b32 s100, 200000
L_g_sps_l:
  s_sleep 2
  buffer_load_dword v6, v5, s[20:23], s52 offen sc1
  s_waitcnt vmcnt(0)
  v_cmp_gt_u32_e64 vcc, 1, v6
  s_sub_u32 s100, s100, 1
  s_cbranch_scc1 L_g_bks
  s_cbranch_vccz L_g_bks
  s_branch L_g_sps_l
L_g_spf:
  s_mov_b32 s100, 200000
L_g_spf_l:
  s_sleep 2
  buffer_load_dword v4, v7, s[20:23], s45 offen sc1
  s_waitcnt vmcnt(0)
  v_cmp_gt_u32_e64 vcc, 5, v4
  s_sub_u32 s100, s100, 1
  s_cbranch_scc1 L_g_bkf
  s_cbranch_vccz L_g_bkf
  s_branch L_g_spf_l
L_prole:
  s_nop 7
  s_mov_b32 s33, s32
  s_add_u32 s30, s89, s92
  s_add_u32 s78, s89, s93
  s_add_u32 s79, s89, s94
  s_add_u32 s80, s89, s95
  v_pk_fma_f32 v[208:209], v[80:81], v[80:81], s[32:33]
  v_pk_fma_f32 v[210:211], v[82:83], v[82:83], s[32:33]
  v_pk_fma_f32 v[212:213], v[112:113], v[112:113], s[32:33]
  v_pk_fma_f32 v[214:215], v[114:115], v[114:115], s[32:33]
  v_pk_mul_f32 v[96:97], v[80:81], v[96:97]
  v_pk_mul_f32 v[98:99], v[82:83], v[98:99]
  v_pk_mul_f32 v[128:129], v[112:113], v[128:129]
  v_pk_mul_f32 v[130:131], v[114:115], v[130:131]
  v_pk_mul_f32 v[80:81], v[80:81], v[208:209] neg_lo:[1,0] neg_hi:[1,0]
  v_pk_mul_f32 v[82:83], v[82:83], v[210:211] neg_lo:[1,0] neg_hi:[1,0]
  v_pk_mul_f32 v[112:113], v[112:113], v[212:213] neg_lo:[1,0] neg_hi:[1,0]
  v_pk_mul_f32 v[114:115], v[114:115], v[214:215] neg_lo:[1,0] neg_hi:[1,0]
  v_exp_f32 v80, v80
  v_exp_f32 v81, v81
  v_exp_f32 v82, v82
  v_exp_f32 v83, v83
  v_exp_f32 v112, v112
  v_exp_f32 v113, v113
  v_exp_f32 v114, v114
  v_exp_f32 v115, v115
  v_pk_add_f32 v[80:81], v[80:81], 1.0 op_sel_hi:[1,0]
  v_pk_add_f32 v[82:83], v[82:83], 1.0 op_sel_hi:[1,0]
  v_pk_add_f32 v[112:113], v[112:113], 1.0 op_sel_hi:[1,0]
  v_pk_add_f32 v[114:115], v[114:115], 1.0 op_sel_hi:[1,0]
  v_rcp_f32 v80, v80
  v_rcp_f32 v81, v81
  v_rcp_f32 v82, v82
  v_rcp_f32 v83, v83
  v_rcp_f32 v112, v112
  v_rcp_f32 v113, v113
  v_rcp_f32 v114, v114
  v_rcp_f32 v115, v115
  v_pk_mul_f32 v[96:97], v[96:97], v[80:81]
  v_pk_mul_f32 v[98:99], v[98:99], v[82:83]
  v_pk_mul_f32 v[128:129], v[128:129], v[112:113]
  v_pk_mul_f32 v[130:131], v[130:131], v[114:115]
  v_cvt_pk_bf16_f32 v224, v96, v97
  v_cvt_pk_bf16_f32 v225, v98, v99
  v_cvt_pk_bf16_f32 v226, v128, v129
  v_cvt_pk_bf16_f32 v227, v130, v131
  buffer_store_dwordx4 v[224:227], v8, s[16:19], s30 offen sc1
  v_pk_fma_f32 v[208:209], v[84:85], v[84:85], s[32:33]
  v_pk_fma_f32 v[210:211], v[86:87], v[86:87], s[32:33]
  v_pk_fma_f32 v[212:213], v[116:117], v[116:117], s[32:33]
  v_pk_fma_f32 v[214:215], v[118:119], v[118:119], s[32:33]
  v_pk_mul_f32 v[100:101], v[84:85], v[100:101]
  v_pk_mul_f32 v[102:103], v[86:87], v[102:103]
  v_pk_mul_f32 v[132:133], v[116:117], v[132:133]
  v_pk_mul_f32 v[134:135], v[118:119], v[134:135]
  v_pk_mul_f32 v[84:85], v[84:85], v[208:209] neg_lo:[1,0] neg_hi:[1,0]
  v_pk_mul_f32 v[86:87], v[86:87], v[210:211] neg_lo:[1,0] neg_hi:[1,0]
  v_pk_mul_f32 v[116:117], v[116:117], v[212:213] neg_lo:[1,0] neg_hi:[1,0]
  v_pk_mul_f32 v[118:119], v[118:119], v[214:215] neg_lo:[1,0] neg_hi:[1,0]
  v_exp_f32 v84, v84
  v_exp_f32 v85, v85
  v_exp_f32 v86, v86
  v_exp_f32 v87, v87
  v_exp_f32 v116, v116
  v_exp_f32 v117, v117
  v_exp_f32 v118, v118
  v_exp_f32 v119, v119
  v_pk_add_f32 v[84:85], v[84:85], 1.0 op_sel_hi:[1,0]
  v_pk_add_f32 v[86:87], v[86:87], 1.0 op_sel_hi:[1,0]
  v_pk_add_f32 v[116:117], v[116:117], 1.0 op_sel_hi:[1,0]
  v_pk_add_f32 v[118:119], v[118:119], 1.0 op_sel_hi:[1,0]
  v_rcp_f32 v84, v84
  v_rcp_f32 v85, v85
  v_rcp_f32 v86, v86
  v_rcp_f32 v87, v87
  v_rcp_f32 v116, v116
  v_rcp_f32 v117, v117
  v_rcp_f32 v118, v118
  v_rcp_f32 v119, v119
  v_pk_mul_f32 v[100:101], v[100:101], v[84:85]
  v_pk_mul_f32 v[102:103], v[102:103], v[86:87]
  v_pk_mul_f32 v[132:133], v[132:133], v[116:117]
  v_pk_mul_f32 v[134:135], v[134:135], v[118:119]
  v_cvt_pk_bf16_f32 v228, v100, v101
  v_cvt_pk_bf16_f32 v229, v102, v103
  v_cvt_pk_bf16_f32 v230, v132, v133
  v_cvt_pk_bf16_f32 v231, v134, v135
  buffer_store_dwordx4 v[228:231], v8, s[16:19], s78 offen sc1
  v_pk_fma_f32 v[208:209], v[88:89], v[88:89], s[32:33]
  v_pk_fma_f32 v[210:211], v[90:91], v[90:91], s[32:33]
  v_pk_fma_f32 v[212:213], v[120:121], v[120:121], s[32:33]
  v_pk_fma_f32 v[214:215], v[122:123], v[122:123], s[32:33]
  v_pk_mul_f32 v[104:105], v[88:89], v[104:105]
  v_pk_mul_f32 v[106:107], v[90:91], v[106:107]
  v_pk_mul_f32 v[136:137], v[120:121], v[136:137]
  v_pk_mul_f32 v[138:139], v[122:123], v[138:139]
  v_pk_mul_f32 v[88:89], v[88:89], v[208:209] neg_lo:[1,0] neg_hi:[1,0]
  v_pk_mul_f32 v[90:91], v[90:91], v[210:211] neg_lo:[1,0] neg_hi:[1,0]
  v_pk_mul_f32 v[120:121], v[120:121], v[212:213] neg_lo:[1,0] neg_hi:[1,0]
  v_pk_mul_f32 v[122:123], v[122:123], v[214:215] neg_lo:[1,0] neg_hi:[1,0]
  v_exp_f32 v88, v88
  v_exp_f32 v89, v89
  v_exp_f32 v90, v90
  v_exp_f32 v91, v91
  v_exp_f32 v120, v120
  v_exp_f32 v121, v121
  v_exp_f32 v122, v122
  v_exp_f32 v123, v123
  v_pk_add_f32 v[88:89], v[88:89], 1.0 op_sel_hi:[1,0]
  v_pk_add_f32 v[90:91], v[90:91], 1.0 op_sel_hi:[1,0]
  v_pk_add_f32 v[120:121], v[120:121], 1.0 op_sel_hi:[1,0]
  v_pk_add_f32 v[122:123], v[122:123], 1.0 op_sel_hi:[1,0]
  v_rcp_f32 v88, v88
  v_rcp_f32 v89, v89
  v_rcp_f32 v90, v90
  v_rcp_f32 v91, v91
  v_rcp_f32 v120, v120
  v_rcp_f32 v121, v121
  v_rcp_f32 v122, v122
  v_rcp_f32 v123, v123
  v_pk_mul_f32 v[104:105], v[104:105], v[88:89]
  v_pk_mul_f32 v[106:107], v[106:107], v[90:91]
  v_pk_mul_f32 v[136:137], v[136:137], v[120:121]
  v_pk_mul_f32 v[138:139], v[138:139], v[122:123]
  v_cvt_pk_bf16_f32 v224, v104, v105
  v_cvt_pk_bf16_f32 v225, v106, v107
  v_cvt_pk_bf16_f32 v226, v136, v137
  v_cvt_pk_bf16_f32 v227, v138, v139
  buffer_store_dwordx4 v[224:227], v8, s[16:19], s79 offen sc1
  v_pk_fma_f32 v[208:209], v[92:93], v[92:93], s[32:33]
  v_pk_fma_f32 v[210:211], v[94:95], v[94:95], s[32:33]
  v_pk_fma_f32 v[212:213], v[124:125], v[124:125], s[32:33]
  v_pk_fma_f32 v[214:215], v[126:127], v[126:127], s[32:33]
  v_pk_mul_f32 v[108:109], v[92:93], v[108:109]
  v_pk_mul_f32 v[110:111], v[94:95], v[110:111]
  v_pk_mul_f32 v[140:141], v[124:125], v[140:141]
  v_pk_mul_f32 v[142:143], v[126:127], v[142:143]
  v_pk_mul_f32 v[92:93], v[92:93], v[208:209] neg_lo:[1,0] neg_hi:[1,0]
  v_pk_mul_f32 v[94:95], v[94:95], v[210:211] neg_lo:[1,0] neg_hi:[1,0]
  v_pk_mul_f32 v[124:125], v[124:125], v[212:213] neg_lo:[1,0] neg_hi:[1,0]
  v_pk_mul_f32 v[126:127], v[126:127], v[214:215] neg_lo:[1,0] neg_hi:[1,0]
  v_exp_f32 v92, v92
  v_exp_f32 v93, v93
  v_exp_f32 v94, v94
  v_exp_f32 v95, v95
  v_exp_f32 v124, v124
  v_exp_f32 v125, v125
  v_exp_f32 v126, v126
  v_exp_f32 v127, v127
  v_pk_add_f32 v[92:93], v[92:93], 1.0 op_sel_hi:[1,0]
  v_pk_add_f32 v[94:95], v[94:95], 1.0 op_sel_hi:[1,0]
  v_pk_add_f32 v[124:125], v[124:125], 1.0 op_sel_hi:[1,0]
  v_pk_add_f32 v[126:127], v[126:127], 1.0 op_sel_hi:[1,0]
  v_rcp_f32 v92, v92
  v_rcp_f32 v93, v93
  v_rcp_f32 v94, v94
  v_rcp_f32 v95, v95
  v_rcp_f32 v124, v124
  v_rcp_f32 v125, v125
  v_rcp_f32 v126, v126
  v_rcp_f32 v127, v127
  v_pk_mul_f32 v[108:109], v[108:109], v[92:93]
  v_pk_mul_f32 v[110:111], v[110:111], v[94:95]
  v_pk_mul_f32 v[140:141], v[140:141], v[124:125]
  v_pk_mul_f32 v[142:143], v[142:143], v[126:127]
  v_cvt_pk_bf16_f32 v228, v108, v109
  v_cvt_pk_bf16_f32 v229, v110, v111
  v_cvt_pk_bf16_f32 v230, v140, v141
  v_cvt_pk_bf16_f32 v231, v142, v143
  buffer_store_dwordx4 v[228:231], v8, s[16:19], s80 offen sc1
  v_add_u32_e64 v219, 1, v219
  s_waitcnt vmcnt(0)
  s_barrier
  buffer_store_dword v219, v216, s[20:23], s36 offen sc1
  s_endpgm
L_vrole:
  s_lshl_b32 s26, s25, 1
  s_lshr_b32 s33, s81, 1
  s_add_u32 s26, s26, s33
  s_mul_i32 s33, s26, 18
  s_add_u32 s41, s33, s24
  s_lshr_b32 s34, s24, 1
  s_add_u32 s42, s33, s34
  s_add_u32 s42, s42, 16
  s_mov_b32 s40, s41
  s_lshl_b32 s33, s40, 8
  v_lshl_add_u32 v2, v0, 2, s33
  s_lshl_b32 s33, s40, 1
  v_mov_b32_e64 v3, s33
  global_load_dword v94, v2, s[8:9]
  global_load_dword v95, v2, s[10:11]
  global_load_dword v96, v2, s[12:13]
  global_load_dword v97, v2, s[14:15]
  global_load_ushort v98, v3, s[16:17]
  v_lshlrev_b32_e64 v2, 4, v0
  v_add_u32 v2, vlane_tab-L_pc+2048, v2
  global_load_dwordx4 v[228:231], v2, s[68:69] offset:-2048
  global_load_dwordx4 v[232:235], v2, s[68:69] offset:-1024
  global_load_dwordx4 v[236:239], v2, s[68:69] offset:0
  global_load_dwordx4 v[240:243], v2, s[68:69] offset:1024
  global_load_dwordx4 v[244:247], v2, s[68:69] offset:2048
  s_add_u32 s33, s41, 0
  s_lshl_b32 s33, s33, 1
  s_and_b32 s33, s33, 0xfffc
  s_load_dword s60, s[18:19], s33
  s_add_u32 s33, s41, 4
  s_lshl_b32 s33, s33, 1
  s_and_b32 s33, s33, 0xfffc
  s_load_dword s61, s[18:19], s33
  s_add_u32 s33, s41, 8
  s_lshl_b32 s33, s33, 1
  s_and_b32 s33, s33, 0xfffc
  s_load_dword s62, s[18:19], s33
  s_add_u32 s33, s41, 12
  s_lshl_b32 s33, s33, 1
  s_and_b32 s33, s33, 0xfffc
  s_load_dword s63, s[18:19], s33
  s_mov_b32 s33, s42
  s_lshl_b32 s33, s33, 1
  s_and_b32 s33, s33, 0xfffc
  s_load_dword s64, s[18:19], s33
  s_mov_b32 s76, s94
  s_mov_b32 s77, s95
  s_and_b32 s39, s24, 1
  s_cmp_eq_u32 s39, 0
  s_cselect_b32 s4, s72, s74
  s_cselect_b32 s5, s73, s75
  s_mov_b32 s6, 5308416
  s_mov_b32 s7, 0x20000
  s_mov_b32 s86, 0
  s_mov_b32 s87, 0x20000
  s_mov_b32 s20, s76
  s_mov_b32 s21, s77
  s_mov_b32 s22, 67108864
  s_mov_b32 s23, 0x20000
  v_min_u32 v4, 53, v0
  v_mul_u32_u24 v5, 86, v4
  v_lshrrev_b32 v5, 8, v5
  v_mul_u32_u24 v6, 3, v5
  v_sub_u32_e64 v6, v4, v6
  v_mul_u32_u24 v5, 9216, v5
  v_lshl_add_u32 v7, v6, 7, v5
  s_and_b32 s33, s25, 14
  s_lshr_b32 s34, s24, 1
  s_add_u32 s33, s33, s34
  s_mul_i32 s43, s33, 331776
  s_mul_i32 s33, s81, 2304
  s_add_u32 s43, s43, s33
  v_mul_u32_u24 v6, 640, v6
  v_add_u32_e64 v219, v5, v6
  v_mul_u32_u24 v220, 82944, v0
  v_mov_b32 v227, v7
  s_mov_b32 s37, s43
  s_mov_b32 s44, 165888
  s_mov_b32 s46, 21
  v_mov_b32 v217, 1
  v_mov_b32 v216, 2147483632
  s_cmp_eq_u32 s24, 0
  s_cselect_b32 s33, 0, 2147483632
  v_writelane_b32 v216, s33, 0
  s_lshl_b32 s36, s26, 7
  s_add_u32 s36, s36, 54591488
  v_mov_b32 v8, 0
  v_mov_b32 v9, 0
  v_mov_b32 v10, 0
  v_mov_b32 v11, 0
  v_and_b32 v4, 1, v0
  v_lshlrev_b32 v4, 7, v4
  v_lshrrev_b32_e64 v5, 1, v0
  v_lshl_add_u32 v4, v5, 15, v4
  s_lshl_b32 s34, s26, 8
  s_add_u32 s34, s34, 54525952
  v_add_u32 v4, s34, v4
  v_writelane_b32 v4, s36, 4
  v_cmp_gt_u32 vcc, 5, v0
  v_or_b32 v4, s33, v4
  v_mov_b32 v5, 2147483632
  v_cndmask_b32_e64 v4, v5, v4, vcc
  buffer_store_dwordx4 v[8:11], v4, s[20:23], 0 offen sc1
  s_mov_b32 s68, s92
  s_mov_b32 s69, s93
  s_and_b32 s33, s2, 7
  s_lshl_b32 s33, s33, 5
  s_add_u32 s92, s92, s33
  s_addc_u32 s93, s93, 0
  s_mov_b32 s94, 4
  s_mov_b32 s95, 0x20000
  s_mov_b32 s3, 0xffff0000
  v_mov_b32 v9, 2147483632
  s_mov_b32 s86, 5308416
  v_min_u32 v4, 53, v0
  v_mul_u32_u24 v5, 3641, v4
  v_lshrrev_b32 v5, 16, v5
  v_mul_u32_u24 v6, 18, v5
  v_sub_u32 v4, v4, v6
  v_lshlrev_b32 v4, 7, v4
  v_mul_u32_u24 v6, 368640, v5
  v_add_u32_e64 v220, v4, v6
  v_mul_u32_u24 v6, 73728, v5
  v_mov_b32 v113, v227
  s_mov_b32 s38, s37
  v_add_u32 v227, v4, v6
  s_and_b32 s33, s25, 14
  s_lshl_b32 s33, s33, 1
  s_add_u32 s33, s33, s24
  s_mov_b32 s34, s81
  s_and_b32 s33, s33, 31
  s_mul_i32 s45, s34, 1327104
  s_mul_i32 s33, s33, 2304
  s_add_u32 s45, s45, s33
  s_add_u32 s37, s45, 1105920
  buffer_load_dword v218, v220, s[84:87], s45 offen
  s_add_u32 s45, s45, 73728
  s_lshl_b32 s34, s24, 15
  v_and_b32_e64 v210, 1, v0
  v_bfe_u32 v211, v0, 2, 1
  v_lshl_or_b32 v210, v211, 1, v210
  v_bfe_u32 v211, v0, 1, 1
  v_lshl_or_b32 v210, v211, 2, v210
  v_lshl_add_u32 v211, v0, 7, s34
  v_xor_b32_e64 v104, 0, v210
  v_lshl_add_u32 v104, v104, 4, v211
  v_xor_b32_e64 v105, 1, v210
  v_lshl_add_u32 v105, v105, 4, v211
  v_xor_b32_e64 v106, 2, v210
  v_lshl_add_u32 v106, v106, 4, v211
  v_xor_b32_e64 v108, 4, v210
  v_lshl_add_u32 v108, v108, 4, v211
  v_xor_b32_e64 v109, 5, v210
  v_lshl_add_u32 v109, v109, 4, v211
  v_xor_b32_e64 v110, 6, v210
  v_lshl_add_u32 v110, v110, 4, v211
  v_xor_b32_e64 v111, 7, v210
  v_lshl_add_u32 v111, v111, 4, v211
  v_lshrrev_b32_e64 v209, 5, v0
  v_bfe_u32 v211, v0, 2, 2
  v_lshl_add_u32 v100, v209, 3, v211
  v_lshl_add_u32 v100, v100, 7, s34
  v_bfe_u32 v212, v0, 4, 1
  v_bfe_u32 v213, v0, 1, 1
  v_lshl_add_u32 v212, v212, 1, v213
  v_bfe_u32 v211, v0, 2, 1
  v_bfe_u32 v213, v0, 3, 1
  v_lshl_or_b32 v211, v213, 2, v211
  v_xor_b32_e64 v212, v212, v211
  v_lshl_add_u32 v100, v212, 4, v100
  v_and_b32_e64 v212, 1, v0
  v_lshl_add_u32 v100, v212, 3, v100
  v_xor_b32 v101, 32, v100
  v_xor_b32 v102, 64, v100
  v_xor_b32 v103, 96, v100
  v_lshlrev_b32_e64 v221, 4, v0
  v_sub_u32 v221, 1072, v221
  v_mul_u32_u24 v222, 384, v212
  v_and_b32_e64 v210, 30, v0
  v_lshl_add_u32 v210, v209, 6, v210
  v_sub_u32_e64 v222, v222, v210
  v_add_u32 v222, 4446, v222
  v_and_b32 v210, 15, v0
  v_lshrrev_b32 v211, 4, v0
  v_mul_u32_u24 v223, 192, v211
  v_lshl_add_u32 v223, v210, 2, v223
  v_add_u32 v223, 4480, v223
  v_mul_u32_u24 v224, 2176, v209
  v_and_b32_e64 v211, 1, v211
  v_mul_u32_u24 v211, 2112, v211
  v_add_u32_e64 v224, v224, v211
  v_lshl_add_u32 v224, v210, 2, v224
  v_mov_b32 v225, 0
  v_mov_b32 v226, 0
  v_writelane_b32 v225, s3, 13
  v_writelane_b32 v225, -1, 14
  v_writelane_b32 v225, -1, 15
  v_writelane_b32 v225, -1, 46
  v_writelane_b32 v225, -1, 47
  s_mov_b32 s33, 0xffff
  v_writelane_b32 v226, s33, 48
  s_mov_b32 s47, 0
  s_mov_b32 s48, 16
  s_mov_b64 s[50:51], 0
  s_mov_b32 s51, -1
  s_mov_b64 exec, 0
  s_cmp_eq_u32 s24, 1
  s_cbranch_scc1 L_vp1
  s_cmp_eq_u32 s24, 2
  s_cbranch_scc1 L_vback
  s_cmp_eq_u32 s24, 0
  s_cbranch_scc1 L_vp0
L_vback:
  s_mov_b64 exec, -1
  s_waitcnt vmcnt(7) lgkmcnt(0)
L_kg_loop:
  v_mov_b32 v88, v94
  v_mov_b32 v89, v95
  v_mov_b32 v90, v96
  v_mov_b32 v91, v97
  v_mov_b32 v92, v98
  s_mul_i32 s49, s40, 5120
  s_add_u32 s49, s49, 27262976
  s_add_u32 s40, s40, 4
  s_cmp_ge_u32 s47, 6
  s_cselect_b32 s40, s42, s40
  s_lshl_b32 s33, s40, 8
  v_lshl_add_u32 v2, v0, 2, s33
  s_lshl_b32 s33, s40, 1
  v_mov_b32 v3, s33
  global_load_dword v94, v2, s[8:9]
  global_load_dword v95, v2, s[10:11]
  global_load_dword v96, v2, s[12:13]
  global_load_dword v97, v2, s[14:15]
  global_load_ushort v98, v3, s[16:17]
  v_lshlrev_b32_e64 v208, 16, v92
  v_and_b32 v210, 0x7fff7fff, v90
  v_and_b32 v211, 0x7fff7fff, v91
  v_mul_f32 v208, 0x3fb8aa3b, v208
  v_pk_max_u16 v210, v210, v211
  v_exp_f32 v208, v208
  v_lshlrev_b32 v211, 16, v210
  v_max_u32_e64 v210, v210, v211
  v_cvt_pk_bf16_f32 v208, v208, v208
  v_and_b32_e64 v208, s3, v208
  v_max_u32_dpp v210, v210, v210 quad_perm:[1,0,3,2] row_mask:0xf bank_mask:0xf
  s_nop 1
  v_max_u32_dpp v210, v210, v210 quad_perm:[2,3,0,1] row_mask:0xf bank_mask:0xf
  s_nop 1
  v_max_u32_dpp v210, v210, v210 row_half_mirror row_mask:0xf bank_mask:0xf
  s_nop 1
  v_max_u32_dpp v210, v210, v210 row_mirror row_mask:0xf bank_mask:0xf
  s_nop 0
  v_readlane_b32 s33, v210, 0
  v_readlane_b32 s34, v210, 16
  v_readlane_b32 s78, v210, 32
  v_readlane_b32 s79, v210, 48
  s_max_u32 s33, s33, s34
  s_max_u32 s78, s78, s79
  s_max_u32 s33, s33, s78
  s_lshr_b32 s33, s33, 23
  s_max_u32 s33, s33, 40
  s_min_u32 s33, s33, 250
  s_sub_u32 s78, 266, s33
  s_lshl_b32 s78, s78, 23
  s_sub_u32 s79, s33, 25
  s_lshl_b32 s79, s79, 23
L_kg_half:
  buffer_load_dword v218, v219, s[4:7], s43 offen offset:128
  s_add_u32 s43, s43, s44
  s_sub_u32 s44, 128, s44
  v_lshlrev_b32 v212, s48, v88
  v_lshlrev_b32 v213, s48, v89
  v_and_b32 v212, s3, v212
  v_and_b32_e64 v213, s3, v213
  v_mul_f32 v212, 0x3fb8aa3b, v212
  v_mul_f32 v213, v213, v208
  v_exp_f32 v212, v212
  v_mul_f32_e64 v213, 0.15915494, v213
  v_cvt_pk_bf16_f32 v212, v212, v212
  v_and_b32 v212, s3, v212
  v_mul_f32 v212, v212, v208
  v_mul_f32 v212, 0xbfb8aa3b, v212
  v_exp_f32 v210, v212
  v_fract_f32 v211, v213
  v_cos_f32 v114, v211
  v_sin_f32 v115, v211
  v_mul_f32 v114, v114, v210
  v_mul_f32 v115, v115, v210
  v_mul_f32 v210, 0x41000000, v212
  v_mul_f32 v211, 0x41000000, v213
  v_exp_f32 v210, v210
  v_fract_f32 v211, v211
  v_cos_f32 v116, v211
  v_sin_f32 v117, v211
  v_mul_f32 v116, v116, v210
  v_mul_f32 v117, v117, v210
  v_mul_f32 v210, 0x43800000, v212
  v_mul_f32 v211, 0x43800000, v213
  v_exp_f32 v210, v210
  v_fract_f32 v211, v211
  v_cos_f32 v118, v211
  v_sin_f32 v119, v211
  v_mul_f32 v118, v118, v210
  v_mul_f32 v119, v119, v210
  v_lshlrev_b32 v120, s48, v90
  v_lshlrev_b32 v121, s48, v91
  v_and_b32 v120, s3, v120
  v_and_b32 v121, s3, v121
  v_mul_f32 v120, s78, v120
  v_mul_f32 v121, s78, v121
  v_mov_b32 v176, 0x46800000
  v_mov_b32_e64 v177, 0
  v_pk_mul_f32 v[122:123], v[120:121], v[114:115] op_sel:[0,0] op_sel_hi:[1,0]
  v_pk_fma_f32 v[122:123], v[120:121], v[114:115], v[122:123] op_sel:[1,1,0] op_sel_hi:[0,1,1] neg_lo:[0,1,0]
  v_pk_mul_f32 v[124:125], v[122:123], v[114:115] op_sel:[0,0] op_sel_hi:[1,0]
  v_pk_fma_f32 v[124:125], v[122:123], v[114:115], v[124:125] op_sel:[1,1,0] op_sel_hi:[0,1,1] neg_lo:[0,1,0]
  v_pk_mul_f32 v[126:127], v[124:125], v[114:115] op_sel:[0,0] op_sel_hi:[1,0]
  v_pk_fma_f32 v[126:127], v[124:125], v[114:115], v[126:127] op_sel:[1,1,0] op_sel_hi:[0,1,1] neg_lo:[0,1,0]
  v_pk_mul_f32 v[178:179], v[176:177], v[116:117] op_sel:[0,0] op_sel_hi:[1,0]
  v_pk_fma_f32 v[178:179], v[176:177], v[116:117], v[178:179] op_sel:[1,1,0] op_sel_hi:[0,1,1] neg_lo:[0,1,0]
  v_pk_mul_f32 v[128:129], v[126:127], v[114:115] op_sel:[0,0] op_sel_hi:[1,0]
  v_pk_fma_f32 v[128:129], v[126:127], v[114:115], v[128:129] op_sel:[1,1,0] op_sel_hi:[0,1,1] neg_lo:[0,1,0]
  v_pk_mul_f32 v[180:181], v[178:179], v[116:117] op_sel:[0,0] op_sel_hi:[1,0]
  v_pk_fma_f32 v[180:181], v[178:179], v[116:117], v[180:181] op_sel:[1,1,0] op_sel_hi:[0,1,1] neg_lo:[0,1,0]
  v_pk_mul_f32 v[130:131], v[128:129], v[114:115] op_sel:[0,0] op_sel_hi:[1,0]
  v_pk_fma_f32 v[130:131], v[128:129], v[114:115], v[130:131] op_sel:[1,1,0] op_sel_hi:[0,1,1] neg_lo:[0,1,0]
  v_pk_mul_f32 v[132:133], v[130:131], v[114:115] op_sel:[0,0] op_sel_hi:[1,0]
  v_pk_fma_f32 v[132:133], v[130:131], v[114:115], v[132:133] op_sel:[1,1,0] op_sel_hi:[0,1,1] neg_lo:[0,1,0]
  v_pk_mul_f32 v[182:183], v[180:181], v[116:117] op_sel:[0,0] op_sel_hi:[1,0]
  v_pk_fma_f32 v[182:183], v[180:181], v[116:117], v[182:183] op_sel:[1,1,0] op_sel_hi:[0,1,1] neg_lo:[0,1,0]
  v_pk_mul_f32 v[134:135], v[132:133], v[114:115] op_sel:[0,0] op_sel_hi:[1,0]
  v_pk_fma_f32 v[134:135], v[132:133], v[114:115], v[134:135] op_sel:[1,1,0] op_sel_hi:[0,1,1] neg_lo:[0,1,0]
  v_pk_mul_f32 v[184:185], v[182:183], v[116:117] op_sel:[0,0] op_sel_hi:[1,0]
  v_pk_fma_f32 v[184:185], v[182:183], v[116:117], v[184:185] op_sel:[1,1,0] op_sel_hi:[0,1,1] neg_lo:[0,1,0]
  v_pk_mul_f32 v[136:137], v[134:135], v[114:115] op_sel:[0,0] op_sel_hi:[1,0]
  v_pk_fma_f32 v[136:137], v[134:135], v[114:115], v[136:137] op_sel:[1,1,0] op_sel_hi:[0,1,1] neg_lo:[0,1,0]
  v_pk_mul_f32 v[138:139], v[120:121], v[118:119] op_sel:[0,0] op_sel_hi:[1,0]
  v_pk_fma_f32 v[138:139], v[120:121], v[118:119], v[138:139] op_sel:[1,1,0] op_sel_hi:[0,1,1] neg_lo:[0,1,0]
  v_pk_mul_f32 v[186:187], v[184:185], v[116:117] op_sel:[0,0] op_sel_hi:[1,0]
  v_pk_fma_f32 v[186:187], v[184:185], v[116:117], v[186:187] op_sel:[1,1,0] op_sel_hi:[0,1,1] neg_lo:[0,1,0]
  v_pk_mul_f32 v[140:141], v[124:125], v[118:119] op_sel:[0,0] op_sel_hi:[1,0]
  v_pk_fma_f32 v[140:141], v[124:125], v[118:119], v[140:141] op_sel:[1,1,0] op_sel_hi:[0,1,1] neg_lo:[0,1,0]
  v_pk_mul_f32 v[188:189], v[186:187], v[116:117] op_sel:[0,0] op_sel_hi:[1,0]
  v_pk_fma_f32 v[188:189], v[186:187], v[116:117], v[188:189] op_sel:[1,1,0] op_sel_hi:[0,1,1] neg_lo:[0,1,0]
  v_pk_mul_f32 v[142:143], v[128:129], v[118:119] op_sel:[0,0] op_sel_hi:[1,0]
  v_pk_fma_f32 v[142:143], v[128:129], v[118:119], v[142:143] op_sel:[1,1,0] op_sel_hi:[0,1,1] neg_lo:[0,1,0]
  v_pk_mul_f32 v[144:145], v[132:133], v[118:119] op_sel:[0,0] op_sel_hi:[1,0]
  v_pk_fma_f32 v[144:145], v[132:133], v[118:119], v[144:145] op_sel:[1,1,0] op_sel_hi:[0,1,1] neg_lo:[0,1,0]
  v_pk_mul_f32 v[190:191], v[188:189], v[116:117] op_sel:[0,0] op_sel_hi:[1,0]
  v_pk_fma_f32 v[190:191], v[188:189], v[116:117], v[190:191] op_sel:[1,1,0] op_sel_hi:[0,1,1] neg_lo:[0,1,0]
  v_cvt_pk_f16_f32 v192, v176, v178
  v_cvt_pk_f16_f32 v193, v180, v182
  v_cvt_pk_f16_f32 v194, v184, v186
  v_cvt_pk_f16_f32 v195, v188, v190
  ds_write_b128 v108, v[192:195] offset:0
  v_cvt_pk_f16_f32 v196, v177, v179
  v_cvt_pk_f16_f32 v197, v181, v183
  v_cvt_pk_f16_f32 v198, v185, v187
  v_cvt_pk_f16_f32 v199, v189, v191
  s_bitcmp1_b32 s46, s47
  s_cbranch_scc1 L_kg_mid
L_kg_midb:
  v_pk_mul_f32 v[146:147], v[136:137], v[118:119] op_sel:[0,0] op_sel_hi:[1,0]
  v_pk_fma_f32 v[146:147], v[136:137], v[118:119], v[146:147] op_sel:[1,1,0] op_sel_hi:[0,1,1] neg_lo:[0,1,0]
  v_pk_mul_f32 v[176:177], v[190:191], v[116:117] op_sel:[0,0] op_sel_hi:[1,0]
  v_pk_fma_f32 v[176:177], v[190:191], v[116:117], v[176:177] op_sel:[1,1,0] op_sel_hi:[0,1,1] neg_lo:[0,1,0]
  v_pk_mul_f32 v[148:149], v[138:139], v[118:119] op_sel:[0,0] op_sel_hi:[1,0]
  v_pk_fma_f32 v[148:149], v[138:139], v[118:119], v[148:149] op_sel:[1,1,0] op_sel_hi:[0,1,1] neg_lo:[0,1,0]
  v_pk_mul_f32 v[150:151], v[142:143], v[118:119] op_sel:[0,0] op_sel_hi:[1,0]
  v_pk_fma_f32 v[150:151], v[142:143], v[118:119], v[150:151] op_sel:[1,1,0] op_sel_hi:[0,1,1] neg_lo:[0,1,0]
  v_pk_mul_f32 v[178:179], v[176:177], v[116:117] op_sel:[0,0] op_sel_hi:[1,0]
  v_pk_fma_f32 v[178:179], v[176:177], v[116:117], v[178:179] op_sel:[1,1,0] op_sel_hi:[0,1,1] neg_lo:[0,1,0]
  v_pk_mul_f32 v[152:153], v[146:147], v[118:119] op_sel:[0,0] op_sel_hi:[1,0]
  v_pk_fma_f32 v[152:153], v[146:147], v[118:119], v[152:153] op_sel:[1,1,0] op_sel_hi:[0,1,1] neg_lo:[0,1,0]
  v_pk_mul_f32 v[180:181], v[178:179], v[116:117] op_sel:[0,0] op_sel_hi:[1,0]
  v_pk_fma_f32 v[180:181], v[178:179], v[116:117], v[180:181] op_sel:[1,1,0] op_sel_hi:[0,1,1] neg_lo:[0,1,0]
  ds_write_b128 v108, v[196:199] offset:8192
  v_pk_mul_f32 v[154:155], v[148:149], v[118:119] op_sel:[0,0] op_sel_hi:[1,0]
  v_pk_fma_f32 v[154:155], v[148:149], v[118:119], v[154:155] op_sel:[1,1,0] op_sel_hi:[0,1,1] neg_lo:[0,1,0]
  v_pk_mul_f32 v[156:157], v[150:151], v[118:119] op_sel:[0,0] op_sel_hi:[1,0]
  v_pk_fma_f32 v[156:157], v[150:151], v[118:119], v[156:157] op_sel:[1,1,0] op_sel_hi:[0,1,1] neg_lo:[0,1,0]
  v_pk_mul_f32 v[182:183], v[180:181], v[116:117] op_sel:[0,0] op_sel_hi:[1,0]
  v_pk_fma_f32 v[182:183], v[180:181], v[116:117], v[182:183] op_sel:[1,1,0] op_sel_hi:[0,1,1] neg_lo:[0,1,0]
  v_pk_mul_f32 v[158:159], v[152:153], v[118:119] op_sel:[0,0] op_sel_hi:[1,0]
  v_pk_fma_f32 v[158:159], v[152:153], v[118:119], v[158:159] op_sel:[1,1,0] op_sel_hi:[0,1,1] neg_lo:[0,1,0]
  v_pk_mul_f32 v[184:185], v[182:183], v[116:117] op_sel:[0,0] op_sel_hi:[1,0]
  v_pk_fma_f32 v[184:185], v[182:183], v[116:117], v[184:185] op_sel:[1,1,0] op_sel_hi:[0,1,1] neg_lo:[0,1,0]
  v_pk_mul_f32 v[160:161], v[158:159], v[118:119] op_sel:[0,0] op_sel_hi:[1,0]
  v_pk_fma_f32 v[160:161], v[158:159], v[118:119], v[160:161] op_sel:[1,1,0] op_sel_hi:[0,1,1] neg_lo:[0,1,0]
  v_pk_mul_f32 v[162:163], v[160:161], v[118:119] op_sel:[0,0] op_sel_hi:[1,0]
  v_pk_fma_f32 v[162:163], v[160:161], v[118:119], v[162:163] op_sel:[1,1,0] op_sel_hi:[0,1,1] neg_lo:[0,1,0]
  v_pk_mul_f32 v[186:187], v[184:185], v[116:117] op_sel:[0,0] op_sel_hi:[1,0]
  v_pk_fma_f32 v[186:187], v[184:185], v[116:117], v[186:187] op_sel:[1,1,0] op_sel_hi:[0,1,1] neg_lo:[0,1,0]
  v_pk_mul_f32 v[164:165], v[162:163], v[118:119] op_sel:[0,0] op_sel_hi:[1,0]
  v_pk_fma_f32 v[164:165], v[162:163], v[118:119], v[164:165] op_sel:[1,1,0] op_sel_hi:[0,1,1] neg_lo:[0,1,0]
  v_pk_mul_f32 v[188:189], v[186:187], v[116:117] op_sel:[0,0] op_sel_hi:[1,0]
  v_pk_fma_f32 v[188:189], v[186:187], v[116:117], v[188:189] op_sel:[1,1,0] op_sel_hi:[0,1,1] neg_lo:[0,1,0]
  v_pk_mul_f32 v[166:167], v[164:165], v[118:119] op_sel:[0,0] op_sel_hi:[1,0]
  v_pk_fma_f32 v[166:167], v[164:165], v[118:119], v[166:167] op_sel:[1,1,0] op_sel_hi:[0,1,1] neg_lo:[0,1,0]
  v_pk_mul_f32 v[190:191], v[188:189], v[116:117] op_sel:[0,0] op_sel_hi:[1,0]
  v_pk_fma_f32 v[190:191], v[188:189], v[116:117], v[190:191] op_sel:[1,1,0] op_sel_hi:[0,1,1] neg_lo:[0,1,0]
  v_cvt_pk_f16_f32 v200, v176, v178
  v_cvt_pk_f16_f32 v201, v180, v182
  v_cvt_pk_f16_f32 v202, v184, v186
  v_cvt_pk_f16_f32 v203, v188, v190
  ds_write_b128 v109, v[200:203] offset:0
  v_cvt_pk_f16_f32 v204, v177, v179
  v_cvt_pk_f16_f32 v205, v181, v183
  v_cvt_pk_f16_f32 v206, v185, v187
  v_cvt_pk_f16_f32 v207, v189, v191
  v_pk_mul_f32 v[176:177], v[190:191], v[116:117] op_sel:[0,0] op_sel_hi:[1,0]
  v_pk_fma_f32 v[176:177], v[190:191], v[116:117], v[176:177] op_sel:[1,1,0] op_sel_hi:[0,1,1] neg_lo:[0,1,0]
  v_cvt_pk_f16_f32 v192, v120, v122
  v_cvt_pk_f16_f32 v193, v124, v126
  v_cvt_pk_f16_f32 v194, v138, v160
  v_cvt_pk_f16_f32 v195, v140, v162
  ds_write_b128 v104, v[192:195] offset:0
  v_pk_mul_f32 v[178:179], v[176:177], v[116:117] op_sel:[0,0] op_sel_hi:[1,0]
  v_pk_fma_f32 v[178:179], v[176:177], v[116:117], v[178:179] op_sel:[1,1,0] op_sel_hi:[0,1,1] neg_lo:[0,1,0]
  v_pk_mul_f32 v[180:181], v[178:179], v[116:117] op_sel:[0,0] op_sel_hi:[1,0]
  v_pk_fma_f32 v[180:181], v[178:179], v[116:117], v[180:181] op_sel:[1,1,0] op_sel_hi:[0,1,1] neg_lo:[0,1,0]
  ds_write_b128 v109, v[204:207] offset:8192
  v_pk_mul_f32 v[182:183], v[180:181], v[116:117] op_sel:[0,0] op_sel_hi:[1,0]
  v_pk_fma_f32 v[182:183], v[180:181], v[116:117], v[182:183] op_sel:[1,1,0] op_sel_hi:[0,1,1] neg_lo:[0,1,0]
  v_pk_mul_f32 v[184:185], v[182:183], v[116:117] op_sel:[0,0] op_sel_hi:[1,0]
  v_pk_fma_f32 v[184:185], v[182:183], v[116:117], v[184:185] op_sel:[1,1,0] op_sel_hi:[0,1,1] neg_lo:[0,1,0]
  v_cvt_pk_f16_f32 v196, -v121, -v123
  v_cvt_pk_f16_f32 v197, -v125, -v127
  v_cvt_pk_f16_f32 v198, -v139, -v161
  v_cvt_pk_f16_f32 v199, -v141, -v163
  ds_write_b128 v104, v[196:199] offset:8192
  v_pk_mul_f32 v[186:187], v[184:185], v[116:117] op_sel:[0,0] op_sel_hi:[1,0]
  v_pk_fma_f32 v[186:187], v[184:185], v[116:117], v[186:187] op_sel:[1,1,0] op_sel_hi:[0,1,1] neg_lo:[0,1,0]
  v_pk_mul_f32 v[188:189], v[186:187], v[116:117] op_sel:[0,0] op_sel_hi:[1,0]
  v_pk_fma_f32 v[188:189], v[186:187], v[116:117], v[188:189] op_sel:[1,1,0] op_sel_hi:[0,1,1] neg_lo:[0,1,0]
  v_cvt_pk_f16_f32 v200, v128, v130
  v_cvt_pk_f16_f32 v201, v132, v134
  v_cvt_pk_f16_f32 v202, v142, v164
  v_cvt_pk_f16_f32 v203, v144, v166
  ds_write_b128 v105, v[200:203] offset:0
  v_pk_mul_f32 v[190:191], v[188:189], v[116:117] op_sel:[0,0] op_sel_hi:[1,0]
  v_pk_fma_f32 v[190:191], v[188:189], v[116:117], v[190:191] op_sel:[1,1,0] op_sel_hi:[0,1,1] neg_lo:[0,1,0]
  v_cvt_pk_f16_f32 v204, v176, v178
  v_cvt_pk_f16_f32 v205, v180, v182
  v_cvt_pk_f16_f32 v206, v184, v186
  v_cvt_pk_f16_f32 v207, v188, v190
  ds_write_b128 v110, v[204:207] offset:0
  v_cvt_pk_f16_f32 v192, v177, v179
  v_cvt_pk_f16_f32 v193, v181, v183
  v_cvt_pk_f16_f32 v194, v185, v187
  v_cvt_pk_f16_f32 v195, v189, v191
  v_pk_mul_f32 v[176:177], v[190:191], v[116:117] op_sel:[0,0] op_sel_hi:[1,0]
  v_pk_fma_f32 v[176:177], v[190:191], v[116:117], v[176:177] op_sel:[1,1,0] op_sel_hi:[0,1,1] neg_lo:[0,1,0]
  v_cvt_pk_f16_f32 v196, -v129, -v131
  v_cvt_pk_f16_f32 v197, -v133, -v135
  v_cvt_pk_f16_f32 v198, -v143, -v165
  v_cvt_pk_f16_f32 v199, -v145, -v167
  ds_write_b128 v105, v[196:199] offset:8192
  v_pk_mul_f32 v[178:179], v[176:177], v[116:117] op_sel:[0,0] op_sel_hi:[1,0]
  v_pk_fma_f32 v[178:179], v[176:177], v[116:117], v[178:179] op_sel:[1,1,0] op_sel_hi:[0,1,1] neg_lo:[0,1,0]
  v_pk_mul_f32 v[180:181], v[178:179], v[116:117] op_sel:[0,0] op_sel_hi:[1,0]
  v_pk_fma_f32 v[180:181], v[178:179], v[116:117], v[180:181] op_sel:[1,1,0] op_sel_hi:[0,1,1] neg_lo:[0,1,0]
  ds_write_b128 v110, v[192:195] offset:8192
  v_pk_mul_f32 v[182:183], v[180:181], v[116:117] op_sel:[0,0] op_sel_hi:[1,0]
  v_pk_fma_f32 v[182:183], v[180:181], v[116:117], v[182:183] op_sel:[1,1,0] op_sel_hi:[0,1,1] neg_lo:[0,1,0]
  v_pk_mul_f32 v[184:185], v[182:183], v[116:117] op_sel:[0,0] op_sel_hi:[1,0]
L_vp0:
  s_cbranch_execz L_vback
  s_nop 0
  v_pk_fma_f32 v[184:185], v[182:183], v[116:117], v[184:185] op_sel:[1,1,0] op_sel_hi:[0,1,1] neg_lo:[0,1,0]
  v_cvt_pk_f16_f32 v200, v136, v148
  v_cvt_pk_f16_f32 v201, v150, v152
  v_cvt_pk_f16_f32 v202, v146, v154
  v_cvt_pk_f16_f32 v203, v156, v158
  ds_write_b128 v106, v[200:203] offset:0
  v_pk_mul_f32 v[186:187], v[184:185], v[116:117] op_sel:[0,0] op_sel_hi:[1,0]
  v_pk_fma_f32 v[186:187], v[184:185], v[116:117], v[186:187] op_sel:[1,1,0] op_sel_hi:[0,1,1] neg_lo:[0,1,0]
  v_pk_mul_f32 v[188:189], v[186:187], v[116:117] op_sel:[0,0] op_sel_hi:[1,0]
  v_pk_fma_f32 v[188:189], v[186:187], v[116:117], v[188:189] op_sel:[1,1,0] op_sel_hi:[0,1,1] neg_lo:[0,1,0]
  v_cvt_pk_f16_f32 v204, -v137, -v149
  v_cvt_pk_f16_f32 v205, -v151, -v153
  v_cvt_pk_f16_f32 v206, -v147, -v155
  v_cvt_pk_f16_f32 v207, -v157, -v159
  ds_write_b128 v106, v[204:207] offset:8192
  v_pk_mul_f32 v[190:191], v[188:189], v[116:117] op_sel:[0,0] op_sel_hi:[1,0]
  v_pk_fma_f32 v[190:191], v[188:189], v[116:117], v[190:191] op_sel:[1,1,0] op_sel_hi:[0,1,1] neg_lo:[0,1,0]
  v_cvt_pk_f16_f32 v192, v176, v178
  v_cvt_pk_f16_f32 v193, v180, v182
  v_cvt_pk_f16_f32 v194, v184, v186
  v_cvt_pk_f16_f32 v195, v188, v190
  ds_write_b128 v111, v[192:195] offset:0
  v_cvt_pk_f16_f32 v196, v177, v179
  v_cvt_pk_f16_f32 v197, v181, v183
  v_cvt_pk_f16_f32 v198, v185, v187
  v_cvt_pk_f16_f32 v199, v189, v191
  s_add_u32 s47, s47, 1
  s_xor_b32 s48, s48, 16
  ds_write_b128 v111, v[196:199] offset:8192
  v_xor_b32 v104, 0x4000, v104
  v_xor_b32 v105, 0x4000, v105
  v_xor_b32 v106, 0x4000, v106
  v_xor_b32 v108, 0x4000, v108
  v_xor_b32 v109, 0x4000, v109
  v_xor_b32 v110, 0x4000, v110
  v_xor_b32 v111, 0x4000, v111
  s_cmp_eq_u32 s47, 9
  s_cbranch_scc1 L_kg_sync
  s_bitcmp1_b32 s47, 0
  s_cbranch_scc0 L_kg_fin
  s_cmp_eq_u32 s47, 1
  s_cbranch_scc0 L_kg_half
  s_waitcnt vmcnt(6)
  buffer_atomic_add v217, v216, s[92:95], 0 offen
  s_branch L_kg_half
L_kg_sync:
  s_cmp_eq_u32 s24, 0
  s_cbranch_scc0 L_v_bk1
  s_waitcnt vmcnt(12)
  v_min3_u32 v6, v6, v7, v8
  v_cmp_gt_u32 vcc, 1, v6
  s_nop 1
  s_cbranch_vccnz L_v_sp1
L_v_bk1:
  s_waitcnt lgkmcnt(0)
  s_barrier
  s_add_u32 m0, s54, 512
  s_nop 0
  s_nop 0
  buffer_load_dwordx4 v233, s[20:23], s58 offen offset:0 sc1 lds
  s_add_u32 s58, s58, 588800
  buffer_load_dwordx4 v233, s[20:23], s58 offen offset:1024 sc1 lds
  s_add_u32 s58, s58, 588800
  buffer_load_dwordx4 v233, s[20:23], s58 offen offset:2048 sc1 lds
  s_add_u32 s58, s58, 588800
  buffer_load_dwordx4 v233, s[20:23], s58 offen offset:3072 sc1 lds
  s_add_u32 m0, s52, 24576
  s_add_u32 s34, s57, 128
  buffer_load_dwordx4 v228, s[20:23], s34 offen offset:0 lds
  buffer_load_dwordx4 v229, s[20:23], s34 offen offset:1024 lds
  buffer_load_dwordx4 v230, s[20:23], s34 offen offset:2048 lds
  s_add_u32 m0, s52, 36864
  s_add_u32 s34, s57, 0
  buffer_load_dwordx4 v228, s[20:23], s34 offen offset:0 lds
  buffer_load_dwordx4 v229, s[20:23], s34 offen offset:1024 lds
  buffer_load_dwordx4 v230, s[20:23], s34 offen offset:2048 lds
L_kg_fin:
  s_lshl_b32 s33, s24, 4
  s_add_u32 s33, s33, s47
  s_cmp_eq_u32 s33, 8
  s_cbranch_scc0 L_kg_fin2
  v_and_b32 v4, 7, v0
  v_lshlrev_b32_e64 v4, 5, v4
  global_load_dword v5, v4, s[68:69] sc1
L_kg_fin2:
  s_waitcnt lgkmcnt(0)
  s_nop 0
  ds_read_b64_tr_b16 a[0:1], v100 offset:0
  ds_read_b64_tr_b16 a[2:3], v101 offset:512
  ds_read_b64_tr_b16 a[4:5], v102 offset:0
  ds_read_b64_tr_b16 a[6:7], v103 offset:512
  ds_read_b64_tr_b16 a[8:9], v100 offset:2048
  ds_read_b64_tr_b16 a[10:11], v101 offset:2560
  ds_read_b64_tr_b16 a[12:13], v102 offset:2048
  ds_read_b64_tr_b16 a[14:15], v103 offset:2560
  ds_read_b64_tr_b16 a[16:17], v100 offset:4096
  ds_read_b64_tr_b16 a[18:19], v101 offset:4608
  ds_read_b64_tr_b16 a[20:21], v102 offset:4096
  ds_read_b64_tr_b16 a[22:23], v103 offset:4608
  v_mov_b32 v210, 0
  v_mul_f32 v208, s79, v208
  v_mul_f32 v208, 0x411b6ceb, v208
  s_waitcnt lgkmcnt(8)
  s_nop 0
  v_mfma_f32_32x32x16_f16 v[176:191], a[0:3], a[4:7], 0
  ds_read_b64_tr_b16 a[24:25], v100 offset:6144
  ds_read_b64_tr_b16 a[26:27], v101 offset:6656
  ds_read_b64_tr_b16 a[28:29], v102 offset:6144
  ds_read_b64_tr_b16 a[30:31], v103 offset:6656
  s_waitcnt lgkmcnt(8)
  s_nop 0
  v_mfma_f32_32x32x16_f16 v[176:191], a[8:11], a[12:15], v[176:191]
  ds_read_b64_tr_b16 a[32:33], v100 offset:8192
  ds_read_b64_tr_b16 a[34:35], v101 offset:8704
  ds_read_b64_tr_b16 a[36:37], v102 offset:8192
  ds_read_b64_tr_b16 a[38:39], v103 offset:8704
  s_waitcnt lgkmcnt(8)
  s_nop 0
  v_mfma_f32_32x32x16_f16 v[176:191], a[16:19], a[20:23], v[176:191]
  ds_read_b64_tr_b16 a[40:41], v100 offset:10240
  ds_read_b64_tr_b16 a[42:43], v101 offset:10752
  ds_read_b64_tr_b16 a[44:45], v102 offset:10240
  ds_read_b64_tr_b16 a[46:47], v103 offset:10752
  s_waitcnt lgkmcnt(8)
  s_nop 0
  v_mfma_f32_32x32x16_f16 v[176:191], a[24:27], a[28:31], v[176:191]
  ds_read_b64_tr_b16 a[48:49], v100 offset:12288
  ds_read_b64_tr_b16 a[50:51], v101 offset:12800
  ds_read_b64_tr_b16 a[52:53], v102 offset:12288
  ds_read_b64_tr_b16 a[54:55], v103 offset:12800
  s_waitcnt lgkmcnt(8)
  s_nop 0
  v_mfma_f32_32x32x16_f16 v[176:191], a[32:35], a[36:39], v[176:191]
  ds_read_b64_tr_b16 a[56:57], v100 offset:14336
  ds_read_b64_tr_b16 a[58:59], v101 offset:14848
  ds_read_b64_tr_b16 a[60:61], v102 offset:14336
  ds_read_b64_tr_b16 a[62:63], v103 offset:14848
  s_waitcnt lgkmcnt(8)
  s_nop 0
  v_mfma_f32_32x32x16_f16 v[176:191], a[40:43], a[44:47], v[176:191]
  ds_read_b64_tr_b16 a[64:65], v100 offset:16384
  ds_read_b64_tr_b16 a[66:67], v101 offset:16896
  ds_read_b64_tr_b16 a[68:69], v102 offset:16384
  ds_read_b64_tr_b16 a[70:71], v103 offset:16896
  s_waitcnt lgkmcnt(8)
  s_nop 0
  v_mfma_f32_32x32x16_f16 v[176:191], a[48:51], a[52:55], v[176:191]
  ds_read_b64_tr_b16 a[72:73], v100 offset:18432
  ds_read_b64_tr_b16 a[74:75], v101 offset:18944
  ds_read_b64_tr_b16 a[76:77], v102 offset:18432
  ds_read_b64_tr_b16 a[78:79], v103 offset:18944
  s_waitcnt lgkmcnt(8)
  s_nop 0
  v_mfma_f32_32x32x16_f16 v[176:191], a[56:59], a[60:63], v[176:191]
  ds_read_b64_tr_b16 a[80:81], v100 offset:20480
  ds_read_b64_tr_b16 a[82:83], v101 offset:20992
  ds_read_b64_tr_b16 a[84:85], v102 offset:20480
  ds_read_b64_tr_b16 a[86:87], v103 offset:20992
  s_waitcnt lgkmcnt(8)
  s_nop 0
  v_mfma_f32_32x32x16_f16 v[176:191], a[64:67], a[68:71], v[176:191]
  ds_read_b64_tr_b16 a[88:89], v100 offset:22528
  ds_read_b64_tr_b16 a[90:91], v101 offset:23040
  ds_read_b64_tr_b16 a[92:93], v102 offset:22528
  ds_read_b64_tr_b16 a[94:95], v103 offset:23040
  s_waitcnt lgkmcnt(8)
  s_nop 0
  v_mfma_f32_32x32x16_f16 v[176:191], a[72:75], a[76:79], v[176:191]
  ds_read_b64_tr_b16 a[96:97], v100 offset:24576
  ds_read_b64_tr_b16 a[98:99], v101 offset:25088
  ds_read_b64_tr_b16 a[100:101], v102 offset:24576
  ds_read_b64_tr_b16 a[102:103], v103 offset:25088
  s_waitcnt lgkmcnt(8)
  s_nop 0
  v_mfma_f32_32x32x16_f16 v[176:191], a[80:83], a[84:87], v[176:191]
  ds_read_b64_tr_b16 a[104:105], v100 offset:26624
  ds_read_b64_tr_b16 a[106:107], v101 offset:27136
  ds_read_b64_tr_b16 a[108:109], v102 offset:26624
  ds_read_b64_tr_b16 a[110:111], v103 offset:27136
  s_waitcnt lgkmcnt(8)
  s_nop 0
  v_mfma_f32_32x32x16_f16 v[176:191], a[88:91], a[92:95], v[176:191]
  ds_read_b64_tr_b16 a[112:113], v100 offset:28672
  ds_read_b64_tr_b16 a[114:115], v101 offset:29184
  ds_read_b64_tr_b16 a[116:117], v102 offset:28672
  ds_read_b64_tr_b16 a[118:119], v103 offset:29184
  s_waitcnt lgkmcnt(8)
  s_nop 0
  v_mfma_f32_32x32x16_f16 v[176:191], a[96:99], a[100:103], v[176:191]
  ds_read_b64_tr_b16 a[120:121], v100 offset:30720
  ds_read_b64_tr_b16 a[122:123], v101 offset:31232
  ds_read_b64_tr_b16 a[124:125], v102 offset:30720
  ds_read_b64_tr_b16 a[126:127], v103 offset:31232
  s_waitcnt lgkmcnt(8)
  v_mfma_f32_32x32x16_f16 v[176:191], a[104:107], a[108:111], v[176:191]
  buffer_store_dword v210, v223, s[20:23], s49 offen
  s_waitcnt lgkmcnt(4)
  v_mfma_f32_32x32x16_f16 v[176:191], a[112:115], a[116:119], v[176:191]
  s_waitcnt lgkmcnt(0)
  v_mfma_f32_32x32x16_f16 v[176:191], a[120:123], a[124:127], v[176:191]
  s_nop 7
  s_nop 3
  s_nop 0
  v_pk_mul_f32 v[176:177], v[176:177], v[208:209] op_sel_hi:[1,0]
  v_pk_mul_f32 v[178:179], v[178:179], v[208:209] op_sel_hi:[1,0]
  v_pk_mul_f32 v[180:181], v[180:181], v[208:209] op_sel_hi:[1,0]
  v_pk_mul_f32 v[182:183], v[182:183], v[208:209] op_sel_hi:[1,0]
  v_pk_mul_f32 v[184:185], v[184:185], v[208:209] op_sel_hi:[1,0]
  v_pk_mul_f32 v[186:187], v[186:187], v[208:209] op_sel_hi:[1,0]
  v_cvt_pk_bf16_f32 v211, v177, v179
  v_cvt_pk_bf16_f32 v212, v181, v183
  v_cvt_pk_bf16_f32 v213, v187, v187
  v_cvt_pk_bf16_f32 v214, v176, v176
  v_permlane32_swap_b32 v211, v212
  s_nop 0
  v_readlane_b32 s33, v213, 63
  v_readlane_b32 s34, v214, 0
  v_cndmask_b32 v177, v177, v176, s[50:51]
  v_cndmask_b32 v179, v179, v180, s[50:51]
  v_cndmask_b32 v181, v181, v180, s[50:51]
  v_cndmask_b32 v183, v183, v184, s[50:51]
  v_and_b32_e64 v213, s33, v225
  v_and_or_b32 v213, s34, v226, v213
  buffer_store_dword v213, v224, s[20:23], s49 offen
  v_cvt_pk_bf16_f32 v120, v183, v182
  v_cvt_pk_bf16_f32 v121, v181, v180
  buffer_store_short_d16_hi v212, v222, s[20:23], s49 offen offset:194
  v_cvt_pk_bf16_f32 v122, v179, v178
  v_cvt_pk_bf16_f32 v123, v177, v176
  buffer_store_dwordx4 v[120:123], v221, s[20:23], s49 offen offset:1024
  v_cvt_pk_bf16_f32 v124, v184, v183
  v_cvt_pk_bf16_f32 v125, v182, v181
  buffer_store_short v212, v222, s[20:23], s49 offen offset:226
  v_cvt_pk_bf16_f32 v126, v180, v179
  v_cvt_pk_bf16_f32 v127, v178, v177
  buffer_store_dwordx4 v[124:127], v221, s[20:23], s49 offen offset:3200
  v_cvt_pk_bf16_f32 v128, v187, v187
  v_cvt_pk_bf16_f32 v129, v186, v186
  buffer_store_short_d16_hi v212, v222, s[20:23], s49 offen
  v_cvt_pk_bf16_f32 v130, v186, v185
  v_cvt_pk_bf16_f32 v131, v185, v185
  buffer_store_dwordx4 v[128:131], v221, s[20:23], s49 offen offset:0
  v_cvt_pk_bf16_f32 v132, v187, v187
  v_cvt_pk_bf16_f32 v133, v187, v186
  buffer_store_short v212, v222, s[20:23], s49 offen offset:32
  v_cvt_pk_bf16_f32 v134, v186, v186
  v_cvt_pk_bf16_f32 v135, v185, v185
  buffer_store_dwordx4 v[132:135], v221, s[20:23], s49 offen offset:2176
  s_cmp_eq_u32 s47, 9
  s_cbranch_scc1 L_kg_done
  s_waitcnt vmcnt(12)
  s_cmp_eq_u32 s47, 8
  s_cbranch_scc0 L_kg_loop
  s_cmp_eq_u32 s24, 0
  s_cbranch_scc0 L_v_nolook
  s_waitcnt vmcnt(10)
  v_cmp_gt_u32 vcc, 4, v5
  v_lshlrev_b32 v9, 7, v0
  s_mov_b32 s31, 54558720
  s_cbranch_vccnz L_v_sp0
L_v_bk0:
  buffer_load_dwordx3 v[6:8], v9, s[20:23], s31 offen sc1
L_v_nolook:
  s_mov_b32 s6, 0
  s_lshl_b32 s48, s39, 4
  s_xor_b32 s48, s48, 16
  s_lshr_b32 s33, s24, 1
  s_sub_u32 s33, s33, s24
  s_add_u32 s33, s33, 3
  s_lshl_b32 s33, s33, 15
  s_lshl_b32 s34, s39, 14
  s_add_u32 s34, s34, s33
  v_add_u32 v104, s34, v104
  v_add_u32 v105, s34, v105
  v_add_u32 v106, s34, v106
  v_add_u32 v108, s34, v108
  v_add_u32 v109, s34, v109
  v_add_u32 v110, s34, v110
  v_add_u32 v111, s34, v111
  v_add_u32 v100, s33, v100
  v_add_u32 v101, s33, v101
  v_add_u32 v102, s33, v102
  v_add_u32_e64 v103, s33, v103
  s_mul_i32 s52, s24, 3072
  s_lshl_b32 s53, s24, 11
  s_add_u32 s53, s53, 49152
  v_add_u32 v239, s53, v239
  v_add_u32 v235, s52, v235
  v_add_u32 v236, s53, v236
  s_mul_i32 s54, s24, 4608
  s_add_u32 s54, s54, 57344
  s_add_u32 s55, s54, 18432
  s_add_u32 s56, s55, 18432
  s_mul_i32 s57, s41, 5120
  s_add_u32 s57, s57, 27260928
  s_lshl_b32 s58, s41, 8
  s_add_u32 s58, s58, 20971520
  s_barrier
  s_add_u32 m0, s52, 0
  s_nop 0
  s_add_u32 s34, s57, 384
  buffer_load_dwordx4 v228, s[20:23], s34 offen offset:0 lds
  buffer_load_dwordx4 v229, s[20:23], s34 offen offset:1024 lds
  buffer_load_dwordx4 v230, s[20:23], s34 offen offset:2048 lds
  s_add_u32 m0, s52, 12288
  s_add_u32 s34, s57, 256
  buffer_load_dwordx4 v228, s[20:23], s34 offen offset:0 lds
  buffer_load_dwordx4 v229, s[20:23], s34 offen offset:1024 lds
  buffer_load_dwordx4 v230, s[20:23], s34 offen offset:2048 lds
  s_mov_b32 m0, s53
  s_nop 0
  buffer_load_dwordx4 v231, s[20:23], s57 offen offset:0 lds
  buffer_load_dwordx4 v232, s[20:23], s57 offen offset:1024 lds
  v_mov_b32 v10, 0
  v_mov_b32 v11, 0
  v_lshl_add_u32 v12, v0, 3, s54
  ds_write_b64 v12, v[10:11]
  ds_write_b64 v12, v[10:11] offset:18432
  s_branch L_kg_loop
L_kg_mid:
  s_cmp_eq_u32 s47, 4
  s_cbranch_scc1 L_kg_mid2
  buffer_load_dword v218, v113, s[4:7], s38 offen offset:1920
  s_add_u32 s38, s38, 165888
  s_branch L_kg_midb
L_kg_mid2:
  buffer_load_dword v218, v220, s[84:87], s45 offen
  s_add_u32 s45, s45, 73728
  s_branch L_kg_midb
L_kg_done:
  s_and_b32 s33, s41, 1
  s_lshl_b32 s33, s33, 4
  s_lshr_b32 s60, s60, s33
  s_lshl_b32 s60, s60, 16
  s_and_b32 s33, s41, 1
  s_lshl_b32 s33, s33, 4
  s_lshr_b32 s61, s61, s33
  s_lshl_b32 s61, s61, 16
  s_and_b32 s33, s41, 1
  s_lshl_b32 s33, s33, 4
  s_lshr_b32 s62, s62, s33
  s_lshl_b32 s62, s62, 16
  s_and_b32 s33, s41, 1
  s_lshl_b32 s33, s33, 4
  s_lshr_b32 s63, s63, s33
  s_lshl_b32 s63, s63, 16
  s_and_b32 s33, s42, 1
  s_lshl_b32 s33, s33, 4
  s_lshr_b32 s64, s64, s33
  s_lshl_b32 s64, s64, 16
  v_mov_b32 v4, 0x411b6ceb
  v_mul_f32 v5, s60, v4
  v_mul_f32 v6, s61, v4
  v_mul_f32 v7, s62, v4
  v_mul_f32 v8, s63, v4
  v_mul_f32 v9, s64, v4
  v_readfirstlane_b32 s60, v5
  v_readfirstlane_b32 s61, v6
  v_readfirstlane_b32 s62, v7
  v_readfirstlane_b32 s63, v8
  v_readfirstlane_b32 s64, v9
  v_add_u32 v13, s54, v237
  v_mov_b32 v10, 0
  v_mov_b32 v11, 0
  v_lshl_add_u32 v7, v0, 3, s56
  s_mov_b32 s29, 0
  s_mov_b32 s65, 0
  s_mov_b32 s66, 2147483632
  s_mov_b32 s40, s41
  s_waitcnt vmcnt(10)
  s_barrier
  s_nop 0
  ds_write_b64 v7, v[10:11]
  s_mov_b32 s86, 5308416
  buffer_load_dword v218, v227, s[84:87], s37 offen
  ds_read_b128 a[16:19], v13 offset:480
  ds_read_b64 a[0:1], v235 offset:0
  ds_read_b128 a[20:23], v13 offset:992
  ds_read_b64 a[2:3], v235 offset:8
  ds_read_b128 a[24:27], v13 offset:1504
  ds_read_b64 a[4:5], v235 offset:96
  ds_read_b128 a[28:31], v13 offset:2016
  ds_read_b64 a[6:7], v235 offset:104
  ds_read_b128 a[32:35], v13 offset:2528
  ds_read_b64 a[8:9], v235 offset:768
  ds_read_b128 a[36:39], v13 offset:3040
  ds_read_b64 a[10:11], v235 offset:776
  ds_read_b128 a[40:43], v13 offset:3552
  ds_read_b64 a[12:13], v235 offset:864
  ds_read_b128 a[44:47], v13 offset:4064
  ds_read_b64 a[14:15], v235 offset:872
  v_accvgpr_write_b32 a124, 0
  v_accvgpr_write_b32 a125, 0
  v_accvgpr_write_b32 a136, 0
  v_accvgpr_write_b32 a137, 0
  s_waitcnt lgkmcnt(0)
L_cv_loop:
  v_mfma_f32_16x16x32_bf16 v[32:35], a[0:3], a[16:19], 0
  s_waitcnt vmcnt(14)
  v_mov_b32 v12, v13
  v_add_u32 v14, s56, v238
  v_mfma_f32_16x16x32_bf16 v[36:39], a[0:3], a[20:23], 0
  s_add_u32 s29, s29, 1
  ds_read_b64 v[152:153], v14 offset:512
  ds_read_b64 v[154:155], v14 offset:1024
  v_mfma_f32_16x16x32_bf16 v[36:39], a[4:7], a[16:19], v[36:39]
  s_mul_i32 s67, s40, 4352
  ds_read_b64 v[156:157], v14 offset:1536
  ds_read_b64 v[158:159], v14 offset:2048
  v_mfma_f32_16x16x32_bf16 v[40:43], a[8:11], a[16:19], 0
  s_add_u32 s40, s40, 4
  ds_read_b64 v[160:161], v14 offset:2560
  ds_read_b64 v[162:163], v14 offset:3072
  v_mfma_f32_16x16x32_bf16 v[40:43], a[4:7], a[20:23], v[40:43]
  s_cmp_ge_u32 s29, 4
  ds_read_b64 v[164:165], v14 offset:3584
  ds_read_b64 v[166:167], v14 offset:4096
  v_mfma_f32_16x16x32_bf16 v[40:43], a[0:3], a[24:27], v[40:43]
  s_cselect_b32 s40, s42, s40
  ds_read_b128 a[96:99], v13 offset:464
  v_mfma_f32_16x16x32_bf16 v[44:47], a[0:3], a[28:31], 0
  s_cselect_b32 s35, s39, 0
  ds_read_b128 a[100:103], v13 offset:976
  v_mfma_f32_16x16x32_bf16 v[44:47], a[4:7], a[24:27], v[44:47]
  s_mul_i32 s57, s40, 5120
  ds_read_b128 a[104:107], v13 offset:1488
  v_mfma_f32_16x16x32_bf16 v[44:47], a[8:11], a[20:23], v[44:47]
  s_add_u32 s57, s57, 27260928
  ds_read_b128 a[108:111], v13 offset:2000
  v_mfma_f32_16x16x32_bf16 v[44:47], a[12:15], a[16:19], v[44:47]
  s_lshl_b32 s33, s35, 30
  ds_read_b64 a[112:113], v239 offset:0
  v_mfma_f32_16x16x32_bf16 v[48:51], a[12:15], a[20:23], 0
  s_add_u32 s59, s57, s33
  ds_read_b64 a[114:115], v239 offset:8
  v_mfma_f32_16x16x32_bf16 v[48:51], a[8:11], a[24:27], v[48:51]
  s_lshl_b32 s35, s35, 8
  ds_read_b128 a[64:67], v12 offset:416
  v_mfma_f32_16x16x32_bf16 v[48:51], a[4:7], a[28:31], v[48:51]
  s_waitcnt lgkmcnt(7)
  ds_read_b64 a[48:49], v235 offset:1536
  v_lshlrev_b32 v168, 16, v152
  v_mfma_f32_16x16x32_bf16 v[48:51], a[0:3], a[32:35], v[48:51]
  s_sub_u32 s57, s57, s35
  ds_read_b128 a[68:71], v12 offset:928
  v_and_b32 v169, s3, v152
  v_mfma_f32_16x16x32_bf16 v[52:55], a[0:3], a[36:39], 0
  s_lshl_b32 s58, s40, 8
  ds_read_b64 a[50:51], v235 offset:1544
  v_fmac_f32 v64, s65, v168
  v_mfma_f32_16x16x32_bf16 v[52:55], a[4:7], a[32:35], v[52:55]
  s_add_u32 s58, s58, 20971520
  ds_read_b128 a[72:75], v12 offset:1440
  v_fmac_f32_e64 v65, s65, v169
  v_mfma_f32_16x16x32_bf16 v[52:55], a[8:11], a[28:31], v[52:55]
  s_sub_u32 s35, s55, s35
  ds_read_b64 a[52:53], v235 offset:1632
  v_cvt_pk_bf16_f32 v184, v64, v65
  v_mfma_f32_16x16x32_bf16 v[52:55], a[12:15], a[24:27], v[52:55]
  s_add_u32 s67, s67, 24117248
  ds_read_b128 a[76:79], v12 offset:1952
  v_lshlrev_b32 v170, 16, v153
  v_mfma_f32_16x16x32_bf16 v[56:59], a[12:15], a[28:31], 0
  ds_read_b64 a[54:55], v235 offset:1640
  v_and_b32_e64 v171, s3, v153
  v_mfma_f32_16x16x32_bf16 v[56:59], a[8:11], a[32:35], v[56:59]
  ds_read_b128 a[80:83], v12 offset:2464
  v_fmac_f32_e64 v66, s65, v170
  v_mfma_f32_16x16x32_bf16 v[56:59], a[4:7], a[36:39], v[56:59]
  ds_read_b64 a[56:57], v235 offset:2304
  v_fmac_f32_e64 v67, s65, v171
  v_mfma_f32_16x16x32_bf16 v[56:59], a[0:3], a[40:43], v[56:59]
  ds_read_b128 a[84:87], v12 offset:2976
  v_cvt_pk_bf16_f32 v185, v66, v67
  v_mfma_f32_16x16x32_bf16 v[60:63], a[0:3], a[44:47], 0
  ds_read_b64 a[58:59], v235 offset:2312
  v_lshlrev_b32_e64 v172, 16, v154
  v_mfma_f32_16x16x32_bf16 v[60:63], a[4:7], a[40:43], v[60:63]
  ds_read_b128 a[88:91], v12 offset:3488
  v_and_b32_e64 v173, s3, v154
  v_mfma_f32_16x16x32_bf16 v[60:63], a[8:11], a[36:39], v[60:63]
  ds_read_b64 a[60:61], v235 offset:2400
  v_fmac_f32_e64 v68, s65, v172
  v_mfma_f32_16x16x32_bf16 v[60:63], a[12:15], a[32:35], v[60:63]
  s_waitcnt lgkmcnt(14)
  ds_read_b128 a[92:95], v12 offset:4000
  v_fmac_f32 v69, s65, v173
  v_mfma_f32_16x16x32_bf16 v[96:99], a[16:19], v[240:243], 0
  ds_read_b64 a[62:63], v235 offset:2408
  v_cvt_pk_bf16_f32 v186, v68, v69
  v_mfma_f32_16x16x32_bf16 v[100:103], a[20:23], v[240:243], 0
  buffer_store_dwordx2 v[184:185], v238, s[20:23], s66 offen offset:0 sc1
  v_mfma_f32_16x16x32_bf16 v[104:107], a[24:27], v[240:243], 0
  v_lshlrev_b32 v174, 16, v155
  v_lshlrev_b32 v176, 16, v156
  v_mfma_f32_16x16x32_bf16 v[108:111], a[28:31], v[240:243], 0
  v_and_b32 v175, s3, v155
  v_and_b32 v177, s3, v156
  v_mfma_f32_16x16x32_bf16 v[112:115], a[96:99], v[244:247], 0
  v_fmac_f32 v70, s65, v174
  v_fmac_f32 v72, s65, v176
  v_mfma_f32_16x16x32_bf16 v[116:119], a[100:103], v[244:247], 0
  v_fmac_f32 v71, s65, v175
  v_fmac_f32 v73, s65, v177
  v_mfma_f32_16x16x32_bf16 v[120:123], a[104:107], v[244:247], 0
  v_cvt_pk_bf16_f32 v187, v70, v71
  v_cvt_pk_bf16_f32 v188, v72, v73
  v_mfma_f32_16x16x32_bf16 v[124:127], a[108:111], v[244:247], 0
  buffer_store_dwordx2 v[186:187], v238, s[20:23], s66 offen offset:512 sc1
  v_mfma_f32_16x16x32_bf16 v[48:51], a[112:115], a[16:19], v[48:51]
  v_lshlrev_b32 v178, 16, v157
  v_lshlrev_b32 v180, 16, v158
  v_mfma_f32_16x16x32_bf16 v[52:55], a[112:115], a[20:23], v[52:55]
  v_and_b32 v179, s3, v157
  v_and_b32 v181, s3, v158
  v_mfma_f32_16x16x32_bf16 v[56:59], a[112:115], a[24:27], v[56:59]
  v_fmac_f32 v74, s65, v178
  v_fmac_f32 v76, s65, v180
  v_mfma_f32_16x16x32_bf16 v[60:63], a[112:115], a[28:31], v[60:63]
  s_waitcnt lgkmcnt(0)
  v_fmac_f32 v75, s65, v179
  v_fmac_f32_e64 v77, s65, v181
  v_mfma_f32_16x16x32_bf16 v[32:35], a[48:51], a[64:67], v[32:35]
  s_waitcnt vmcnt(7)
  v_cvt_pk_bf16_f32 v189, v74, v75
  v_cvt_pk_bf16_f32 v190, v76, v77
  v_mfma_f32_16x16x32_bf16 v[36:39], a[48:51], a[68:71], v[36:39]
  ds_read_b128 a[16:19], v12 offset:352
  ds_read_b64 a[122:123], v236 offset:96
  v_mfma_f32_16x16x32_bf16 v[36:39], a[52:55], a[64:67], v[36:39]
  ds_read_b64 a[0:1], v235 offset:12288
  v_cvt_pk_bf16_f32 v128, v96, v97
  v_mfma_f32_16x16x32_bf16 v[40:43], a[56:59], a[64:67], v[40:43]
  ds_read_b128 a[20:23], v12 offset:864
  ds_read_b64 a[120:121], v236 offset:64
  v_mfma_f32_16x16x32_bf16 v[40:43], a[52:55], a[68:71], v[40:43]
  ds_read_b64 a[2:3], v235 offset:12296
  v_cvt_pk_bf16_f32 v129, v98, v99
  v_mfma_f32_16x16x32_bf16 v[40:43], a[48:51], a[72:75], v[40:43]
  ds_read_b128 a[24:27], v12 offset:1376
  ds_read_b64 a[118:119], v236 offset:32
  v_mfma_f32_16x16x32_bf16 v[44:47], a[48:51], a[76:79], v[44:47]
  ds_read_b64 a[4:5], v235 offset:12384
  v_cvt_pk_bf16_f32 v130, v100, v101
  v_mfma_f32_16x16x32_bf16 v[44:47], a[52:55], a[72:75], v[44:47]
  ds_read_b128 a[28:31], v12 offset:1888
  ds_read_b64 a[116:117], v236 offset:0
  v_mfma_f32_16x16x32_bf16 v[44:47], a[56:59], a[68:71], v[44:47]
  ds_read_b64 a[6:7], v235 offset:12392
  v_cvt_pk_bf16_f32 v131, v102, v103
  v_mfma_f32_16x16x32_bf16 v[44:47], a[60:63], a[64:67], v[44:47]
  ds_read_b128 a[32:35], v12 offset:2400
  ds_read_b64 a[134:135], v236 offset:256
  v_mfma_f32_16x16x32_bf16 v[48:51], a[60:63], a[68:71], v[48:51]
  ds_read_b64 a[8:9], v235 offset:13056
  v_cvt_pk_bf16_f32 v132, v104, v105
  v_mfma_f32_16x16x32_bf16 v[48:51], a[56:59], a[72:75], v[48:51]
  ds_read_b128 a[36:39], v12 offset:2912
  ds_read_b64 a[132:133], v236 offset:224
  v_mfma_f32_16x16x32_bf16 v[48:51], a[52:55], a[76:79], v[48:51]
  ds_read_b64 a[10:11], v235 offset:13064
  v_cvt_pk_bf16_f32 v133, v106, v107
  v_mfma_f32_16x16x32_bf16 v[48:51], a[48:51], a[80:83], v[48:51]
  ds_read_b128 a[40:43], v12 offset:3424
  ds_read_b64 a[130:131], v236 offset:192
  v_mfma_f32_16x16x32_bf16 v[52:55], a[48:51], a[84:87], v[52:55]
  ds_read_b64 a[12:13], v235 offset:13152
  v_cvt_pk_bf16_f32 v134, v108, v109
  v_mfma_f32_16x16x32_bf16 v[52:55], a[52:55], a[80:83], v[52:55]
  ds_read_b128 a[44:47], v12 offset:3936
  ds_read_b64 a[128:129], v236 offset:160
  v_mfma_f32_16x16x32_bf16 v[52:55], a[56:59], a[76:79], v[52:55]
  s_add_u32 m0, s52, 0
  ds_read_b64 a[14:15], v235 offset:13160
  v_cvt_pk_bf16_f32 v135, v110, v111
  v_mfma_f32_16x16x32_bf16 v[52:55], a[60:63], a[72:75], v[52:55]
  s_add_u32 s34, s57, 384
  v_cvt_pk_bf16_f32 v136, v112, v113
  v_cvt_pk_bf16_f32 v137, v114, v115
  v_mfma_f32_16x16x32_bf16 v[56:59], a[60:63], a[76:79], v[56:59]
  buffer_load_dwordx4 v228, s[20:23], s34 offen offset:0 lds
  v_mfma_f32_16x16x32_bf16 v[56:59], a[56:59], a[80:83], v[56:59]
  v_cvt_pk_bf16_f32 v138, v116, v117
  v_cvt_pk_bf16_f32 v139, v118, v119
  v_mfma_f32_16x16x32_bf16 v[56:59], a[52:55], a[84:87], v[56:59]
  buffer_load_dwordx4 v229, s[20:23], s34 offen offset:1024 lds
  v_mfma_f32_16x16x32_bf16 v[56:59], a[48:51], a[88:91], v[56:59]
  v_cvt_pk_bf16_f32 v140, v120, v121
  v_cvt_pk_bf16_f32 v141, v122, v123
  v_mfma_f32_16x16x32_bf16 v[60:63], a[48:51], a[92:95], v[60:63]
  buffer_load_dwordx4 v230, s[20:23], s34 offen offset:2048 lds
  v_mfma_f32_16x16x32_bf16 v[60:63], a[52:55], a[88:91], v[60:63]
  v_cvt_pk_bf16_f32 v142, v124, v125
  v_cvt_pk_bf16_f32 v143, v126, v127
  v_mfma_f32_16x16x32_bf16 v[60:63], a[56:59], a[84:87], v[60:63]
  buffer_store_dwordx2 v[188:189], v238, s[20:23], s66 offen offset:1024 sc1
  v_mfma_f32_16x16x32_bf16 v[60:63], a[60:63], a[80:83], v[60:63]
  s_waitcnt lgkmcnt(0)
  v_lshlrev_b32 v182, 16, v159
  v_lshlrev_b32_e64 v168, 16, v160
  v_mfma_f32_16x16x32_bf16 v[32:35], a[0:3], a[16:19], v[32:35]
  v_and_b32 v183, s3, v159
  v_and_b32 v169, s3, v160
  v_mfma_f32_16x16x32_bf16 v[36:39], a[0:3], a[20:23], v[36:39]
  ds_read_b128 a[64:67], v12 offset:288
  v_fmac_f32_e64 v78, s65, v182
  v_mfma_f32_16x16x32_bf16 v[36:39], a[4:7], a[16:19], v[36:39]
  ds_read_b64 a[48:49], v235 offset:13824
  v_fmac_f32_e64 v79, s65, v183
  v_mfma_f32_16x16x32_bf16 v[40:43], a[8:11], a[16:19], v[40:43]
  ds_read_b128 a[68:71], v12 offset:800
  v_cvt_pk_bf16_f32 v191, v78, v79
  v_mfma_f32_16x16x32_bf16 v[40:43], a[4:7], a[20:23], v[40:43]
  ds_read_b64 a[50:51], v235 offset:13832
  v_fmac_f32_e64 v80, s65, v168
  v_mfma_f32_16x16x32_bf16 v[40:43], a[0:3], a[24:27], v[40:43]
L_vp1:
  s_cbranch_execz L_vback
  ds_read_b128 a[72:75], v12 offset:1312
  v_fmac_f32 v81, s65, v169
  v_mfma_f32_16x16x32_bf16 v[44:47], a[0:3], a[28:31], v[44:47]
  ds_read_b64 a[52:53], v235 offset:13920
  v_cvt_pk_bf16_f32 v184, v80, v81
  v_mfma_f32_16x16x32_bf16 v[44:47], a[4:7], a[24:27], v[44:47]
  ds_read_b128 a[76:79], v12 offset:1824
  v_lshlrev_b32_e64 v170, 16, v161
  v_mfma_f32_16x16x32_bf16 v[44:47], a[8:11], a[20:23], v[44:47]
  ds_read_b64 a[54:55], v235 offset:13928
  v_and_b32_e64 v171, s3, v161
  v_mfma_f32_16x16x32_bf16 v[44:47], a[12:15], a[16:19], v[44:47]
  ds_read_b128 a[80:83], v12 offset:2336
  v_fmac_f32_e64 v82, s65, v170
  v_mfma_f32_16x16x32_bf16 v[48:51], a[12:15], a[20:23], v[48:51]
  ds_read_b64 a[56:57], v235 offset:14592
  v_fmac_f32_e64 v83, s65, v171
  v_mfma_f32_16x16x32_bf16 v[48:51], a[8:11], a[24:27], v[48:51]
  ds_read_b128 a[84:87], v12 offset:2848
  v_cvt_pk_bf16_f32 v185, v82, v83
  v_mfma_f32_16x16x32_bf16 v[48:51], a[4:7], a[28:31], v[48:51]
  ds_read_b64 a[58:59], v235 offset:14600
  v_lshlrev_b32_e64 v172, 16, v162
  v_mfma_f32_16x16x32_bf16 v[48:51], a[0:3], a[32:35], v[48:51]
  ds_read_b128 a[88:91], v12 offset:3360
  v_and_b32_e64 v173, s3, v162
  v_mfma_f32_16x16x32_bf16 v[52:55], a[0:3], a[36:39], v[52:55]
  ds_read_b64 a[60:61], v235 offset:14688
  v_fmac_f32_e64 v84, s65, v172
  v_mfma_f32_16x16x32_bf16 v[52:55], a[4:7], a[32:35], v[52:55]
  ds_read_b128 a[92:95], v12 offset:3872
  v_fmac_f32_e64 v85, s65, v173
  v_mfma_f32_16x16x32_bf16 v[52:55], a[8:11], a[28:31], v[52:55]
  ds_read_b64 a[62:63], v235 offset:14696
  v_cvt_pk_bf16_f32 v186, v84, v85
  v_mfma_f32_16x16x32_bf16 v[52:55], a[12:15], a[24:27], v[52:55]
  buffer_store_dwordx2 v[190:191], v238, s[20:23], s66 offen offset:1536 sc1
  v_mfma_f32_16x16x32_bf16 v[56:59], a[12:15], a[28:31], v[56:59]
  s_mov_b32 m0, s53
  v_lshlrev_b32 v174, 16, v163
  v_and_b32_e64 v175, s3, v163
  v_mfma_f32_16x16x32_bf16 v[56:59], a[8:11], a[32:35], v[56:59]
  buffer_store_dwordx2 v[184:185], v238, s[20:23], s66 offen offset:2048 sc1
  v_mfma_f32_16x16x32_bf16 v[56:59], a[4:7], a[36:39], v[56:59]
  buffer_load_dwordx4 v231, s[20:23], s59 offen offset:0 lds
  v_mfma_f32_16x16x32_bf16 v[56:59], a[0:3], a[40:43], v[56:59]
  v_fmac_f32 v86, s65, v174
  v_lshlrev_b32 v176, 16, v164
  v_mfma_f32_16x16x32_bf16 v[60:63], a[0:3], a[44:47], v[60:63]
  buffer_load_dwordx4 v232, s[20:23], s59 offen offset:1024 lds
  v_mfma_f32_16x16x32_bf16 v[60:63], a[4:7], a[40:43], v[60:63]
  v_fmac_f32 v87, s65, v175
  v_and_b32 v177, s3, v164
  v_mfma_f32_16x16x32_bf16 v[60:63], a[8:11], a[36:39], v[60:63]
  v_cvt_pk_bf16_f32 v187, v86, v87
  v_fmac_f32_e64 v88, s65, v176
  v_mfma_f32_16x16x32_bf16 v[60:63], a[12:15], a[32:35], v[60:63]
  buffer_store_dwordx2 v[186:187], v238, s[20:23], s66 offen offset:2560 sc1
  v_mfma_f32_16x16x32_bf16 v[48:51], v[128:131], a[122:125], v[48:51]
  v_fmac_f32 v89, s65, v177
  v_lshlrev_b32 v178, 16, v165
  v_mfma_f32_16x16x32_bf16 v[52:55], v[128:131], a[120:123], v[52:55]
  v_cvt_pk_bf16_f32 v188, v88, v89
  v_and_b32_e64 v179, s3, v165
  v_mfma_f32_16x16x32_bf16 v[56:59], v[128:131], a[118:121], v[56:59]
  v_fmac_f32 v90, s65, v178
  v_lshlrev_b32 v180, 16, v166
  v_mfma_f32_16x16x32_bf16 v[60:63], v[128:131], a[116:119], v[60:63]
  v_fmac_f32 v91, s65, v179
  v_and_b32 v181, s3, v166
  v_mfma_f32_16x16x32_bf16 v[56:59], v[132:135], a[122:125], v[56:59]
  v_cvt_pk_bf16_f32 v189, v90, v91
  v_fmac_f32_e64 v92, s65, v180
  v_mfma_f32_16x16x32_bf16 v[60:63], v[132:135], a[120:123], v[60:63]
  buffer_store_dwordx2 v[188:189], v238, s[20:23], s66 offen offset:3072 sc1
  v_mfma_f32_16x16x32_bf16 v[48:51], v[136:139], a[134:137], v[48:51]
  v_fmac_f32 v93, s65, v181
  v_lshlrev_b32 v182, 16, v167
  v_mfma_f32_16x16x32_bf16 v[52:55], v[136:139], a[132:135], v[52:55]
  v_cvt_pk_bf16_f32 v190, v92, v93
  v_and_b32_e64 v183, s3, v167
  v_mfma_f32_16x16x32_bf16 v[56:59], v[136:139], a[130:133], v[56:59]
  v_fmac_f32 v94, s65, v182
  v_fmac_f32 v95, s65, v183
  v_mfma_f32_16x16x32_bf16 v[60:63], v[136:139], a[128:131], v[60:63]
  v_cvt_pk_bf16_f32 v191, v94, v95
  v_mfma_f32_16x16x32_bf16 v[56:59], v[140:143], a[134:137], v[56:59]
  buffer_store_dwordx2 v[190:191], v238, s[20:23], s66 offen offset:3584 sc1
  v_mfma_f32_16x16x32_bf16 v[60:63], v[140:143], a[132:135], v[60:63]
  s_waitcnt lgkmcnt(0)
  v_mfma_f32_16x16x32_bf16 v[32:35], a[48:51], a[64:67], v[32:35]
  s_waitcnt vmcnt(9)
  v_mfma_f32_16x16x32_bf16 v[36:39], a[48:51], a[68:71], v[36:39]
  ds_read_b128 a[16:19], v12 offset:224
  v_mfma_f32_16x16x32_bf16 v[36:39], a[52:55], a[64:67], v[36:39]
  ds_read_b64 a[0:1], v235 offset:24576
  v_mfma_f32_16x16x32_bf16 v[40:43], a[56:59], a[64:67], v[40:43]
  ds_read_b128 a[20:23], v12 offset:736
  v_mfma_f32_16x16x32_bf16 v[40:43], a[52:55], a[68:71], v[40:43]
  ds_read_b64 a[2:3], v235 offset:24584
  v_mfma_f32_16x16x32_bf16 v[40:43], a[48:51], a[72:75], v[40:43]
  ds_read_b128 a[24:27], v12 offset:1248
  v_mfma_f32_16x16x32_bf16 v[44:47], a[48:51], a[76:79], v[44:47]
  ds_read_b64 a[4:5], v235 offset:24672
  v_mfma_f32_16x16x32_bf16 v[44:47], a[52:55], a[72:75], v[44:47]
  ds_read_b128 a[28:31], v12 offset:1760
  v_mfma_f32_16x16x32_bf16 v[44:47], a[56:59], a[68:71], v[44:47]
  ds_read_b64 a[6:7], v235 offset:24680
  v_mfma_f32_16x16x32_bf16 v[44:47], a[60:63], a[64:67], v[44:47]
  ds_read_b128 a[32:35], v12 offset:2272
  v_mfma_f32_16x16x32_bf16 v[48:51], a[60:63], a[68:71], v[48:51]
  ds_read_b64 a[8:9], v235 offset:25344
  v_mfma_f32_16x16x32_bf16 v[48:51], a[56:59], a[72:75], v[48:51]
  ds_read_b128 a[36:39], v12 offset:2784
  v_mfma_f32_16x16x32_bf16 v[48:51], a[52:55], a[76:79], v[48:51]
  ds_read_b64 a[10:11], v235 offset:25352
  v_mfma_f32_16x16x32_bf16 v[48:51], a[48:51], a[80:83], v[48:51]
  ds_read_b128 a[40:43], v12 offset:3296
  v_mfma_f32_16x16x32_bf16 v[52:55], a[48:51], a[84:87], v[52:55]
  ds_read_b64 a[12:13], v235 offset:25440
  v_mfma_f32_16x16x32_bf16 v[52:55], a[52:55], a[80:83], v[52:55]
  ds_read_b128 a[44:47], v12 offset:3808
  v_mfma_f32_16x16x32_bf16 v[52:55], a[56:59], a[76:79], v[52:55]
  s_add_u32 m0, s55, 512
  ds_read_b64 a[14:15], v235 offset:25448
  v_mfma_f32_16x16x32_bf16 v[52:55], a[60:63], a[72:75], v[52:55]
  buffer_load_dwordx4 v233, s[20:23], s58 offen offset:0 sc1 lds
  v_mfma_f32_16x16x32_bf16 v[56:59], a[60:63], a[76:79], v[56:59]
  s_add_u32 s58, s58, 588800
  v_mfma_f32_16x16x32_bf16 v[56:59], a[56:59], a[80:83], v[56:59]
  buffer_load_dwordx4 v233, s[20:23], s58 offen offset:1024 sc1 lds
  v_mfma_f32_16x16x32_bf16 v[56:59], a[52:55], a[84:87], v[56:59]
  s_add_u32 s58, s58, 588800
  v_mfma_f32_16x16x32_bf16 v[56:59], a[48:51], a[88:91], v[56:59]
  buffer_load_dwordx4 v233, s[20:23], s58 offen offset:2048 sc1 lds
  v_mfma_f32_16x16x32_bf16 v[60:63], a[48:51], a[92:95], v[60:63]
  s_add_u32 s58, s58, 588800
  v_mfma_f32_16x16x32_bf16 v[60:63], a[52:55], a[88:91], v[60:63]
  buffer_load_dwordx4 v233, s[20:23], s58 offen offset:3072 sc1 lds
  v_mfma_f32_16x16x32_bf16 v[60:63], a[56:59], a[84:87], v[60:63]
  s_cmp_eq_u32 s29, 5
  v_mfma_f32_16x16x32_bf16 v[60:63], a[60:63], a[80:83], v[60:63]
  s_waitcnt lgkmcnt(0)
  s_cbranch_scc1 L_cv_tail
  v_mfma_f32_16x16x32_bf16 v[32:35], a[0:3], a[16:19], v[32:35]
  v_mfma_f32_16x16x32_bf16 v[36:39], a[0:3], a[20:23], v[36:39]
  ds_read_b128 a[64:67], v12 offset:160
  v_mfma_f32_16x16x32_bf16 v[36:39], a[4:7], a[16:19], v[36:39]
  ds_read_b64 a[48:49], v235 offset:26112
  v_mfma_f32_16x16x32_bf16 v[40:43], a[8:11], a[16:19], v[40:43]
  ds_read_b128 a[68:71], v12 offset:672
  v_mfma_f32_16x16x32_bf16 v[40:43], a[4:7], a[20:23], v[40:43]
  ds_read_b64 a[50:51], v235 offset:26120
  v_mfma_f32_16x16x32_bf16 v[40:43], a[0:3], a[24:27], v[40:43]
  ds_read_b128 a[72:75], v12 offset:1184
  v_mfma_f32_16x16x32_bf16 v[44:47], a[0:3], a[28:31], v[44:47]
  ds_read_b64 a[52:53], v235 offset:26208
  v_mfma_f32_16x16x32_bf16 v[44:47], a[4:7], a[24:27], v[44:47]
  ds_read_b128 a[76:79], v12 offset:1696
  v_mfma_f32_16x16x32_bf16 v[44:47], a[8:11], a[20:23], v[44:47]
  ds_read_b64 a[54:55], v235 offset:26216
  v_mfma_f32_16x16x32_bf16 v[44:47], a[12:15], a[16:19], v[44:47]
  ds_read_b128 a[80:83], v12 offset:2208
  v_mfma_f32_16x16x32_bf16 v[48:51], a[12:15], a[20:23], v[48:51]
  ds_read_b64 a[56:57], v235 offset:26880
  v_mfma_f32_16x16x32_bf16 v[48:51], a[8:11], a[24:27], v[48:51]
  ds_read_b128 a[84:87], v12 offset:2720
  v_mfma_f32_16x16x32_bf16 v[48:51], a[4:7], a[28:31], v[48:51]
  ds_read_b64 a[58:59], v235 offset:26888
  v_mfma_f32_16x16x32_bf16 v[48:51], a[0:3], a[32:35], v[48:51]
  ds_read_b128 a[88:91], v12 offset:3232
  v_mfma_f32_16x16x32_bf16 v[52:55], a[0:3], a[36:39], v[52:55]
  ds_read_b64 a[60:61], v235 offset:26976
  v_mfma_f32_16x16x32_bf16 v[52:55], a[4:7], a[32:35], v[52:55]
  ds_read_b128 a[92:95], v12 offset:3744
  v_mfma_f32_16x16x32_bf16 v[52:55], a[8:11], a[28:31], v[52:55]
  s_add_u32 m0, s52, 12288
  ds_read_b64 a[62:63], v235 offset:26984
  v_mfma_f32_16x16x32_bf16 v[52:55], a[12:15], a[24:27], v[52:55]
  s_add_u32 s34, s57, 256
  v_mfma_f32_16x16x32_bf16 v[56:59], a[12:15], a[28:31], v[56:59]
  buffer_load_dwordx4 v228, s[20:23], s34 offen offset:0 lds
  v_mfma_f32_16x16x32_bf16 v[56:59], a[8:11], a[32:35], v[56:59]
  v_mfma_f32_16x16x32_bf16 v[56:59], a[4:7], a[36:39], v[56:59]
  buffer_load_dwordx4 v229, s[20:23], s34 offen offset:1024 lds
  v_mfma_f32_16x16x32_bf16 v[56:59], a[0:3], a[40:43], v[56:59]
  v_mfma_f32_16x16x32_bf16 v[60:63], a[0:3], a[44:47], v[60:63]
  buffer_load_dwordx4 v230, s[20:23], s34 offen offset:2048 lds
  v_mfma_f32_16x16x32_bf16 v[60:63], a[4:7], a[40:43], v[60:63]
  v_mfma_f32_16x16x32_bf16 v[60:63], a[8:11], a[36:39], v[60:63]
  v_mfma_f32_16x16x32_bf16 v[60:63], a[12:15], a[32:35], v[60:63]
  s_waitcnt lgkmcnt(0)
  v_mfma_f32_16x16x32_bf16 v[32:35], a[48:51], a[64:67], v[32:35]
  s_waitcnt vmcnt(12)
  v_mfma_f32_16x16x32_bf16 v[36:39], a[48:51], a[68:71], v[36:39]
  ds_read_b128 a[16:19], v12 offset:96
  v_mfma_f32_16x16x32_bf16 v[36:39], a[52:55], a[64:67], v[36:39]
  ds_read_b64 a[0:1], v235 offset:36864
  v_mfma_f32_16x16x32_bf16 v[40:43], a[56:59], a[64:67], v[40:43]
  ds_read_b128 a[20:23], v12 offset:608
  v_mfma_f32_16x16x32_bf16 v[40:43], a[52:55], a[68:71], v[40:43]
  ds_read_b64 a[2:3], v235 offset:36872
  v_mfma_f32_16x16x32_bf16 v[40:43], a[48:51], a[72:75], v[40:43]
  ds_read_b128 a[24:27], v12 offset:1120
  v_mfma_f32_16x16x32_bf16 v[44:47], a[48:51], a[76:79], v[44:47]
  ds_read_b64 a[4:5], v235 offset:36960
  v_mfma_f32_16x16x32_bf16 v[44:47], a[52:55], a[72:75], v[44:47]
  ds_read_b128 a[28:31], v12 offset:1632
  v_mfma_f32_16x16x32_bf16 v[44:47], a[56:59], a[68:71], v[44:47]
  ds_read_b64 a[6:7], v235 offset:36968
  v_mfma_f32_16x16x32_bf16 v[44:47], a[60:63], a[64:67], v[44:47]
  ds_read_b128 a[32:35], v12 offset:2144
  v_mfma_f32_16x16x32_bf16 v[48:51], a[60:63], a[68:71], v[48:51]
  ds_read_b64 a[8:9], v235 offset:37632
  v_mfma_f32_16x16x32_bf16 v[48:51], a[56:59], a[72:75], v[48:51]
  ds_read_b128 a[36:39], v12 offset:2656
  v_mfma_f32_16x16x32_bf16 v[48:51], a[52:55], a[76:79], v[48:51]
  ds_read_b64 a[10:11], v235 offset:37640
  v_mfma_f32_16x16x32_bf16 v[48:51], a[48:51], a[80:83], v[48:51]
  ds_read_b128 a[40:43], v12 offset:3168
  v_mfma_f32_16x16x32_bf16 v[52:55], a[48:51], a[84:87], v[52:55]
  ds_read_b64 a[12:13], v235 offset:37728
  v_mfma_f32_16x16x32_bf16 v[52:55], a[52:55], a[80:83], v[52:55]
  ds_read_b128 a[44:47], v12 offset:3680
  v_mfma_f32_16x16x32_bf16 v[52:55], a[56:59], a[76:79], v[52:55]
  s_add_u32 m0, s52, 24576
  ds_read_b64 a[14:15], v235 offset:37736
  v_mfma_f32_16x16x32_bf16 v[52:55], a[60:63], a[72:75], v[52:55]
  s_add_u32 s34, s57, 128
  v_add_u32 v13, s35, v237
  v_mfma_f32_16x16x32_bf16 v[56:59], a[60:63], a[76:79], v[56:59]
  buffer_load_dwordx4 v228, s[20:23], s34 offen offset:0 lds
  v_mfma_f32_16x16x32_bf16 v[56:59], a[56:59], a[80:83], v[56:59]
  v_mfma_f32_16x16x32_bf16 v[56:59], a[52:55], a[84:87], v[56:59]
  buffer_load_dwordx4 v229, s[20:23], s34 offen offset:1024 lds
  v_mfma_f32_16x16x32_bf16 v[56:59], a[48:51], a[88:91], v[56:59]
  v_mfma_f32_16x16x32_bf16 v[60:63], a[48:51], a[92:95], v[60:63]
  buffer_load_dwordx4 v230, s[20:23], s34 offen offset:2048 lds
  v_mfma_f32_16x16x32_bf16 v[60:63], a[52:55], a[88:91], v[60:63]
  v_mfma_f32_16x16x32_bf16 v[60:63], a[56:59], a[84:87], v[60:63]
  buffer_load_dword v218, v220, s[84:87], s45 offen
  v_mfma_f32_16x16x32_bf16 v[60:63], a[60:63], a[80:83], v[60:63]
  s_waitcnt lgkmcnt(0)
  v_mfma_f32_16x16x32_bf16 v[32:35], a[0:3], a[16:19], v[32:35]
  v_mfma_f32_16x16x32_bf16 v[36:39], a[0:3], a[20:23], v[36:39]
  s_mov_b32 s33, s56
  ds_read_b128 a[64:67], v12 offset:32
  v_mfma_f32_16x16x32_bf16 v[36:39], a[4:7], a[16:19], v[36:39]
  s_mov_b32 s56, s54
  ds_read_b64 a[48:49], v235 offset:38400
  v_mfma_f32_16x16x32_bf16 v[40:43], a[8:11], a[16:19], v[40:43]
  s_mov_b32 s54, s55
  ds_read_b128 a[68:71], v12 offset:544
  v_mfma_f32_16x16x32_bf16 v[40:43], a[4:7], a[20:23], v[40:43]
  s_mov_b32 s55, s33
  ds_read_b64 a[50:51], v235 offset:38408
  v_mfma_f32_16x16x32_bf16 v[40:43], a[0:3], a[24:27], v[40:43]
  s_mov_b32 s65, s60
  ds_read_b128 a[72:75], v12 offset:1056
  v_mfma_f32_16x16x32_bf16 v[44:47], a[0:3], a[28:31], v[44:47]
  s_mov_b32 s60, s61
  ds_read_b64 a[52:53], v235 offset:38496
  v_mfma_f32_16x16x32_bf16 v[44:47], a[4:7], a[24:27], v[44:47]
  s_mov_b32 s61, s62
  ds_read_b128 a[76:79], v12 offset:1568
  v_mfma_f32_16x16x32_bf16 v[44:47], a[8:11], a[20:23], v[44:47]
  s_mov_b32 s62, s63
  ds_read_b64 a[54:55], v235 offset:38504
  v_mfma_f32_16x16x32_bf16 v[44:47], a[12:15], a[16:19], v[44:47]
  s_mov_b32 s63, s64
  ds_read_b128 a[80:83], v12 offset:2080
  v_mfma_f32_16x16x32_bf16 v[48:51], a[12:15], a[20:23], v[48:51]
  s_mov_b32 s66, s67
  ds_read_b64 a[56:57], v235 offset:39168
  v_mfma_f32_16x16x32_bf16 v[48:51], a[8:11], a[24:27], v[48:51]
  ds_read_b128 a[84:87], v12 offset:2592
  v_mfma_f32_16x16x32_bf16 v[48:51], a[4:7], a[28:31], v[48:51]
  ds_read_b64 a[58:59], v235 offset:39176
  v_mfma_f32_16x16x32_bf16 v[48:51], a[0:3], a[32:35], v[48:51]
  ds_read_b128 a[88:91], v12 offset:3104
  v_mfma_f32_16x16x32_bf16 v[52:55], a[0:3], a[36:39], v[52:55]
  ds_read_b64 a[60:61], v235 offset:39264
  v_mfma_f32_16x16x32_bf16 v[52:55], a[4:7], a[32:35], v[52:55]
  ds_read_b128 a[92:95], v12 offset:3616
  v_mfma_f32_16x16x32_bf16 v[52:55], a[8:11], a[28:31], v[52:55]
  ds_read_b64 a[62:63], v235 offset:39272
  v_mfma_f32_16x16x32_bf16 v[52:55], a[12:15], a[24:27], v[52:55]
  v_mfma_f32_16x16x32_bf16 v[56:59], a[12:15], a[28:31], v[56:59]
  v_mfma_f32_16x16x32_bf16 v[56:59], a[8:11], a[32:35], v[56:59]
  v_mfma_f32_16x16x32_bf16 v[56:59], a[4:7], a[36:39], v[56:59]
  v_mfma_f32_16x16x32_bf16 v[56:59], a[0:3], a[40:43], v[56:59]
  v_mfma_f32_16x16x32_bf16 v[60:63], a[0:3], a[44:47], v[60:63]
  v_mfma_f32_16x16x32_bf16 v[60:63], a[4:7], a[40:43], v[60:63]
  v_mfma_f32_16x16x32_bf16 v[60:63], a[8:11], a[36:39], v[60:63]
  v_mfma_f32_16x16x32_bf16 v[60:63], a[12:15], a[32:35], v[60:63]
  s_waitcnt lgkmcnt(0)
  v_mfma_f32_16x16x32_bf16 v[64:67], a[48:51], a[64:67], v[32:35]
  s_waitcnt vmcnt(7)
  v_mfma_f32_16x16x32_bf16 v[36:39], a[48:51], a[68:71], v[36:39]
  ds_read_b128 a[16:19], v13 offset:480
  v_mfma_f32_16x16x32_bf16 v[68:71], a[52:55], a[64:67], v[36:39]
  s_add_u32 s45, s45, 73728
  ds_read_b64 a[0:1], v235 offset:0
  v_mfma_f32_16x16x32_bf16 v[40:43], a[56:59], a[64:67], v[40:43]
  s_cmp_ge_u32 s29, 1
  ds_read_b128 a[20:23], v13 offset:992
  v_mfma_f32_16x16x32_bf16 v[40:43], a[52:55], a[68:71], v[40:43]
  s_cselect_b32 s86, 0, s86
  ds_read_b64 a[2:3], v235 offset:8
  v_mfma_f32_16x16x32_bf16 v[72:75], a[48:51], a[72:75], v[40:43]
  ds_read_b128 a[24:27], v13 offset:1504
  v_mfma_f32_16x16x32_bf16 v[44:47], a[48:51], a[76:79], v[44:47]
  ds_read_b64 a[4:5], v235 offset:96
  v_mfma_f32_16x16x32_bf16 v[44:47], a[52:55], a[72:75], v[44:47]
  ds_read_b128 a[28:31], v13 offset:2016
  v_mfma_f32_16x16x32_bf16 v[44:47], a[56:59], a[68:71], v[44:47]
  ds_read_b64 a[6:7], v235 offset:104
  v_mfma_f32_16x16x32_bf16 v[76:79], a[60:63], a[64:67], v[44:47]
  ds_read_b128 a[32:35], v13 offset:2528
  v_mfma_f32_16x16x32_bf16 v[48:51], a[60:63], a[68:71], v[48:51]
  ds_read_b64 a[8:9], v235 offset:768
  v_mfma_f32_16x16x32_bf16 v[48:51], a[56:59], a[72:75], v[48:51]
  ds_read_b128 a[36:39], v13 offset:3040
  v_mfma_f32_16x16x32_bf16 v[48:51], a[52:55], a[76:79], v[48:51]
  ds_read_b64 a[10:11], v235 offset:776
  v_mfma_f32_16x16x32_bf16 v[80:83], a[48:51], a[80:83], v[48:51]
  ds_read_b128 a[40:43], v13 offset:3552
  v_mfma_f32_16x16x32_bf16 v[52:55], a[48:51], a[84:87], v[52:55]
  ds_read_b64 a[12:13], v235 offset:864
  v_mfma_f32_16x16x32_bf16 v[52:55], a[52:55], a[80:83], v[52:55]
  ds_read_b128 a[44:47], v13 offset:4064
  v_mfma_f32_16x16x32_bf16 v[52:55], a[56:59], a[76:79], v[52:55]
  s_add_u32 m0, s52, 36864
  ds_read_b64 a[14:15], v235 offset:872
  v_mfma_f32_16x16x32_bf16 v[84:87], a[60:63], a[72:75], v[52:55]
  s_add_u32 s34, s57, 0
  v_mfma_f32_16x16x32_bf16 v[56:59], a[60:63], a[76:79], v[56:59]
  buffer_load_dwordx4 v228, s[20:23], s34 offen offset:0 lds
  v_mfma_f32_16x16x32_bf16 v[56:59], a[56:59], a[80:83], v[56:59]
  v_mfma_f32_16x16x32_bf16 v[56:59], a[52:55], a[84:87], v[56:59]
  buffer_load_dwordx4 v229, s[20:23], s34 offen offset:1024 lds
  v_mfma_f32_16x16x32_bf16 v[88:91], a[48:51], a[88:91], v[56:59]
  v_mfma_f32_16x16x32_bf16 v[60:63], a[48:51], a[92:95], v[60:63]
  buffer_load_dwordx4 v230, s[20:23], s34 offen offset:2048 lds
  v_mfma_f32_16x16x32_bf16 v[60:63], a[52:55], a[88:91], v[60:63]
  v_mfma_f32_16x16x32_bf16 v[60:63], a[56:59], a[84:87], v[60:63]
  v_mfma_f32_16x16x32_bf16 v[92:95], a[60:63], a[80:83], v[60:63]
  s_waitcnt lgkmcnt(0)
  s_branch L_cv_loop
L_cv_tail:
  s_lshl_b32 s33, s24, 13
  s_add_u32 s33, s33, 112640
  v_add_u32 v4, s33, v234
  s_xor_b32 s33, s24, 1
  s_lshl_b32 s33, s33, 13
  s_add_u32 s33, s33, 112640
  v_add_u32 v5, s33, v234
  s_lshl_b32 s34, s39, 11
  s_add_u32 s67, s67, s34
  s_add_u32 s34, s34, s54
  v_add_u32 v14, s34, v238
  v_add_u32 v15, s34, v234
  s_cmp_eq_u32 s39, 0
  s_cbranch_scc1 L_cv_even
  ds_write_b128 v4, v[32:35] offset:0
  ds_write_b128 v4, v[36:39] offset:1024
  ds_write_b128 v4, v[40:43] offset:2048
  ds_write_b128 v4, v[44:47] offset:3072
  v_pk_mul_f32 v[32:33], v[48:49], 1.0 op_sel_hi:[1,0]
  v_pk_mul_f32 v[34:35], v[50:51], 1.0 op_sel_hi:[1,0]
  v_pk_mul_f32 v[36:37], v[52:53], 1.0 op_sel_hi:[1,0]
  v_pk_mul_f32 v[38:39], v[54:55], 1.0 op_sel_hi:[1,0]
  v_pk_mul_f32 v[40:41], v[56:57], 1.0 op_sel_hi:[1,0]
  v_pk_mul_f32 v[42:43], v[58:59], 1.0 op_sel_hi:[1,0]
  v_pk_mul_f32 v[44:45], v[60:61], 1.0 op_sel_hi:[1,0]
  v_pk_mul_f32 v[46:47], v[62:63], 1.0 op_sel_hi:[1,0]
  s_branch L_cv_join
L_cv_even:
  s_nop 0
  ds_write_b128 v4, v[48:51] offset:0
  ds_write_b128 v4, v[52:55] offset:1024
  ds_write_b128 v4, v[56:59] offset:2048
  ds_write_b128 v4, v[60:63] offset:3072
L_cv_join:
  ds_read_b64 v[152:153], v14 offset:512
  ds_read_b64 v[154:155], v14 offset:1024
  ds_read_b64 v[156:157], v14 offset:1536
  ds_read_b64 v[158:159], v14 offset:2048
  s_waitcnt lgkmcnt(0)
  s_barrier
  ds_read_b128 v[48:51], v5 offset:0
  ds_read_b128 v[52:55], v5 offset:1024
  ds_read_b128 v[56:59], v5 offset:2048
  ds_read_b128 v[60:63], v5 offset:3072
  s_waitcnt lgkmcnt(0)
  s_nop 0
  v_pk_add_f32 v[32:33], v[32:33], v[48:49]
  v_pk_add_f32 v[34:35], v[34:35], v[50:51]
  v_pk_add_f32 v[36:37], v[36:37], v[52:53]
  v_pk_add_f32 v[38:39], v[38:39], v[54:55]
  v_pk_add_f32 v[40:41], v[40:41], v[56:57]
  v_pk_add_f32 v[42:43], v[42:43], v[58:59]
  v_pk_add_f32 v[44:45], v[44:45], v[60:61]
  v_pk_add_f32 v[46:47], v[46:47], v[62:63]
  v_lshlrev_b32 v168, 16, v152
  v_lshlrev_b32 v170, 16, v153
  v_and_b32 v169, s3, v152
  v_and_b32 v171, s3, v153
  v_fmac_f32 v32, s60, v168
  v_fmac_f32 v34, s60, v170
  v_fmac_f32 v33, s60, v169
  v_fmac_f32 v35, s60, v171
  v_cvt_pk_bf16_f32 v184, v32, v33
  v_cvt_pk_bf16_f32 v185, v34, v35
  buffer_store_dwordx2 v[184:185], v238, s[20:23], s67 offen offset:0 sc1
  v_lshlrev_b32 v172, 16, v154
  v_lshlrev_b32 v174, 16, v155
  v_and_b32 v173, s3, v154
  v_and_b32 v175, s3, v155
  v_fmac_f32 v36, s60, v172
  v_fmac_f32 v38, s60, v174
  v_fmac_f32 v37, s60, v173
  v_fmac_f32 v39, s60, v175
  v_cvt_pk_bf16_f32 v186, v36, v37
  v_cvt_pk_bf16_f32 v187, v38, v39
  buffer_store_dwordx2 v[186:187], v238, s[20:23], s67 offen offset:512 sc1
  v_lshlrev_b32 v176, 16, v156
  v_lshlrev_b32 v178, 16, v157
  v_and_b32 v177, s3, v156
  v_and_b32 v179, s3, v157
  v_fmac_f32 v40, s60, v176
  v_fmac_f32 v42, s60, v178
  v_fmac_f32 v41, s60, v177
  v_fmac_f32 v43, s60, v179
  v_cvt_pk_bf16_f32 v188, v40, v41
  v_cvt_pk_bf16_f32 v189, v42, v43
  buffer_store_dwordx2 v[188:189], v238, s[20:23], s67 offen offset:1024 sc1
  v_lshlrev_b32 v180, 16, v158
  v_lshlrev_b32 v182, 16, v159
  v_and_b32 v181, s3, v158
  v_and_b32 v183, s3, v159
  v_fmac_f32 v44, s60, v180
  v_fmac_f32 v46, s60, v182
  v_fmac_f32 v45, s60, v181
  v_fmac_f32 v47, s60, v183
  v_cvt_pk_bf16_f32 v190, v44, v45
  v_cvt_pk_bf16_f32 v191, v46, v47
  buffer_store_dwordx2 v[190:191], v238, s[20:23], s67 offen offset:1536 sc1
  s_waitcnt vmcnt(0)
  s_barrier
  buffer_store_dword v217, v216, s[20:23], s36 offen sc1
  s_endpgm
L_v_sp0:
  s_mov_b32 s100, 200000
L_v_sp0_l:
  s_sleep 32
  global_load_dword v5, v4, s[68:69] sc1
  s_waitcnt vmcnt(0)
  v_cmp_gt_u32 vcc, 4, v5
  s_sub_u32 s100, s100, 1
  s_cbranch_scc1 L_v_bk0
  s_cbranch_vccz L_v_bk0
  s_branch L_v_sp0_l
L_v_sp1:
  s_mov_b32 s100, 200000
L_v_sp1_l:
  s_sleep 16
  buffer_load_dwordx3 v[6:8], v9, s[20:23], s31 offen sc1
  s_waitcnt vmcnt(0)
  v_min3_u32 v6, v6, v7, v8
  v_cmp_gt_u32 vcc, 1, v6
  s_sub_u32 s100, s100, 1
  s_cbranch_scc1 L_v_bk1
  s_cbranch_vccz L_v_bk1
  s_branch L_v_sp1_l
L_end:
  s_endpgm
.p2align 6
.type korder_tab,@object
korder_tab:
.byte 0,1,2,3,10,11,12,13,20,21,22,23,4,5,14,15,24,25,30,31,6,7,8,9,16,17,18,19,26,27,28,29,32,33,34,35,0,0,0,0,0,0,0,0,0,0,0,0,0,0,0,0,0,0,0,0,0,0,0,0,0,0,0,0
.byte 1,2,3,10,11,12,13,20,21,22,23,0,5,14,15,24,25,30,31,4,7,8,9,6,17,18,19,26,27,28,29,16,33,34,35,32,0,0,0,0,0,0,0,0,0,0,0,0,0,0,0,0,0,0,0,0,0,0,0,0,0,0,0,0
.byte 2,3,10,11,12,13,20,21,22,23,0,1,14,15,24,25,30,31,4,5,8,9,6,7,18,19,26,27,28,29,16,17,34,35,32,33,0,0,0,0,0,0,0,0,0,0,0,0,0,0,0,0,0,0,0,0,0,0,0,0,0,0,0,0
.byte 3,10,11,12,13,20,21,22,23,0,1,2,15,24,25,30,31,4,5,14,9,6,7,8,19,26,27,28,29,16,17,18,35,32,33,34,0,0,0,0,0,0,0,0,0,0,0,0,0,0,0,0,0,0,0,0,0,0,0,0,0,0,0,0
.byte 10,11,12,13,20,21,22,23,0,1,2,3,24,25,30,31,4,5,14,15,6,7,8,9,26,27,28,29,16,17,18,19,32,33,34,35,0,0,0,0,0,0,0,0,0,0,0,0,0,0,0,0,0,0,0,0,0,0,0,0,0,0,0,0
.byte 11,12,13,20,21,22,23,0,1,2,3,10,25,30,31,4,5,14,15,24,7,8,9,6,27,28,29,16,17,18,19,26,33,34,35,32,0,0,0,0,0,0,0,0,0,0,0,0,0,0,0,0,0,0,0,0,0,0,0,0,0,0,0,0
.byte 12,13,20,21,22,23,0,1,2,3,10,11,30,31,4,5,14,15,24,25,8,9,6,7,28,29,16,17,18,19,26,27,34,35,32,33,0,0,0,0,0,0,0,0,0,0,0,0,0,0,0,0,0,0,0,0,0,0,0,0,0,0,0,0
.byte 13,20,21,22,23,0,1,2,3,10,11,12,31,4,5,14,15,24,25,30,9,6,7,8,29,16,17,18,19,26,27,28,35,32,33,34,0,0,0,0,0,0,0,0,0,0,0,0,0,0,0,0,0,0,0,0,0,0,0,0,0,0,0,0
.byte 10,11,12,13,20,21,22,23,0,1,2,3,14,15,24,25,30,31,4,5,18,19,16,17,8,9,26,27,28,29,6,7,34,35,32,33,0,0,0,0,0,0,0,0,0,0,0,0,0,0,0,0,0,0,0,0,0,0,0,0,0,0,0,0
.byte 11,12,13,20,21,22,23,0,1,2,3,10,15,24,25,30,31,4,5,14,19,16,17,18,9,26,27,28,29,6,7,8,35,32,33,34,0,0,0,0,0,0,0,0,0,0,0,0,0,0,0,0,0,0,0,0,0,0,0,0,0,0,0,0
.byte 12,13,20,21,22,23,0,1,2,3,10,11,24,25,30,31,4,5,14,15,16,17,18,19,26,27,28,29,6,7,8,9,32,33,34,35,0,0,0,0,0,0,0,0,0,0,0,0,0,0,0,0,0,0,0,0,0,0,0,0,0,0,0,0
.byte 13,20,21,22,23,0,1,2,3,10,11,12,25,30,31,4,5,14,15,24,17,18,19,16,27,28,29,6,7,8,9,26,33,34,35,32,0,0,0,0,0,0,0,0,0,0,0,0,0,0,0,0,0,0,0,0,0,0,0,0,0,0,0,0
.byte 20,21,22,23,0,1,2,3,10,11,12,13,30,31,4,5,14,15,24,25,18,19,16,17,28,29,6,7,8,9,26,27,34,35,32,33,0,0,0,0,0,0,0,0,0,0,0,0,0,0,0,0,0,0,0,0,0,0,0,0,0,0,0,0
.byte 21,22,23,0,1,2,3,10,11,12,13,20,31,4,5,14,15,24,25,30,19,16,17,18,29,6,7,8,9,26,27,28,35,32,33,34,0,0,0,0,0,0,0,0,0,0,0,0,0,0,0,0,0,0,0,0,0,0,0,0,0,0,0,0
.byte 22,23,0,1,2,3,10,11,12,13,20,21,4,5,14,15,24,25,30,31,16,17,18,19,6,7,8,9,26,27,28,29,32,33,34,35,0,0,0,0,0,0,0,0,0,0,0,0,0,0,0,0,0,0,0,0,0,0,0,0,0,0,0,0
.byte 23,0,1,2,3,10,11,12,13,20,21,22,5,14,15,24,25,30,31,4,17,18,19,16,7,8,9,26,27,28,29,6,33,34,35,32,0,0,0,0,0,0,0,0,0,0,0,0,0,0,0,0,0,0,0,0,0,0,0,0,0,0,0,0
.byte 20,21,22,23,0,1,2,3,10,11,12,13,24,25,30,31,4,5,14,15,26,27,28,29,16,17,18,19,6,7,8,9,32,33,34,35,0,0,0,0,0,0,0,0,0,0,0,0,0,0,0,0,0,0,0,0,0,0,0,0,0,0,0,0
.byte 21,22,23,0,1,2,3,10,11,12,13,20,25,30,31,4,5,14,15,24,27,28,29,26,17,18,19,6,7,8,9,16,33,34,35,32,0,0,0,0,0,0,0,0,0,0,0,0,0,0,0,0,0,0,0,0,0,0,0,0,0,0,0,0
.byte 22,23,0,1,2,3,10,11,12,13,20,21,30,31,4,5,14,15,24,25,28,29,26,27,18,19,6,7,8,9,16,17,34,35,32,33,0,0,0,0,0,0,0,0,0,0,0,0,0,0,0,0,0,0,0,0,0,0,0,0,0,0,0,0
.byte 23,0,1,2,3,10,11,12,13,20,21,22,31,4,5,14,15,24,25,30,29,26,27,28,19,6,7,8,9,16,17,18,35,32,33,34,0,0,0,0,0,0,0,0,0,0,0,0,0,0,0,0,0,0,0,0,0,0,0,0,0,0,0,0
.byte 0,1,2,3,10,11,12,13,20,21,22,23,4,5,14,15,24,25,30,31,26,27,28,29,6,7,8,9,16,17,18,19,32,33,34,35,0,0,0,0,0,0,0,0,0,0,0,0,0,0,0,0,0,0,0,0,0,0,0,0,0,0,0,0
.byte 1,2,3,10,11,12,13,20,21,22,23,0,5,14,15,24,25,30,31,4,27,28,29,26,7,8,9,16,17,18,19,6,33,34,35,32,0,0,0,0,0,0,0,0,0,0,0,0,0,0,0,0,0,0,0,0,0,0,0,0,0,0,0,0
.byte 2,3,10,11,12,13,20,21,22,23,0,1,14,15,24,25,30,31,4,5,28,29,26,27,8,9,16,17,18,19,6,7,34,35,32,33,0,0,0,0,0,0,0,0,0,0,0,0,0,0,0,0,0,0,0,0,0,0,0,0,0,0,0,0
.byte 3,10,11,12,13,20,21,22,23,0,1,2,15,24,25,30,31,4,5,14,29,26,27,28,9,16,17,18,19,6,7,8,35,32,33,34,0,0,0,0,0,0,0,0,0,0,0,0,0,0,0,0,0,0,0,0,0,0,0,0,0,0,0,0
.byte 0,0,0,0,0,0,0,0,0,0,0,0,0,0,0,0,0,0,0,0,0,0,0,0,0,0,0,0,0,0,0,0,0,0,0,0,0,0,0,0,0,0,0,0,0,0,0,0,0,0,0,0,0,0,0,0,0,0,0,0,0,0,0,0
.byte 0,0,0,0,0,0,0,0,0,0,0,0,0,0,0,0,0,0,0,0,0,0,0,0,0,0,0,0,0,0,0,0,0,0,0,0,0,0,0,0,0,0,0,0,0,0,0,0,0,0,0,0,0,0,0,0,0,0,0,0,0,0,0,0
.byte 0,0,0,0,0,0,0,0,0,0,0,0,0,0,0,0,0,0,0,0,0,0,0,0,0,0,0,0,0,0,0,0,0,0,0,0,0,0,0,0,0,0,0,0,0,0,0,0,0,0,0,0,0,0,0,0,0,0,0,0,0,0,0,0
.byte 0,0,0,0,0,0,0,0,0,0,0,0,0,0,0,0,0,0,0,0,0,0,0,0,0,0,0,0,0,0,0,0,0,0,0,0,0,0,0,0,0,0,0,0,0,0,0,0,0,0,0,0,0,0,0,0,0,0,0,0,0,0,0,0
.byte 0,0,0,0,0,0,0,0,0,0,0,0,0,0,0,0,0,0,0,0,0,0,0,0,0,0,0,0,0,0,0,0,0,0,0,0,0,0,0,0,0,0,0,0,0,0,0,0,0,0,0,0,0,0,0,0,0,0,0,0,0,0,0,0
.byte 0,0,0,0,0,0,0,0,0,0,0,0,0,0,0,0,0,0,0,0,0,0,0,0,0,0,0,0,0,0,0,0,0,0,0,0,0,0,0,0,0,0,0,0,0,0,0,0,0,0,0,0,0,0,0,0,0,0,0,0,0,0,0,0
.byte 0,0,0,0,0,0,0,0,0,0,0,0,0,0,0,0,0,0,0,0,0,0,0,0,0,0,0,0,0,0,0,0,0,0,0,0,0,0,0,0,0,0,0,0,0,0,0,0,0,0,0,0,0,0,0,0,0,0,0,0,0,0,0,0
.byte 0,0,0,0,0,0,0,0,0,0,0,0,0,0,0,0,0,0,0,0,0,0,0,0,0,0,0,0,0,0,0,0,0,0,0,0,0,0,0,0,0,0,0,0,0,0,0,0,0,0,0,0,0,0,0,0,0,0,0,0,0,0,0,0
.size korder_tab, 2048
code_end:
.p2align 7
.type vlane_tab,@object
vlane_tab:
.long 0xe80,0xf44,0x464,0x1900,0xe90,0xf54,0x474,0x1910,0xea0,0xd04,0x484,0x1920,0xeb0,0xd14,0x494,0x1930
.long 0xec0,0xd24,0xec8,0x1940,0xed0,0xd34,0xed8,0x1950,0xc80,0xd44,0xee8,0x1960,0xc90,0xd54,0xef8,0x1970
.long 0xca0,0x684,0xf08,0x1980,0xcb0,0x694,0xf18,0x1990,0xcc0,0x6a4,0xcc8,0x1a80,0xcd0,0x6b4,0xcd8,0x1a90
.long 0x1704,0x6c4,0xce8,0x1aa0,0x1714,0x6d4,0xcf8,0x1ab0,0x1724,0x484,0xd08,0x1ac0,0x1734,0x494,0xd18,0x1ad0
.long 0x1744,0x4a4,0x240,0x1ae0,0x1754,0x4b4,0x250,0x1af0,0x1504,0x4c4,0x260,0x1b00,0x1514,0x4d4,0x270,0x1b10
.long 0x1524,0xf08,0x280,0x19c4,0x1534,0xf18,0x290,0x19d4,0x1544,0xf28,0x40,0x19e4,0x1554,0xf38,0x50,0x19f4
.long 0xe84,0xf48,0x60,0x1a04,0xe94,0xf58,0x70,0x1a14,0xea4,0xd08,0x80,0x1a24,0xeb4,0xd18,0x90,0x1a34
.long 0xec4,0xd28,0xac4,0x1a44,0xed4,0xd38,0xad4,0x1a54,0xc84,0xd48,0xae4,0x1b44,0xc94,0xd58,0xaf4,0x1b54
.long 0xca4,0xa40,0xb04,0x1b64,0xcb4,0xa50,0xb14,0x1b74,0xcc4,0xa60,0x8c4,0x1b84,0xcd4,0xa70,0x8d4,0x1b94
.long 0x1708,0xa80,0x8e4,0x1ba4,0x1718,0xa90,0x8f4,0x1bb4,0x1728,0x840,0x904,0x1bc4,0x1738,0x850,0x914,0x1bd4
.long 0x1748,0x860,0x244,0x1904,0x1758,0x870,0x254,0x1914,0x1508,0x880,0x264,0x1924,0x1518,0x890,0x274,0x1934
.long 0x1528,0x12c4,0x284,0x1944,0x1538,0x12d4,0x294,0x1954,0x1548,0x12e4,0x44,0x1964,0x1558,0x12f4,0x54,0x1974
.long 0xa80,0x1304,0x64,0x1984,0xa90,0x1314,0x74,0x1994,0xaa0,0x10c4,0x84,0x1a84,0xab0,0x10d4,0x94,0x1a94
.long 0xac0,0x10e4,0xac8,0x1aa4,0xad0,0x10f4,0xad8,0x1ab4,0x880,0x1104,0xae8,0x1ac4,0x890,0x1114,0xaf8,0x1ad4
.long 0x8a0,0xa44,0xb08,0x1ae4,0x8b0,0xa54,0xb18,0x1af4,0x8c0,0xa64,0x8c8,0x1b04,0x8d0,0xa74,0x8d8,0x1b14
.long 0x1304,0xa84,0x8e8,0x19c8,0x1314,0xa94,0x8f8,0x19d8,0x1324,0x844,0x908,0x19e8,0x1334,0x854,0x918,0x19f8
.long 0x1608,0x0,0x0,0x258,0x1618,0x10,0x10,0x198,0x1628,0x20,0x20,0xd8,0x1638,0x30,0x30,0x18
.long 0x1648,0x40,0x40,0x250,0x1658,0x50,0x50,0x190,0x1748,0x60,0x60,0xd0,0x1758,0x70,0x70,0x10
.long 0x1768,0x80,0x80,0x248,0x1778,0x90,0x90,0x188,0x1788,0xa0,0xa0,0xc8,0x1798,0xb0,0xb0,0x8
.long 0x17a8,0xc0,0xc0,0x240,0x17b8,0xd0,0xd0,0x180,0x17c8,0xe0,0xe0,0xc0,0x17d8,0xf0,0xf0,0x0
.long 0x400,0x24000,0x100,0x268,0x410,0x24010,0x110,0x1a8,0x420,0x24020,0x120,0xe8,0x430,0x24030,0x130,0x28
.long 0x440,0x24040,0x140,0x260,0x450,0x24050,0x150,0x1a0,0x450,0x24060,0x160,0xe0,0x450,0x24070,0x170,0x20
.long 0x450,0x24080,0x180,0x258,0x450,0x24090,0x190,0x198,0x450,0x240a0,0x1a0,0xd8,0x450,0x240b0,0x1b0,0x18
.long 0xc84,0x240c0,0x1c0,0x250,0xc94,0x240d0,0x1d0,0x190,0xca4,0x240e0,0x1e0,0xd0,0xcb4,0x240f0,0x1f0,0x10
.long 0xcc4,0x48000,0x200,0x278,0xcd4,0x48010,0x210,0x1b8,0xcd4,0x48020,0x220,0xf8,0xcd4,0x48030,0x230,0x38
.long 0xcd4,0x48040,0x240,0x270,0xcd4,0x48050,0x250,0x1b0,0xcd4,0x48060,0x260,0xf0,0xcd4,0x48070,0x270,0x30
.long 0x404,0x48080,0x280,0x268,0x414,0x48090,0x290,0x1a8,0x424,0x480a0,0x2a0,0xe8,0x434,0x480b0,0x2b0,0x28
.long 0x444,0x480c0,0x2c0,0x260,0x454,0x480d0,0x2d0,0x1a0,0x454,0x480e0,0x2e0,0xe0,0x454,0x480f0,0x2f0,0x20
.long 0x454,0x6c000,0x300,0x288,0x454,0x6c010,0x310,0x1c8,0x454,0x6c020,0x320,0x108,0x454,0x6c030,0x330,0x48
.long 0xc88,0x6c040,0x340,0x280,0xc98,0x6c050,0x350,0x1c0,0xca8,0x6c060,0x360,0x100,0xcb8,0x6c070,0x370,0x40
.long 0xcc8,0x6c080,0x380,0x278,0xcd8,0x6c090,0x390,0x1b8,0xcd8,0x6c0a0,0x3a0,0xf8,0xcd8,0x6c0b0,0x3b0,0x38
.long 0xcd8,0x6c0c0,0x3c0,0x270,0xcd8,0x6c0d0,0x3d0,0x1b0,0xcd8,0x6c0e0,0x3e0,0xf0,0xcd8,0x6c0f0,0x3f0,0x30
.long 0x3d8,0x0,0x0,0x758,0x298,0x20,0x20,0x698,0x158,0x40,0x40,0x5d8,0x18,0x60,0x60,0x518
.long 0x3d0,0x80,0x80,0x750,0x290,0xa0,0xa0,0x690,0x150,0xc0,0xc0,0x5d0,0x10,0xe0,0xe0,0x510
.long 0x3c8,0x100,0x100,0x748,0x288,0x120,0x120,0x688,0x148,0x140,0x140,0x5c8,0x8,0x160,0x160,0x508
.long 0x3c0,0x180,0x180,0x740,0x280,0x1a0,0x1a0,0x680,0x140,0x1c0,0x1c0,0x5c0,0x0,0x1e0,0x1e0,0x500
.long 0x3e0,0x10,0x8,0x768,0x2a0,0x30,0x28,0x6a8,0x160,0x50,0x48,0x5e8,0x20,0x70,0x68,0x528
.long 0x3d8,0x90,0x88,0x760,0x298,0xb0,0xa8,0x6a0,0x158,0xd0,0xc8,0x5e0,0x18,0xf0,0xe8,0x520
.long 0x3d0,0x110,0x108,0x758,0x290,0x130,0x128,0x698,0x150,0x150,0x148,0x5d8,0x10,0x170,0x168,0x518
.long 0x3c8,0x190,0x188,0x750,0x288,0x1b0,0x1a8,0x690,0x148,0x1d0,0x1c8,0x5d0,0x8,0x1f0,0x1e8,0x510
.long 0x3e8,0x20,0x10,0x778,0x2a8,0x40,0x30,0x6b8,0x168,0x60,0x50,0x5f8,0x28,0x80,0x70,0x538
.long 0x3e0,0xa0,0x90,0x770,0x2a0,0xc0,0xb0,0x6b0,0x160,0xe0,0xd0,0x5f0,0x20,0x100,0xf0,0x530
.long 0x3d8,0x120,0x110,0x768,0x298,0x140,0x130,0x6a8,0x158,0x160,0x150,0x5e8,0x18,0x180,0x170,0x528
.long 0x3d0,0x1a0,0x190,0x760,0x290,0x1c0,0x1b0,0x6a0,0x150,0x1e0,0x1d0,0x5e0,0x10,0x200,0x1f0,0x520
.long 0x3f0,0x30,0x18,0x788,0x2b0,0x50,0x38,0x6c8,0x170,0x70,0x58,0x608,0x30,0x90,0x78,0x548
.long 0x3e8,0xb0,0x98,0x780,0x2a8,0xd0,0xb8,0x6c0,0x168,0xf0,0xd8,0x600,0x28,0x110,0xf8,0x540
.long 0x3e0,0x130,0x118,0x778,0x2a0,0x150,0x138,0x6b8,0x160,0x170,0x158,0x5f8,0x20,0x190,0x178,0x538
.long 0x3d8,0x1b0,0x198,0x770,0x298,0x1d0,0x1b8,0x6b0,0x158,0x1f0,0x1d8,0x5f0,0x18,0x210,0x1f8,0x530
.long 0x0,0x0,0x3f800000,0x3f803f80,0x0,0x0,0x0,0x3f803f80,0x0,0x0,0x0,0x3f800000,0x0,0x0,0x0,0x0
.long 0x0,0x0,0x0,0x0,0x0,0x0,0x0,0x0,0x0,0x0,0x0,0x0,0x0,0x0,0x0,0x0
.long 0x0,0x0,0x0,0x0,0x0,0x0,0x0,0x0,0x0,0x0,0x0,0x0,0x0,0x0,0x0,0x0
.long 0x0,0x0,0x0,0x0,0x0,0x0,0x0,0x0,0x0,0x0,0x0,0x0,0x0,0x0,0x0,0x0
.long 0x3f803f80,0x3f803f80,0x0,0x0,0x3f803f80,0x3f803f80,0x3f80,0x0,0x3f803f80,0x3f803f80,0x3f803f80,0x0,0x3f803f80,0x3f803f80,0x3f803f80,0x3f80
.long 0x3f800000,0x3f803f80,0x3f803f80,0x3f803f80,0x0,0x3f803f80,0x3f803f80,0x3f803f80,0x0,0x3f800000,0x3f803f80,0x3f803f80,0x0,0x0,0x3f803f80,0x3f803f80
.long 0x0,0x0,0x3f800000,0x3f803f80,0x0,0x0,0x0,0x3f803f80,0x0,0x0,0x0,0x3f800000,0x0,0x0,0x0,0x0
.long 0x0,0x0,0x0,0x0,0x0,0x0,0x0,0x0,0x0,0x0,0x0,0x0,0x0,0x0,0x0,0x0
.long 0x0,0x0,0x0,0x0,0x0,0x0,0x0,0x0,0x0,0x0,0x0,0x0,0x0,0x0,0x0,0x0
.long 0x0,0x0,0x0,0x0,0x3f80,0x0,0x0,0x0,0x3f803f80,0x0,0x0,0x0,0x3f803f80,0x3f80,0x0,0x0
.long 0x3f803f80,0x3f803f80,0x0,0x0,0x3f803f80,0x3f803f80,0x3f80,0x0,0x3f803f80,0x3f803f80,0x3f803f80,0x0,0x3f803f80,0x3f803f80,0x3f803f80,0x3f80
.long 0x3f800000,0x3f803f80,0x3f803f80,0x3f803f80,0x0,0x3f803f80,0x3f803f80,0x3f803f80,0x0,0x3f800000,0x3f803f80,0x3f803f80,0x0,0x0,0x3f803f80,0x3f803f80
.long 0x0,0x0,0x0,0x0,0x0,0x0,0x0,0x0,0x0,0x0,0x0,0x0,0x0,0x0,0x0,0x0
.long 0x0,0x0,0x0,0x0,0x0,0x0,0x0,0x0,0x0,0x0,0x0,0x0,0x0,0x0,0x0,0x0
.long 0x0,0x0,0x0,0x0,0x0,0x0,0x0,0x0,0x0,0x0,0x0,0x0,0x0,0x0,0x0,0x0
.long 0x0,0x0,0x0,0x0,0x3f80,0x0,0x0,0x0,0x3f803f80,0x0,0x0,0x0,0x3f803f80,0x3f80,0x0,0x0
.long 0x0,0x0,0x3f803f80,0x3f803f80,0x0,0x0,0x3f800000,0x3f803f80,0x0,0x0,0x0,0x3f803f80,0x0,0x0,0x0,0x3f800000
.long 0x0,0x0,0x0,0x0,0x0,0x0,0x0,0x0,0x0,0x0,0x0,0x0,0x0,0x0,0x0,0x0
.long 0x0,0x0,0x0,0x0,0x0,0x0,0x0,0x0,0x0,0x0,0x0,0x0,0x0,0x0,0x0,0x0
.long 0x0,0x0,0x0,0x0,0x0,0x0,0x0,0x0,0x0,0x0,0x0,0x0,0x0,0x0,0x0,0x0
.long 0x3f803f80,0x3f803f80,0x3f80,0x0,0x3f803f80,0x3f803f80,0x3f803f80,0x0,0x3f803f80,0x3f803f80,0x3f803f80,0x3f80,0x3f803f80,0x3f803f80,0x3f803f80,0x3f803f80
.long 0x3f803f80,0x3f803f80,0x3f803f80,0x3f803f80,0x3f800000,0x3f803f80,0x3f803f80,0x3f803f80,0x0,0x3f803f80,0x3f803f80,0x3f803f80,0x0,0x3f800000,0x3f803f80,0x3f803f80
.long 0x0,0x0,0x3f803f80,0x3f803f80,0x0,0x0,0x3f800000,0x3f803f80,0x0,0x0,0x0,0x3f803f80,0x0,0x0,0x0,0x3f800000
.long 0x0,0x0,0x0,0x0,0x0,0x0,0x0,0x0,0x0,0x0,0x0,0x0,0x0,0x0,0x0,0x0
.long 0x0,0x0,0x0,0x0,0x0,0x0,0x0,0x0,0x0,0x0,0x0,0x0,0x0,0x0,0x0,0x0
.long 0x3f80,0x0,0x0,0x0,0x3f803f80,0x0,0x0,0x0,0x3f803f80,0x3f80,0x0,0x0,0x3f803f80,0x3f803f80,0x0,0x0
.long 0x3f803f80,0x3f803f80,0x3f80,0x0,0x3f803f80,0x3f803f80,0x3f803f80,0x0,0x3f803f80,0x3f803f80,0x3f803f80,0x3f80,0x3f803f80,0x3f803f80,0x3f803f80,0x3f803f80
.long 0x3f803f80,0x3f803f80,0x3f803f80,0x3f803f80,0x3f800000,0x3f803f80,0x3f803f80,0x3f803f80,0x0,0x3f803f80,0x3f803f80,0x3f803f80,0x0,0x3f800000,0x3f803f80,0x3f803f80
.long 0x0,0x0,0x0,0x0,0x0,0x0,0x0,0x0,0x0,0x0,0x0,0x0,0x0,0x0,0x0,0x0
.long 0x0,0x0,0x0,0x0,0x0,0x0,0x0,0x0,0x0,0x0,0x0,0x0,0x0,0x0,0x0,0x0
.long 0x0,0x0,0x0,0x0,0x0,0x0,0x0,0x0,0x0,0x0,0x0,0x0,0x0,0x0,0x0,0x0
.long 0x3f80,0x0,0x0,0x0,0x3f803f80,0x0,0x0,0x0,0x3f803f80,0x3f80,0x0,0x0,0x3f803f80,0x3f803f80,0x0,0x0
.size vlane_tab, 5120
.section .rodata,"a"
.p2align 6
.amdhsa_kernel recurrent_scan__ssm_conv_s4d__geglu_ffn__prompt_kernel
  .amdhsa_next_free_vgpr 512
  .amdhsa_next_free_sgpr 102
  .amdhsa_accum_offset 256
  .amdhsa_group_segment_fixed_size 0
  .amdhsa_kernarg_size 112
  .amdhsa_user_sgpr_count 2
  .amdhsa_user_sgpr_kernarg_segment_ptr 1
  .amdhsa_system_sgpr_workgroup_id_x 1
.end_amdhsa_kernel
```
